```python
import torch

def _softmax(x, axis=-1):
    return torch.softmax(x, dim=axis)
def _gelu(x):
    return torch.nn.functional.gelu(x, approximate="tanh")
def _silu(x):
    return torch.nn.functional.silu(x)
def _sigmoid(x):
    return torch.sigmoid(x)
def _layernorm(x, axis=-1, eps=1e-5):
    m = x.mean(dim=axis, keepdim=True)
    v = x.var(dim=axis, keepdim=True, unbiased=False)
    return (x - m) / torch.sqrt(v + eps)
def _scatter_add(tgt, idx, src, axis=0):
    return tgt.clone().index_add_(axis, idx, src)
def _segment_sum(src, seg, n):
    out = torch.zeros((n,) + src.shape[1:], dtype=src.dtype)
    return out.index_add_(0, seg, src)
def _pad(x, pw):
    flat = tuple(v for pair in reversed(pw) for v in pair)
    return torch.nn.functional.pad(x, flat)

kernel_name = 'recurrent_scan__softmax_full_mha__geglu_ffn__prompt'

def setup_inputs():

    _w = (lambda a: (lambda t: t.to(torch.bfloat16) if t.is_floating_point() else t)(torch.as_tensor(a)))
    def _A_setup():
        B, S, D = 1, 2048, 1024
        return {
            "x": _w((lambda *s: torch.randn(*s, dtype=torch.bfloat16) * 0.05)(B, S, D)),
            "wqkv": _w((lambda *s: torch.randn(*s, dtype=torch.bfloat16) * 0.05)(D, 3 * D)),
            "wo": _w((lambda *s: torch.randn(*s, dtype=torch.bfloat16) * 0.05)(D, D)),
        }
    _A_in = _A_setup()

    def _B_setup():
        B, S, D, F = 1, 2048, 1024, 3584
        return {
            "x": _w((lambda *s: torch.randn(*s, dtype=torch.bfloat16) * 0.05)(B, S, D)),
            "w_gate": _w((lambda *s: torch.randn(*s, dtype=torch.bfloat16) * 0.05)(D, F)),
            "w_up": _w((lambda *s: torch.randn(*s, dtype=torch.bfloat16) * 0.05)(D, F)),
            "w_down": _w((lambda *s: torch.randn(*s, dtype=torch.bfloat16) * 0.05)(F, D)),
        }
    _B_in = _B_setup()

    return {
        "A_x": _A_in["x"],
        "A_wqkv": _A_in["wqkv"],
        "A_wo": _A_in["wo"],
        "B_x": _B_in["x"],
        "B_w_gate": _B_in["w_gate"],
        "B_w_up": _B_in["w_up"],
        "B_w_down": _B_in["w_down"],
    }

def reference(A_x, A_wqkv, A_wo, B_x, B_w_gate, B_w_up, B_w_down):
    def _A_ref(x, wqkv, wo):
        B, S, D = x.shape
        H = 32; Dh = D // H
        qkv = (lambda x, *d: x.permute(*d))((x @ wqkv).reshape(B, S, 3, H, Dh), 2, 0, 3, 1, 4)
        q, k, v = qkv[0], qkv[1], qkv[2]
        scale = Dh ** -0.5
        scores = torch.einsum("bhqd,bhkd->bhqk", q, k) * scale
        p = _softmax(scores, axis=-1)
        o = torch.einsum("bhqk,bhkd->bhqd", p, v)
        return (lambda x, *d: x.permute(*d))(o, 0, 2, 1, 3).reshape(B, S, D) @ wo

    def _B_ref(x, w_gate, w_up, w_down):
        return (_gelu(x @ w_gate) * (x @ w_up)) @ w_down

    x = A_x
    xn = _layernorm(x, axis=-1)
    s = _A_ref(xn, A_wqkv, A_wo)
    g = _silu(_B_ref(xn, B_w_gate, B_w_up, B_w_down))
    return x + s * g
```

```asm
; @launch grid=(256,1,1) block=(256,1,1) lds=163840
.amdgcn_target "amdgcn-amd-amdhsa--gfx950"
.text
.globl recurrent_scan__softmax_full_mha__geglu_ffn__prompt_kernel
.p2align 8
.type recurrent_scan__softmax_full_mha__geglu_ffn__prompt_kernel,@function
recurrent_scan__softmax_full_mha__geglu_ffn__prompt_kernel:
L_begin:
    s_cmp_ge_u32 s2, 256
    s_cbranch_scc1 L_end
    s_load_dwordx4 s[60:63], s[0:1], 0
    s_load_dwordx2 s[64:65], s[0:1], 16
    s_load_dwordx2 s[66:67], s[0:1], 32
    s_load_dwordx4 s[68:71], s[0:1], 40
    s_load_dwordx2 s[72:73], s[0:1], 56
    s_load_dwordx2 s[74:75], s[0:1], 72
    v_lshrrev_b32 v1, 6, v0
    v_and_b32 v0, 63, v0
    v_readfirstlane_b32 s77, v1
    s_getpc_b64 s[52:53]
L_pc0:
    s_add_u32 s52, s52, L_pc0-L_pc0
    s_addc_u32 s53, s53, 0
    s_mov_b32 s54, L_code_end-L_pc0
    s_mov_b32 s55, 0x20000
    s_lshr_b32 s4, s2, 3
    s_lshl_b32 s4, s4, 2
    s_add_u32 s4, s4, s77
    s_and_b32 s4, s4, 15
    s_lshl_b32 s4, s4, 12
    v_lshlrev_b32 v20, 6, v0
    v_add_u32 v20, s4, v20
    buffer_load_dword v163, v20, s[52:55], 0 offen
    v_and_b32 v13, 7, v0
    v_lshrrev_b32 v14, 3, v0
    v_lshlrev_b32 v15, 11, v13
    v_lshl_add_u32 v15, v14, 4, v15
    s_lshl_b32 s4, s2, 14
    s_lshl_b32 s5, s77, 7
    s_add_u32 s4, s4, s5
    v_add_u32 v15, s4, v15
    s_waitcnt lgkmcnt(0)
    s_add_u32 s56, s74, 41943040
    s_addc_u32 s57, s75, 0
    s_mov_b32 s28, s60
    s_mov_b32 s29, s61
    s_mov_b32 s30, 4194304
    s_mov_b32 s31, 0x20000
    buffer_load_dwordx4 v[24:27], v15, s[28:31], 0 offen offset:0
    buffer_load_dwordx4 v[28:31], v15, s[28:31], 0 offen offset:512
    buffer_load_dwordx4 v[32:35], v15, s[28:31], 0 offen offset:1024
    buffer_load_dwordx4 v[36:39], v15, s[28:31], 0 offen offset:1536
    s_mov_b32 s58, 2097152
    s_mov_b32 s59, 0x20000
    buffer_load_dword v51, off, s[56:59], 0 offset:0 sc1
    s_and_b32 s21, s2, 7
    s_lshl_b32 s21, s21, 2
    s_bfe_u32 s50, s2, 0x20003
    s_add_u32 s21, s21, s50
    s_lshr_b32 s22, s2, 5
    s_lshl_b32 s50, s21, 17
    s_add_u32 s51, s50, 4194304
    s_add_u32 s52, s51, 4194304
    s_add_u32 s53, s51, 8388608
    s_add_u32 s54, s50, 33554432
    v_lshlrev_b32 v2, 4, v0
    v_lshrrev_b32 v9, 4, v0
    v_lshlrev_b32 v9, 2, v9
    v_xor_b32 v9, v9, v0
    v_lshlrev_b32 v3, 4, v9
    s_lshl_b32 s24, s77, 11
    v_add_u32 v2, s24, v2
    v_add_u32 v3, s24, v3
    v_bfe_u32 v9, v0, 4, 1
    v_lshlrev_b32 v9, 10, v9
    v_lshrrev_b32 v10, 5, v0
    v_lshl_add_u32 v9, v10, 8, v9
    v_and_b32 v10, 15, v0
    v_lshl_add_u32 v4, v10, 4, v9
    s_lshl_b32 s27, s22, 14
    s_lshl_b32 s50, s77, 12
    s_add_u32 s27, s27, s50
    v_and_b32 v9, 3, v0
    v_bfe_u32 v10, v0, 2, 2
    v_lshrrev_b32 v11, 5, v0
    v_lshl_add_u32 v10, v11, 2, v10
    v_lshlrev_b32 v11, 2, v9
    v_xor_b32 v10, v10, v11
    v_lshlrev_b32 v10, 4, v10
    v_lshl_add_u32 v10, v9, 8, v10
    v_bfe_u32 v11, v0, 4, 1
    v_lshl_add_u32 v5, v11, 3, v10
    v_xor_b32 v165, 128, v5
    v_and_b32 v9, 6, v0
    v_mov_b32 v11, 0x3f803f80
    v_cmp_eq_u32 vcc, 0, v9
    v_cmp_eq_u32 s[50:51], 4, v9
    v_and_b32 v166, 1, v0
    v_cndmask_b32 v8, 0, v11, vcc
    v_cndmask_b32 v10, 0, v11, s[50:51]
    v_mov_b32 v9, v8
    v_mov_b32 v11, v10
    v_mul_u32_u24 v166, 0xaaaa, v166
    v_add_u32 v166, 0x4444, v166
    s_bfe_u32 s50, s2, 0x20001
    s_lshl_b32 s50, s50, 2
    s_bfe_u32 s51, s2, 0x20006
    s_add_u32 s44, s50, s51
    s_and_b32 s50, s2, 1
    s_lshl_b32 s50, s50, 3
    s_bfe_u32 s51, s2, 0x30003
    s_add_u32 s45, s50, s51
    s_add_u32 s32, s74, 16777216
    s_addc_u32 s33, s75, 0
    s_mov_b32 s34, 14680064
    s_mov_b32 s35, 0x20000
    s_mov_b32 s36, s70
    s_mov_b32 s37, s71
    s_mov_b32 s38, 7340032
    s_mov_b32 s39, 0x20000
    s_add_u32 s40, s74, 41943040
    s_addc_u32 s41, s75, 0
    s_mov_b32 s42, 2097152
    s_mov_b32 s43, 0x20000
    s_lshl_b32 s50, s44, 13
    s_lshl_b32 s51, s77, 17
    s_add_u32 s50, s50, s51
    s_add_u32 s51, s77, 0
    s_and_b32 s51, s51, 3
    s_lshl_b32 s51, s51, 11
    s_add_u32 s51, s51, s50
    v_add_u32 v176, s51, v4
    s_add_u32 s51, s77, 1
    s_and_b32 s51, s51, 3
    s_lshl_b32 s51, s51, 11
    s_add_u32 s51, s51, s50
    v_add_u32 v177, s51, v4
    s_add_u32 s51, s77, 2
    s_and_b32 s51, s51, 3
    s_lshl_b32 s51, s51, 11
    s_add_u32 s51, s51, s50
    v_add_u32 v178, s51, v4
    s_add_u32 s51, s77, 3
    s_and_b32 s51, s51, 3
    s_lshl_b32 s51, s51, 11
    s_add_u32 s51, s51, s50
    v_add_u32 v179, s51, v4
    v_lshrrev_b32 v180, 3, v0
    v_bfe_u32 v181, v0, 4, 1
    v_lshlrev_b32 v181, 2, v181
    v_and_b32 v182, 7, v0
    v_xor_b32 v181, v181, v182
    v_lshlrev_b32 v181, 4, v181
    v_lshl_add_u32 v180, v180, 11, v181
    s_lshl_b32 s50, s77, 16
    s_lshl_b32 s51, s45, 7
    s_add_u32 s50, s50, s51
    v_add_u32 v180, s50, v180
    s_lshl_b32 s48, s77, 14
    s_add_u32 s48, s48, 65536
    s_mov_b32 s46, 0
    s_mov_b32 s47, 0
    v_bfe_u32 v183, v0, 2, 2
    v_lshrrev_b32 v181, 5, v0
    v_lshl_add_u32 v181, v181, 2, v183
    v_lshlrev_b32 v181, 7, v181
    v_bfe_u32 v183, v0, 3, 1
    v_lshl_add_u32 v181, v183, 6, v181
    v_bfe_u32 v183, v0, 4, 1
    v_lshl_add_u32 v181, v183, 5, v181
    v_and_b32 v183, 3, v0
    v_lshl_add_u32 v181, v183, 3, v181
    v_add_u32 v181, s48, v181
    v_xor_b32 v182, 64, v181
    v_mov_b32 v183, 0
    s_lshr_b32 s52, s21, 2
    s_mul_i32 s50, s52, 3
    s_add_u32 s51, s50, 2
    s_add_u32 s52, s52, 24
    s_bfe_u32 s53, s21, 0x10001
    s_cselect_b32 s51, s52, s51
    s_add_u32 s50, s50, s53
    s_lshl_b32 s50, s50, 7
    s_lshl_b32 s51, s51, 7
    s_lshl_b32 s52, s52, 7
    s_lshl_b32 s53, s22, 4
    s_add_u32 s50, s50, s53
    v_and_b32 v156, 15, v0
    v_lshlrev_b32 v156, 3, v156
    v_add_u32 v157, s51, v156
    v_add_u32 v158, s52, v156
    v_cmp_gt_u32 vcc, 16, v0
    v_and_b32 v156, 8, v156
    v_add_u32 v156, s50, v156
    v_cndmask_b32 v157, v158, v157, vcc
    v_cmp_gt_u32 vcc, 32, v0
    s_and_b32 s53, s21, 1
    s_lshl_b32 s53, s53, 2
    s_add_u32 s53, s53, 8192
    v_cndmask_b32 v156, v156, v157, vcc
    v_add_u32 v156, s53, v156
    v_lshlrev_b32 v156, 5, v156
    v_mov_b32 v6, v4
    v_mov_b32 v7, v5
    v_mov_b32 v164, v165
    v_mov_b32 v172, 0
    v_mov_b32 v173, 0
    v_mov_b32 v174, 0
    v_mov_b32 v175, 0
    v_lshrrev_b32 v152, 3, v0
    v_and_b32 v167, 7, v0
    v_xor_b32 v167, v167, v152
    v_lshlrev_b32 v167, 4, v167
    v_lshl_add_u32 v167, v152, 11, v167
    s_lshl_b32 s50, s44, 18
    s_lshl_b32 s51, s77, 16
    s_add_u32 s50, s50, s51
    s_lshl_b32 s51, s45, 7
    s_add_u32 s50, s50, s51
    v_add_u32 v167, s50, v167
    s_mov_b32 s92, s60
    s_mov_b32 s93, s61
    s_mov_b32 s94, 4194304
    s_mov_b32 s95, 0x20000
    s_lshl_b32 s98, s77, 13
    s_add_u32 s98, s98, 131072
    v_lshrrev_b32 v152, 5, v0
    v_and_b32 v148, 7, v0
    v_xor_b32 v148, v148, v152
    v_lshlrev_b32 v148, 4, v148
    v_and_b32 v152, 31, v0
    v_lshl_add_u32 v148, v152, 7, v148
    v_add_u32 v148, s98, v148
    v_xor_b32 v149, 32, v148
    v_xor_b32 v150, 64, v148
    v_xor_b32 v151, 96, v148
    v_lshlrev_b32 v152, 4, v0
    v_add_u32 v152, s98, v152
    s_mov_b32 s84, s64
    s_mov_b32 s85, s65
    s_mov_b32 s86, 2097152
    s_mov_b32 s87, 0x20000
    s_lshl_b32 s50, s77, 17
    v_subrev_u32 v191, s50, v176
    s_mul_i32 s50, s77, 49152
    v_subrev_u32 v190, s50, v180
    v_lshlrev_b32 v189, 4, v0
    s_add_u32 s50, s77, 1
    s_and_b32 s50, s50, 3
    s_lshl_b32 s50, s50, 14
    s_add_u32 s50, s50, 0
    v_add_u32 v186, s50, v189
    s_add_u32 s50, s77, 2
    s_and_b32 s50, s50, 3
    s_lshl_b32 s50, s50, 14
    s_add_u32 s50, s50, 8192
    v_add_u32 v187, s50, v189
    s_add_u32 s50, s77, 3
    s_and_b32 s50, s50, 3
    s_lshl_b32 s50, s50, 13
    s_add_u32 s50, s50, 131072
    v_add_u32 v188, s50, v189
    s_mov_b32 s99, 0xfffb0000
    s_lshl_b32 s50, s77, 12
    v_lshlrev_b32 v162, 6, v0
    v_add_u32 v162, s50, v162
    v_lshlrev_b32 v161, 2, v0
    s_lshl_b32 s50, s44, 8
    s_add_u32 s50, s50, 16384
    v_add_u32 v159, s50, v161
    v_lshlrev_b32 v159, 5, v159
    s_lshr_b32 s96, s77, 1
    s_lshl_b32 s51, s22, 1
    s_add_u32 s96, s96, s51
    s_lshl_b32 s96, s96, 8
    s_lshl_b32 s51, s21, 3
    s_add_u32 s96, s96, s51
    s_and_b32 s51, s77, 1
    s_lshl_b32 s51, s51, 2
    s_add_u32 s96, s96, s51
    s_add_u32 s96, s96, 24576
    s_lshl_b32 s96, s96, 5
    s_mov_b32 s4, s74
    s_mov_b32 s5, s75
    s_mov_b32 s6, 4194304
    s_mov_b32 s7, 0x20000
    v_and_b32 v18, 3, v14
    s_and_b32 s55, s2, 7
    s_mul_i32 s43, s55, 3
    s_bfe_u32 s54, s2, 0x20003
    s_add_u32 s43, s43, s54
    s_add_u32 s55, s55, 24
    s_cmp_eq_u32 s54, 3
    s_cselect_b32 s43, s55, s43
    s_lshr_b32 s44, s2, 5
    s_lshr_b32 s41, s77, 1
    s_and_b32 s42, s77, 1
    s_lshl_b32 s48, s43, 8
    s_sub_u32 s46, s43, 24
    s_lshl_b32 s50, s46, 7
    s_add_u32 s50, s50, 6144
    s_mul_i32 s49, s54, 8
    s_lshr_b32 s49, 0x21100100, s49
    s_and_b32 s49, s49, 0xff
    s_and_b32 s51, s2, 7
    s_lshl_b32 s51, s51, 1
    s_add_u32 s40, s49, s51
    s_lshl_b32 s49, s40, 7
    s_cmp_lt_u32 s43, 24
    s_cselect_b32 s45, 0, 1
    s_cselect_b32 s48, s48, s50
    s_mov_b32 s50, 229376
    s_mov_b32 s51, 196608
    s_cselect_b32 s36, s50, s51
    s_add_u32 s8, s66, s48
    s_addc_u32 s9, s67, 0
    s_sub_u32 s10, 7340032, s48
    s_mov_b32 s11, 0x20000
    s_add_u32 s12, s68, s48
    s_addc_u32 s13, s69, 0
    s_sub_u32 s14, 7340032, s48
    s_mov_b32 s15, 0x20000
    s_add_u32 s24, s62, s49
    s_addc_u32 s25, s63, 0
    s_sub_u32 s26, 6291456, s49
    s_mov_b32 s27, 0x20000
    s_cmp_eq_u32 s45, 0
    s_cbranch_scc0 L_g1_typeC
    s_add_u32 s50, s48, 128
    s_add_u32 s16, s66, s50
    s_addc_u32 s17, s67, 0
    s_sub_u32 s18, 7340032, s50
    s_mov_b32 s19, 0x20000
    s_add_u32 s20, s68, s50
    s_addc_u32 s21, s69, 0
    s_sub_u32 s22, 7340032, s50
    s_mov_b32 s23, 0x20000
    s_branch L_g1_typeD
L_g1_typeC:
    s_sub_u32 s50, s49, 2048
    s_sub_u32 s51, s49, 128
    s_add_u32 s16, s62, s50
    s_addc_u32 s17, s63, 0
    s_sub_u32 s18, 6291456, s50
    s_mov_b32 s19, 0x20000
    s_add_u32 s20, s62, s51
    s_addc_u32 s21, s63, 0
    s_sub_u32 s22, 6291456, s51
    s_mov_b32 s23, 0x20000
L_g1_typeD:
    v_lshlrev_b32 v184, 4, v0
    s_lshl_b32 s50, s44, 14
    s_lshl_b32 s51, s77, 12
    s_add_u32 s50, s50, s51
    v_add_u32 v60, s50, v184
    v_and_b32 v16, 6, v14
    v_xor_b32 v16, v16, v13
    v_lshlrev_b32 v16, 4, v16
    v_lshrrev_b32 v17, 2, v14
    v_lshl_add_u32 v17, v17, 3, v18
    s_lshl_b32 s50, s42, 4
    s_lshl_b32 s51, s41, 2
    s_add_u32 s50, s50, s51
    v_add_u32 v17, s50, v17
    v_mul_u32_u24 v61, 7168, v17
    v_add_u32 v61, v61, v16
    v_mul_u32_u24 v62, 6144, v17
    v_add_u32 v62, v62, v16
    s_cmp_eq_u32 s45, 0
    s_cselect_b64 vcc, -1, 0
    v_cndmask_b32 v63, v62, v61, vcc
    s_mov_b32 s32, 0
    s_mov_b32 s33, 0
    s_mov_b32 s34, 0
    s_mov_b32 s35, 0
    s_lshl_b32 s37, s77, 12
    s_lshl_b32 s38, s77, 10
    s_add_u32 s38, s38, 16384
    s_add_u32 m0, s38, 0
    s_nop 0
    buffer_load_dwordx4 v61, s[8:11], s33 offen lds
    s_add_u32 m0, s38, 4096
    s_nop 0
    buffer_load_dwordx4 v61, s[12:15], s33 offen lds
    s_add_u32 s33, s33, 229376
    s_add_u32 m0, s38, 8192
    s_nop 0
    buffer_load_dwordx4 v63, s[16:19], s35 offen lds
    s_add_u32 m0, s38, 12288
    s_nop 0
    buffer_load_dwordx4 v63, s[20:23], s35 offen lds
    s_add_u32 s35, s35, s36
    s_add_u32 m0, s38, 16384
    s_nop 0
    buffer_load_dwordx4 v62, s[24:27], s34 offen lds
    s_add_u32 s34, s34, 196608
    v_lshrrev_b32 v21, 2, v14
    v_lshlrev_b32 v21, 17, v21
    v_lshl_add_u32 v21, v18, 8, v21
    v_lshl_add_u32 v21, v13, 4, v21
    s_lshr_b32 s50, s2, 1
    s_lshl_b32 s50, s50, 10
    s_and_b32 s51, s2, 1
    s_lshl_b32 s51, s51, 7
    s_add_u32 s50, s50, s51
    s_lshl_b32 s51, s77, 18
    s_add_u32 s50, s50, s51
    v_add_u32 v21, s50, v21
    v_lshlrev_b32 v23, 4, v13
    v_add_u32 v23, 147456, v23
    s_lshl_b32 s50, s77, 2
    v_add_u32 v22, s50, v23
    s_mov_b32 s50, 0xffff0000
    s_waitcnt vmcnt(9)
    v_lshlrev_b32 v64, 16, v24
    v_and_b32 v65, s50, v24
    v_lshlrev_b32 v66, 16, v25
    v_and_b32 v67, s50, v25
    v_lshlrev_b32 v68, 16, v26
    v_and_b32 v69, s50, v26
    v_lshlrev_b32 v70, 16, v27
    v_and_b32 v71, s50, v27
    s_waitcnt vmcnt(8)
    v_lshlrev_b32 v72, 16, v28
    v_and_b32 v73, s50, v28
    v_lshlrev_b32 v74, 16, v29
    v_and_b32 v75, s50, v29
    v_lshlrev_b32 v76, 16, v30
    v_and_b32 v77, s50, v30
    v_lshlrev_b32 v78, 16, v31
    v_and_b32 v79, s50, v31
    s_waitcnt vmcnt(7)
    v_lshlrev_b32 v80, 16, v32
    v_and_b32 v81, s50, v32
    v_lshlrev_b32 v82, 16, v33
    v_and_b32 v83, s50, v33
    v_lshlrev_b32 v84, 16, v34
    v_and_b32 v85, s50, v34
    v_lshlrev_b32 v86, 16, v35
    v_and_b32 v87, s50, v35
    s_waitcnt vmcnt(6)
    v_lshlrev_b32 v88, 16, v36
    v_and_b32 v89, s50, v36
    v_lshlrev_b32 v90, 16, v37
    v_and_b32 v91, s50, v37
    v_lshlrev_b32 v92, 16, v38
    v_and_b32 v93, s50, v38
    v_lshlrev_b32 v94, 16, v39
    v_and_b32 v95, s50, v39
    v_pk_add_f32 v[40:41], v[64:65], v[66:67]
    v_pk_add_f32 v[42:43], v[68:69], v[70:71]
    v_pk_add_f32 v[40:41], v[40:41], v[72:73]
    v_pk_add_f32 v[42:43], v[42:43], v[74:75]
    v_pk_add_f32 v[40:41], v[40:41], v[76:77]
    v_pk_add_f32 v[42:43], v[42:43], v[78:79]
    v_pk_add_f32 v[40:41], v[40:41], v[80:81]
    v_pk_add_f32 v[42:43], v[42:43], v[82:83]
    v_pk_add_f32 v[40:41], v[40:41], v[84:85]
    v_pk_add_f32 v[42:43], v[42:43], v[86:87]
    v_pk_add_f32 v[40:41], v[40:41], v[88:89]
    v_pk_add_f32 v[42:43], v[42:43], v[90:91]
    v_pk_add_f32 v[40:41], v[40:41], v[92:93]
    v_pk_add_f32 v[42:43], v[42:43], v[94:95]
    v_pk_add_f32 v[40:41], v[40:41], v[42:43]
    v_add_f32 v40, v40, v41
    s_nop 1
    v_add_f32_dpp v40, v40, v40 row_ror:8 row_mask:0xf bank_mask:0xf
    v_mov_b32 v41, v40
    s_nop 1
    v_permlane16_swap_b32 v40, v41
    s_nop 1
    v_add_f32 v40, v40, v41
    v_mov_b32 v41, v40
    s_nop 1
    v_permlane32_swap_b32 v40, v41
    s_nop 1
    v_add_f32 v40, v40, v41
    ds_write_b32 v22, v40 offset:0
    s_waitcnt lgkmcnt(0)
    s_barrier
    ds_read_b128 v[44:47], v23 offset:0
    s_waitcnt lgkmcnt(0)
    v_add_f32 v44, v44, v45
    v_add_f32 v46, v46, v47
    v_add_f32 v40, v44, v46
    v_mul_f32 v40, 0x3a800000, v40
    v_mov_b32 v41, v40
    v_pk_add_f32 v[96:97], v[64:65], v[40:41] neg_lo:[0,1] neg_hi:[0,1]
    v_pk_add_f32 v[98:99], v[66:67], v[40:41] neg_lo:[0,1] neg_hi:[0,1]
    v_pk_add_f32 v[100:101], v[68:69], v[40:41] neg_lo:[0,1] neg_hi:[0,1]
    v_pk_add_f32 v[102:103], v[70:71], v[40:41] neg_lo:[0,1] neg_hi:[0,1]
    v_pk_add_f32 v[104:105], v[72:73], v[40:41] neg_lo:[0,1] neg_hi:[0,1]
    v_pk_add_f32 v[106:107], v[74:75], v[40:41] neg_lo:[0,1] neg_hi:[0,1]
    v_pk_add_f32 v[108:109], v[76:77], v[40:41] neg_lo:[0,1] neg_hi:[0,1]
    v_pk_add_f32 v[110:111], v[78:79], v[40:41] neg_lo:[0,1] neg_hi:[0,1]
    v_pk_add_f32 v[112:113], v[80:81], v[40:41] neg_lo:[0,1] neg_hi:[0,1]
    v_pk_add_f32 v[114:115], v[82:83], v[40:41] neg_lo:[0,1] neg_hi:[0,1]
    v_pk_add_f32 v[116:117], v[84:85], v[40:41] neg_lo:[0,1] neg_hi:[0,1]
    v_pk_add_f32 v[118:119], v[86:87], v[40:41] neg_lo:[0,1] neg_hi:[0,1]
    v_pk_add_f32 v[120:121], v[88:89], v[40:41] neg_lo:[0,1] neg_hi:[0,1]
    v_pk_add_f32 v[122:123], v[90:91], v[40:41] neg_lo:[0,1] neg_hi:[0,1]
    v_pk_add_f32 v[124:125], v[92:93], v[40:41] neg_lo:[0,1] neg_hi:[0,1]
    v_pk_add_f32 v[126:127], v[94:95], v[40:41] neg_lo:[0,1] neg_hi:[0,1]
    v_pk_mul_f32 v[42:43], v[96:97], v[96:97]
    v_pk_mul_f32 v[48:49], v[98:99], v[98:99]
    v_pk_fma_f32 v[42:43], v[100:101], v[100:101], v[42:43]
    v_pk_fma_f32 v[48:49], v[102:103], v[102:103], v[48:49]
    v_pk_fma_f32 v[42:43], v[104:105], v[104:105], v[42:43]
    v_pk_fma_f32 v[48:49], v[106:107], v[106:107], v[48:49]
    v_pk_fma_f32 v[42:43], v[108:109], v[108:109], v[42:43]
    v_pk_fma_f32 v[48:49], v[110:111], v[110:111], v[48:49]
    v_pk_fma_f32 v[42:43], v[112:113], v[112:113], v[42:43]
    v_pk_fma_f32 v[48:49], v[114:115], v[114:115], v[48:49]
    v_pk_fma_f32 v[42:43], v[116:117], v[116:117], v[42:43]
    v_pk_fma_f32 v[48:49], v[118:119], v[118:119], v[48:49]
    v_pk_fma_f32 v[42:43], v[120:121], v[120:121], v[42:43]
    v_pk_fma_f32 v[48:49], v[122:123], v[122:123], v[48:49]
    v_pk_fma_f32 v[42:43], v[124:125], v[124:125], v[42:43]
    v_pk_fma_f32 v[48:49], v[126:127], v[126:127], v[48:49]
    v_pk_add_f32 v[42:43], v[42:43], v[48:49]
    v_add_f32 v42, v42, v43
    s_nop 1
    v_add_f32_dpp v42, v42, v42 row_ror:8 row_mask:0xf bank_mask:0xf
    v_mov_b32 v43, v42
    s_nop 1
    v_permlane16_swap_b32 v42, v43
    s_nop 1
    v_add_f32 v42, v42, v43
    v_mov_b32 v43, v42
    s_nop 1
    v_permlane32_swap_b32 v42, v43
    s_nop 1
    v_add_f32 v42, v42, v43
    ds_write_b32 v22, v42 offset:128
    v_cvt_pk_bf16_f32 v40, v40, v40
    v_lshlrev_b32 v40, 16, v40
    v_mov_b32 v41, v40
    v_pk_add_f32 v[64:65], v[64:65], v[40:41] neg_lo:[0,1] neg_hi:[0,1]
    v_pk_add_f32 v[66:67], v[66:67], v[40:41] neg_lo:[0,1] neg_hi:[0,1]
    v_pk_add_f32 v[68:69], v[68:69], v[40:41] neg_lo:[0,1] neg_hi:[0,1]
    v_pk_add_f32 v[70:71], v[70:71], v[40:41] neg_lo:[0,1] neg_hi:[0,1]
    v_pk_add_f32 v[72:73], v[72:73], v[40:41] neg_lo:[0,1] neg_hi:[0,1]
    v_pk_add_f32 v[74:75], v[74:75], v[40:41] neg_lo:[0,1] neg_hi:[0,1]
    v_pk_add_f32 v[76:77], v[76:77], v[40:41] neg_lo:[0,1] neg_hi:[0,1]
    v_pk_add_f32 v[78:79], v[78:79], v[40:41] neg_lo:[0,1] neg_hi:[0,1]
    v_pk_add_f32 v[80:81], v[80:81], v[40:41] neg_lo:[0,1] neg_hi:[0,1]
    v_pk_add_f32 v[82:83], v[82:83], v[40:41] neg_lo:[0,1] neg_hi:[0,1]
    v_pk_add_f32 v[84:85], v[84:85], v[40:41] neg_lo:[0,1] neg_hi:[0,1]
    v_pk_add_f32 v[86:87], v[86:87], v[40:41] neg_lo:[0,1] neg_hi:[0,1]
    v_pk_add_f32 v[88:89], v[88:89], v[40:41] neg_lo:[0,1] neg_hi:[0,1]
    v_pk_add_f32 v[90:91], v[90:91], v[40:41] neg_lo:[0,1] neg_hi:[0,1]
    v_pk_add_f32 v[92:93], v[92:93], v[40:41] neg_lo:[0,1] neg_hi:[0,1]
    v_pk_add_f32 v[94:95], v[94:95], v[40:41] neg_lo:[0,1] neg_hi:[0,1]
    s_waitcnt lgkmcnt(0)
    s_barrier
    ds_read_b128 v[44:47], v23 offset:128
    v_cvt_pk_bf16_f32 v24, v64, v65
    v_cvt_pk_bf16_f32 v25, v66, v67
    v_cvt_pk_bf16_f32 v26, v68, v69
    v_cvt_pk_bf16_f32 v27, v70, v71
    v_cvt_pk_bf16_f32 v28, v72, v73
    v_cvt_pk_bf16_f32 v29, v74, v75
    v_cvt_pk_bf16_f32 v30, v76, v77
    v_cvt_pk_bf16_f32 v31, v78, v79
    v_cvt_pk_bf16_f32 v32, v80, v81
    v_cvt_pk_bf16_f32 v33, v82, v83
    v_cvt_pk_bf16_f32 v34, v84, v85
    v_cvt_pk_bf16_f32 v35, v86, v87
    v_cvt_pk_bf16_f32 v36, v88, v89
    v_cvt_pk_bf16_f32 v37, v90, v91
    v_cvt_pk_bf16_f32 v38, v92, v93
    v_cvt_pk_bf16_f32 v39, v94, v95
    v_lshlrev_b32 v64, 16, v24
    v_and_b32 v65, s50, v24
    v_lshlrev_b32 v66, 16, v25
    v_and_b32 v67, s50, v25
    v_lshlrev_b32 v68, 16, v26
    v_and_b32 v69, s50, v26
    v_lshlrev_b32 v70, 16, v27
    v_and_b32 v71, s50, v27
    v_lshlrev_b32 v72, 16, v28
    v_and_b32 v73, s50, v28
    v_lshlrev_b32 v74, 16, v29
    v_and_b32 v75, s50, v29
    v_lshlrev_b32 v76, 16, v30
    v_and_b32 v77, s50, v30
    v_lshlrev_b32 v78, 16, v31
    v_and_b32 v79, s50, v31
    v_lshlrev_b32 v80, 16, v32
    v_and_b32 v81, s50, v32
    v_lshlrev_b32 v82, 16, v33
    v_and_b32 v83, s50, v33
    v_lshlrev_b32 v84, 16, v34
    v_and_b32 v85, s50, v34
    v_lshlrev_b32 v86, 16, v35
    v_and_b32 v87, s50, v35
    v_lshlrev_b32 v88, 16, v36
    v_and_b32 v89, s50, v36
    v_lshlrev_b32 v90, 16, v37
    v_and_b32 v91, s50, v37
    v_lshlrev_b32 v92, 16, v38
    v_and_b32 v93, s50, v38
    v_lshlrev_b32 v94, 16, v39
    v_and_b32 v95, s50, v39
    s_waitcnt lgkmcnt(0)
    v_add_f32 v44, v44, v45
    v_add_f32 v46, v46, v47
    v_add_f32 v42, v44, v46
    v_mul_f32 v42, 0x3a800000, v42
    v_cvt_pk_bf16_f32 v42, v42, v42
    v_lshlrev_b32 v42, 16, v42
    v_add_f32 v42, 0x3727c5ac, v42
    v_cvt_pk_bf16_f32 v42, v42, v42
    v_lshlrev_b32 v42, 16, v42
    v_sqrt_f32 v42, v42
    s_nop 0
    v_cvt_pk_bf16_f32 v42, v42, v42
    v_lshlrev_b32 v42, 16, v42
    v_rcp_f32 v42, v42
    s_mov_b32 s51, 0
    v_mov_b32 v43, v42
    v_pk_mul_f32 v[64:65], v[64:65], v[42:43]
    v_pk_mul_f32 v[66:67], v[66:67], v[42:43]
    v_pk_mul_f32 v[68:69], v[68:69], v[42:43]
    v_pk_mul_f32 v[70:71], v[70:71], v[42:43]
    v_cvt_pk_bf16_f32 v24, v64, v65
    v_cvt_pk_bf16_f32 v25, v66, v67
    v_cvt_pk_bf16_f32 v26, v68, v69
    v_cvt_pk_bf16_f32 v27, v70, v71
    buffer_store_dwordx4 v[24:27], v21, s[4:7], s51 offen sc1
    s_add_u32 s51, s51, 0x100000
    v_pk_mul_f32 v[72:73], v[72:73], v[42:43]
    v_pk_mul_f32 v[74:75], v[74:75], v[42:43]
    v_pk_mul_f32 v[76:77], v[76:77], v[42:43]
    v_pk_mul_f32 v[78:79], v[78:79], v[42:43]
    v_cvt_pk_bf16_f32 v28, v72, v73
    v_cvt_pk_bf16_f32 v29, v74, v75
    v_cvt_pk_bf16_f32 v30, v76, v77
    v_cvt_pk_bf16_f32 v31, v78, v79
    buffer_store_dwordx4 v[28:31], v21, s[4:7], s51 offen sc1
    s_add_u32 s51, s51, 0x100000
    v_pk_mul_f32 v[80:81], v[80:81], v[42:43]
    v_pk_mul_f32 v[82:83], v[82:83], v[42:43]
    v_pk_mul_f32 v[84:85], v[84:85], v[42:43]
    v_pk_mul_f32 v[86:87], v[86:87], v[42:43]
    v_cvt_pk_bf16_f32 v32, v80, v81
    v_cvt_pk_bf16_f32 v33, v82, v83
    v_cvt_pk_bf16_f32 v34, v84, v85
    v_cvt_pk_bf16_f32 v35, v86, v87
    buffer_store_dwordx4 v[32:35], v21, s[4:7], s51 offen sc1
    s_add_u32 s51, s51, 0x100000
    v_pk_mul_f32 v[88:89], v[88:89], v[42:43]
    v_pk_mul_f32 v[90:91], v[90:91], v[42:43]
    v_pk_mul_f32 v[92:93], v[92:93], v[42:43]
    v_pk_mul_f32 v[94:95], v[94:95], v[42:43]
    v_cvt_pk_bf16_f32 v36, v88, v89
    v_cvt_pk_bf16_f32 v37, v90, v91
    v_cvt_pk_bf16_f32 v38, v92, v93
    v_cvt_pk_bf16_f32 v39, v94, v95
    buffer_store_dwordx4 v[36:39], v21, s[4:7], s51 offen sc1
    s_add_u32 s51, s51, 0x100000
    s_lshl_b32 s50, s41, 13
    v_add_u32 v54, s50, v184
    v_add_u32 v55, 73728, v54
    v_lshrrev_b32 v13, 2, v0
    v_and_b32 v13, 7, v13
    v_and_b32 v14, 6, v13
    v_bfe_u32 v15, v0, 1, 1
    s_lshl_b32 s50, s42, 2
    v_add_u32 v15, s50, v15
    v_lshrrev_b32 v16, 5, v0
    v_lshlrev_b32 v16, 10, v16
    v_lshl_add_u32 v16, v13, 7, v16
    v_and_b32 v17, 1, v0
    v_lshl_add_u32 v16, v17, 3, v16
    v_add_u32 v16, 16384, v16
    v_add_u32 v17, 0, v15
    v_xor_b32 v17, v17, v14
    v_lshl_add_u32 v56, v17, 4, v16
    v_add_u32 v58, 73728, v56
    v_add_u32 v17, 2, v15
    v_xor_b32 v17, v17, v14
    v_lshl_add_u32 v57, v17, 4, v16
    v_add_u32 v59, 73728, v57
    s_lshl_b32 s50, s44, 8
    s_and_b32 s51, s2, 31
    s_lshl_b32 s51, s51, 2
    s_add_u32 s51, s51, s50
    s_add_u32 s51, s51, 4096
    v_mov_b32 v128, 0
    v_mov_b32 v129, 0
    v_mov_b32 v130, 0
    v_mov_b32 v131, 0
    s_nop 1
    v_mfma_f32_32x32x16_bf16 a[0:15], v[128:131], v[128:131], 0
    v_mfma_f32_32x32x16_bf16 a[16:31], v[128:131], v[128:131], 0
    v_mfma_f32_32x32x16_bf16 a[32:47], v[128:131], v[128:131], 0
    v_mfma_f32_32x32x16_bf16 a[48:63], v[128:131], v[128:131], 0
    v_mfma_f32_32x32x16_bf16 a[64:79], v[128:131], v[128:131], 0
    v_mfma_f32_32x32x16_bf16 a[80:95], v[128:131], v[128:131], 0
    v_mfma_f32_32x32x16_bf16 a[96:111], v[128:131], v[128:131], 0
    v_mfma_f32_32x32x16_bf16 a[112:127], v[128:131], v[128:131], 0
    v_mfma_f32_32x32x16_bf16 a[128:143], v[128:131], v[128:131], 0
    v_mfma_f32_32x32x16_bf16 a[144:159], v[128:131], v[128:131], 0
    v_mfma_f32_32x32x16_bf16 a[160:175], v[128:131], v[128:131], 0
    v_mfma_f32_32x32x16_bf16 a[176:191], v[128:131], v[128:131], 0
    v_mfma_f32_32x32x16_bf16 v[64:79], v[128:131], v[128:131], 0
    v_mfma_f32_32x32x16_bf16 v[80:95], v[128:131], v[128:131], 0
    v_mfma_f32_32x32x16_bf16 v[96:111], v[128:131], v[128:131], 0
    v_mfma_f32_32x32x16_bf16 v[112:127], v[128:131], v[128:131], 0
    v_mfma_f32_32x32x16_bf16 v[192:207], v[128:131], v[128:131], 0
    v_mfma_f32_32x32x16_bf16 v[208:223], v[128:131], v[128:131], 0
    v_mfma_f32_32x32x16_bf16 v[224:239], v[128:131], v[128:131], 0
    v_mfma_f32_32x32x16_bf16 v[240:255], v[128:131], v[128:131], 0
    s_waitcnt vmcnt(0)
    v_readfirstlane_b32 s76, v51
    s_barrier
    s_add_u32 s76, s76, 1
    s_cmp_eq_u32 s77, 0
    s_cbranch_scc0 L_nosig0
    s_lshl_b32 s51, s51, 5
    v_lshlrev_b32 v13, 2, v0
    v_mov_b32 v14, s76
    s_mov_b32 exec_hi, 0
    buffer_store_dword v14, v13, s[56:59], s51 offen sc1
    s_mov_b64 exec, -1
L_nosig0:
    s_add_u32 m0, s38, 36864
    s_nop 0
    buffer_load_dwordx4 v61, s[8:11], s33 offen lds
    s_add_u32 m0, s38, 40960
    s_nop 0
    buffer_load_dwordx4 v61, s[12:15], s33 offen lds
    s_add_u32 s33, s33, 229376
    s_add_u32 m0, s38, 45056
    s_nop 0
    buffer_load_dwordx4 v63, s[16:19], s35 offen lds
    s_add_u32 m0, s38, 49152
    s_nop 0
    buffer_load_dwordx4 v63, s[20:23], s35 offen lds
    s_add_u32 s35, s35, s36
    s_add_u32 m0, s38, 53248
    s_nop 0
    buffer_load_dwordx4 v62, s[24:27], s34 offen lds
    s_add_u32 s34, s34, 196608
    s_add_u32 m0, s38, 73728
    s_nop 0
    buffer_load_dwordx4 v61, s[8:11], s33 offen lds
    s_add_u32 m0, s38, 77824
    s_nop 0
    buffer_load_dwordx4 v61, s[12:15], s33 offen lds
    s_add_u32 s33, s33, 229376
    s_add_u32 m0, s38, 81920
    s_nop 0
    buffer_load_dwordx4 v63, s[16:19], s35 offen lds
    s_add_u32 m0, s38, 86016
    s_nop 0
    buffer_load_dwordx4 v63, s[20:23], s35 offen lds
    s_add_u32 s35, s35, s36
    s_add_u32 m0, s38, 90112
    s_nop 0
    buffer_load_dwordx4 v62, s[24:27], s34 offen lds
    s_add_u32 s34, s34, 196608
    v_and_b32 v13, 31, v0
    v_lshlrev_b32 v13, 2, v13
    s_lshl_b32 s47, s44, 8
    s_add_u32 s47, s47, 4096
    v_add_u32 v13, s47, v13
    v_lshlrev_b32 v13, 5, v13
    s_mov_b32 s48, s62
    s_mov_b32 s49, s63
    s_mov_b32 s50, 6291456
    s_mov_b32 s3, 768
    s_mov_b32 s46, 0x120000
    s_cmp_eq_u32 s77, 1
    s_cselect_b32 s48, s66, s48
    s_cselect_b32 s49, s67, s49
    s_cselect_b32 s50, 7340032, s50
    s_cselect_b32 s3, 896, s3
    s_cselect_b32 s46, 0x150000, s46
    s_cmp_eq_u32 s77, 2
    s_cselect_b32 s48, s68, s48
    s_cselect_b32 s49, s69, s49
    s_cselect_b32 s50, 7340032, s50
    s_cselect_b32 s3, 896, s3
    s_cselect_b32 s46, 0x150000, s46
    s_cmp_eq_u32 s77, 3
    s_cselect_b32 s48, s70, s48
    s_cselect_b32 s49, s71, s49
    s_cselect_b32 s50, 7340032, s50
    s_cselect_b32 s3, 1024, s3
    s_cselect_b32 s46, 0x0, s46
    s_mov_b32 s51, 0x20000
    s_mul_i32 s100, s2, s3
    s_add_u32 s100, s100, s46
    s_sub_u32 s101, s3, 128
    v_lshlrev_b32 v18, 7, v0
    v_min_u32 v18, s101, v18
    s_lshl_b32 s3, s3, 8
    s_cmp_lg_u32 s77, 3
    s_cbranch_scc1 L_f0_go
    s_mov_b32 s47, 0x40000
L_f0_poll:
    buffer_load_dword v14, v13, s[56:59], 0 offen sc1
    s_waitcnt vmcnt(0)
    v_cmp_ne_u32 vcc, s76, v14
    s_cmp_eq_u64 vcc, 0
    s_cbranch_scc1 L_f0_go
    s_sleep 1
    s_sub_u32 s47, s47, 1
    s_cmp_lg_u32 s47, 0
    s_cbranch_scc1 L_f0_poll
L_f0_go:
    s_barrier
    s_add_u32 m0, s37, 0
    s_nop 0
    buffer_load_dwordx4 v60, s[4:7], s32 offen sc1 lds
    buffer_load_dwordx4 v60, s[4:7], s32 offen offset:1024 sc1 lds
    buffer_load_dwordx4 v60, s[4:7], s32 offen offset:2048 sc1 lds
    buffer_load_dwordx4 v60, s[4:7], s32 offen offset:3072 sc1 lds
    s_add_u32 s32, s32, 0x20000
    s_add_u32 m0, s37, 36864
    s_nop 0
    buffer_load_dwordx4 v60, s[4:7], s32 offen sc1 lds
    buffer_load_dwordx4 v60, s[4:7], s32 offen offset:1024 sc1 lds
    buffer_load_dwordx4 v60, s[4:7], s32 offen offset:2048 sc1 lds
    buffer_load_dwordx4 v60, s[4:7], s32 offen offset:3072 sc1 lds
    s_add_u32 s32, s32, 0x20000
    s_add_u32 m0, s37, 73728
    s_nop 0
    buffer_load_dwordx4 v60, s[4:7], s32 offen sc1 lds
    buffer_load_dwordx4 v60, s[4:7], s32 offen offset:1024 sc1 lds
    buffer_load_dwordx4 v60, s[4:7], s32 offen offset:2048 sc1 lds
    buffer_load_dwordx4 v60, s[4:7], s32 offen offset:3072 sc1 lds
    s_add_u32 s32, s32, 0x20000
    s_add_u32 m0, s37, 110592
    s_nop 0
    buffer_load_dwordx4 v60, s[4:7], s32 offen sc1 lds
    buffer_load_dwordx4 v60, s[4:7], s32 offen offset:1024 sc1 lds
    buffer_load_dwordx4 v60, s[4:7], s32 offen offset:2048 sc1 lds
    v_and_b32 v52, 3, v0
    v_lshlrev_b32 v53, 18, v52
    v_max_u32 v53, 131072, v53
    s_lshl_b32 s47, s2, 2
    s_add_u32 s47, s47, s77
    s_lshl_b32 s47, s47, 7
    buffer_load_dword v52, v53, s[56:59], s47 offen sc1
    s_waitcnt vmcnt(8)
    s_barrier
    ds_read_b64_tr_b16 v[128:129], v56 offset:0
    ds_read_b64_tr_b16 v[130:131], v56 offset:2048
    ds_read_b128 a[192:195], v54 offset:0
    ds_read_b128 a[196:199], v54 offset:1024
    ds_read_b128 a[200:203], v54 offset:2048
    ds_read_b64_tr_b16 v[132:133], v57 offset:0
    ds_read_b64_tr_b16 v[134:135], v57 offset:2048
    ds_read_b128 a[204:207], v54 offset:3072
    ds_read_b128 a[208:211], v54 offset:4096
    ds_read_b128 a[212:215], v54 offset:5120
    ds_read_b64_tr_b16 v[136:137], v56 offset:4096
    ds_read_b64_tr_b16 v[138:139], v56 offset:6144
    ds_read_b128 a[216:219], v54 offset:6144
    ds_read_b128 a[220:223], v54 offset:7168
    s_getpc_b64 s[52:53]
L_pc1:
    s_add_u32 s52, s52, L_g1_tail-L_pc1
    s_addc_u32 s53, s53, 0
    s_mov_b32 s54, L_code_end-L_g1_tail
    s_mov_b32 s55, 0x20000
    s_mov_b32 s46, 0xfffa0000
    s_mov_b32 s39, 7
.p2align 6
L_g1_loop:
    s_waitcnt lgkmcnt(11)
    v_mfma_f32_16x16x32_bf16 v[192:195], v[128:131], a[192:195], v[192:195]
    ds_read_b64_tr_b16 v[140:141], v57 offset:4096
    s_waitcnt lgkmcnt(11)
    v_mfma_f32_16x16x32_bf16 v[196:199], v[128:131], a[196:199], v[196:199]
    ds_read_b64_tr_b16 v[142:143], v57 offset:6144
    s_waitcnt lgkmcnt(11)
    v_mfma_f32_16x16x32_bf16 v[200:203], v[128:131], a[200:203], v[200:203]
    s_waitcnt lgkmcnt(8)
    v_mfma_f32_16x16x32_bf16 v[204:207], v[128:131], a[204:207], v[204:207]
    s_waitcnt lgkmcnt(7)
    v_mfma_f32_16x16x32_bf16 v[208:211], v[128:131], a[208:211], v[208:211]
    s_waitcnt lgkmcnt(6)
    v_mfma_f32_16x16x32_bf16 v[212:215], v[128:131], a[212:215], v[212:215]
    buffer_load_dwordx4 v60, s[4:7], s32 offen offset:3072 sc1 lds
    s_waitcnt lgkmcnt(3)
    v_mfma_f32_16x16x32_bf16 v[216:219], v[128:131], a[216:219], v[216:219]
    s_add_u32 s32, s32, 0x20000
    s_waitcnt lgkmcnt(2)
    v_mfma_f32_16x16x32_bf16 v[220:223], v[128:131], a[220:223], v[220:223]
    v_mfma_f32_16x16x32_bf16 v[252:255], v[132:135], a[220:223], v[252:255]
    ds_read_b64_tr_b16 v[144:145], v56 offset:8192
    v_mfma_f32_16x16x32_bf16 v[248:251], v[132:135], a[216:219], v[248:251]
    ds_read_b64_tr_b16 v[146:147], v56 offset:10240
    v_mfma_f32_16x16x32_bf16 v[244:247], v[132:135], a[212:215], v[244:247]
    v_mfma_f32_16x16x32_bf16 v[240:243], v[132:135], a[208:211], v[240:243]
    v_mfma_f32_16x16x32_bf16 v[236:239], v[132:135], a[204:207], v[236:239]
    s_add_u32 m0, s38, 110592
    v_mfma_f32_16x16x32_bf16 v[232:235], v[132:135], a[200:203], v[232:235]
    buffer_load_dwordx4 v61, s[8:11], s33 offen lds
    v_mfma_f32_16x16x32_bf16 v[228:231], v[132:135], a[196:199], v[228:231]
    v_mfma_f32_16x16x32_bf16 v[224:227], v[132:135], a[192:195], v[224:227]
    v_mfma_f32_16x16x32_bf16 v[64:67], v[136:139], a[192:195], v[64:67]
    ds_read_b64_tr_b16 v[128:129], v57 offset:8192
    v_mfma_f32_16x16x32_bf16 v[68:71], v[136:139], a[196:199], v[68:71]
    ds_read_b64_tr_b16 v[130:131], v57 offset:10240
    v_mfma_f32_16x16x32_bf16 v[72:75], v[136:139], a[200:203], v[72:75]
    v_mfma_f32_16x16x32_bf16 v[76:79], v[136:139], a[204:207], v[76:79]
    v_mfma_f32_16x16x32_bf16 v[80:83], v[136:139], a[208:211], v[80:83]
    s_add_u32 m0, s38, 114688
    v_mfma_f32_16x16x32_bf16 v[84:87], v[136:139], a[212:215], v[84:87]
    buffer_load_dwordx4 v61, s[12:15], s33 offen lds
    v_mfma_f32_16x16x32_bf16 v[88:91], v[136:139], a[216:219], v[88:91]
    s_add_u32 s33, s33, 229376
    v_mfma_f32_16x16x32_bf16 v[92:95], v[136:139], a[220:223], v[92:95]
    s_waitcnt lgkmcnt(4)
    v_mfma_f32_16x16x32_bf16 v[124:127], v[140:143], a[220:223], v[124:127]
    ds_read_b64_tr_b16 v[132:133], v56 offset:12288
    v_mfma_f32_16x16x32_bf16 v[120:123], v[140:143], a[216:219], v[120:123]
    ds_read_b64_tr_b16 v[134:135], v56 offset:14336
    v_mfma_f32_16x16x32_bf16 v[116:119], v[140:143], a[212:215], v[116:119]
    v_mfma_f32_16x16x32_bf16 v[112:115], v[140:143], a[208:211], v[112:115]
    v_mfma_f32_16x16x32_bf16 v[108:111], v[140:143], a[204:207], v[108:111]
    s_add_u32 m0, s38, 118784
    v_mfma_f32_16x16x32_bf16 v[104:107], v[140:143], a[200:203], v[104:107]
    buffer_load_dwordx4 v63, s[16:19], s35 offen lds
    v_mfma_f32_16x16x32_bf16 v[100:103], v[140:143], a[196:199], v[100:103]
    v_mfma_f32_16x16x32_bf16 v[96:99], v[140:143], a[192:195], v[96:99]
    s_waitcnt lgkmcnt(4)
    v_mfma_f32_16x16x32_bf16 a[0:3], v[144:147], a[192:195], a[0:3]
    ds_read_b64_tr_b16 v[136:137], v57 offset:12288
    v_mfma_f32_16x16x32_bf16 a[4:7], v[144:147], a[196:199], a[4:7]
    ds_read_b64_tr_b16 v[138:139], v57 offset:14336
    v_mfma_f32_16x16x32_bf16 a[8:11], v[144:147], a[200:203], a[8:11]
    v_mfma_f32_16x16x32_bf16 a[12:15], v[144:147], a[204:207], a[12:15]
    v_mfma_f32_16x16x32_bf16 a[16:19], v[144:147], a[208:211], a[16:19]
    s_add_u32 m0, s38, 122880
    v_mfma_f32_16x16x32_bf16 a[20:23], v[144:147], a[212:215], a[20:23]
    buffer_load_dwordx4 v63, s[20:23], s35 offen lds
    v_mfma_f32_16x16x32_bf16 a[24:27], v[144:147], a[216:219], a[24:27]
    s_add_u32 s35, s35, s36
    v_mfma_f32_16x16x32_bf16 a[28:31], v[144:147], a[220:223], a[28:31]
    s_waitcnt lgkmcnt(4)
    v_mfma_f32_16x16x32_bf16 a[60:63], v[128:131], a[220:223], a[60:63]
    ds_read_b64_tr_b16 v[140:141], v56 offset:16384
    v_mfma_f32_16x16x32_bf16 a[56:59], v[128:131], a[216:219], a[56:59]
    ds_read_b64_tr_b16 v[142:143], v56 offset:18432
    v_mfma_f32_16x16x32_bf16 a[52:55], v[128:131], a[212:215], a[52:55]
    v_mfma_f32_16x16x32_bf16 a[48:51], v[128:131], a[208:211], a[48:51]
    v_mfma_f32_16x16x32_bf16 a[44:47], v[128:131], a[204:207], a[44:47]
    s_add_u32 m0, s38, 126976
    v_mfma_f32_16x16x32_bf16 a[40:43], v[128:131], a[200:203], a[40:43]
    buffer_load_dwordx4 v62, s[24:27], s34 offen lds
    v_mfma_f32_16x16x32_bf16 a[36:39], v[128:131], a[196:199], a[36:39]
    s_add_u32 s34, s34, 196608
    v_mfma_f32_16x16x32_bf16 a[32:35], v[128:131], a[192:195], a[32:35]
    s_waitcnt lgkmcnt(4)
    v_mfma_f32_16x16x32_bf16 a[64:67], v[132:135], a[192:195], a[64:67]
    ds_read_b64_tr_b16 v[144:145], v57 offset:16384
    v_mfma_f32_16x16x32_bf16 a[68:71], v[132:135], a[196:199], a[68:71]
    ds_read_b64_tr_b16 v[146:147], v57 offset:18432
    v_mfma_f32_16x16x32_bf16 a[72:75], v[132:135], a[200:203], a[72:75]
    v_mfma_f32_16x16x32_bf16 a[76:79], v[132:135], a[204:207], a[76:79]
    buffer_load_dword v163, v18, s[48:51], s100 offen
    v_mfma_f32_16x16x32_bf16 a[80:83], v[132:135], a[208:211], a[80:83]
    s_add_u32 s100, s100, s3
    v_mfma_f32_16x16x32_bf16 a[84:87], v[132:135], a[212:215], a[84:87]
    v_mfma_f32_16x16x32_bf16 a[88:91], v[132:135], a[216:219], a[88:91]
    buffer_load_dword v163, v20, s[52:55], s46 offen
    v_mfma_f32_16x16x32_bf16 a[92:95], v[132:135], a[220:223], a[92:95]
    s_add_u32 s46, s46, 0x10000
    s_waitcnt vmcnt(20) lgkmcnt(0)
    s_barrier
    v_mfma_f32_16x16x32_bf16 a[124:127], v[136:139], a[220:223], a[124:127]
    ds_read_b64_tr_b16 v[128:129], v56 offset:36864
    v_mfma_f32_16x16x32_bf16 a[120:123], v[136:139], a[216:219], a[120:123]
    ds_read_b64_tr_b16 v[130:131], v56 offset:38912
    v_mfma_f32_16x16x32_bf16 a[116:119], v[136:139], a[212:215], a[116:119]
    ds_read_b128 a[224:227], v54 offset:36864
    v_mfma_f32_16x16x32_bf16 a[112:115], v[136:139], a[208:211], a[112:115]
    ds_read_b128 a[228:231], v54 offset:37888
    v_mfma_f32_16x16x32_bf16 a[108:111], v[136:139], a[204:207], a[108:111]
    ds_read_b128 a[232:235], v54 offset:38912
    s_add_u32 m0, s37, 0
    v_mfma_f32_16x16x32_bf16 a[104:107], v[136:139], a[200:203], a[104:107]
    buffer_load_dwordx4 v60, s[4:7], s32 offen sc1 lds
    v_mfma_f32_16x16x32_bf16 a[100:103], v[136:139], a[196:199], a[100:103]
    v_mfma_f32_16x16x32_bf16 a[96:99], v[136:139], a[192:195], a[96:99]
    v_mfma_f32_16x16x32_bf16 a[128:131], v[140:143], a[192:195], a[128:131]
    ds_read_b64_tr_b16 v[132:133], v57 offset:36864
    v_mfma_f32_16x16x32_bf16 a[132:135], v[140:143], a[196:199], a[132:135]
    ds_read_b64_tr_b16 v[134:135], v57 offset:38912
    v_mfma_f32_16x16x32_bf16 a[136:139], v[140:143], a[200:203], a[136:139]
    ds_read_b128 a[236:239], v54 offset:39936
    v_mfma_f32_16x16x32_bf16 a[140:143], v[140:143], a[204:207], a[140:143]
    ds_read_b128 a[240:243], v54 offset:40960
    v_mfma_f32_16x16x32_bf16 a[144:147], v[140:143], a[208:211], a[144:147]
    ds_read_b128 a[244:247], v54 offset:41984
    v_mfma_f32_16x16x32_bf16 a[148:151], v[140:143], a[212:215], a[148:151]
    buffer_load_dwordx4 v60, s[4:7], s32 offen offset:1024 sc1 lds
    v_mfma_f32_16x16x32_bf16 a[152:155], v[140:143], a[216:219], a[152:155]
    v_mfma_f32_16x16x32_bf16 a[156:159], v[140:143], a[220:223], a[156:159]
    v_mfma_f32_16x16x32_bf16 a[188:191], v[144:147], a[220:223], a[188:191]
    ds_read_b64_tr_b16 v[136:137], v56 offset:40960
    v_mfma_f32_16x16x32_bf16 a[184:187], v[144:147], a[216:219], a[184:187]
    ds_read_b64_tr_b16 v[138:139], v56 offset:43008
    v_mfma_f32_16x16x32_bf16 a[180:183], v[144:147], a[212:215], a[180:183]
    ds_read_b128 a[248:251], v54 offset:43008
    v_mfma_f32_16x16x32_bf16 a[176:179], v[144:147], a[208:211], a[176:179]
    ds_read_b128 a[252:255], v54 offset:44032
    v_mfma_f32_16x16x32_bf16 a[172:175], v[144:147], a[204:207], a[172:175]
    v_mfma_f32_16x16x32_bf16 a[168:171], v[144:147], a[200:203], a[168:171]
    buffer_load_dwordx4 v60, s[4:7], s32 offen offset:2048 sc1 lds
    v_mfma_f32_16x16x32_bf16 a[164:167], v[144:147], a[196:199], a[164:167]
    v_mfma_f32_16x16x32_bf16 a[160:163], v[144:147], a[192:195], a[160:163]
    s_waitcnt lgkmcnt(11)
    v_mfma_f32_16x16x32_bf16 v[192:195], v[128:131], a[224:227], v[192:195]
    ds_read_b64_tr_b16 v[140:141], v57 offset:40960
    s_waitcnt lgkmcnt(11)
    v_mfma_f32_16x16x32_bf16 v[196:199], v[128:131], a[228:231], v[196:199]
    ds_read_b64_tr_b16 v[142:143], v57 offset:43008
    s_waitcnt lgkmcnt(11)
    v_mfma_f32_16x16x32_bf16 v[200:203], v[128:131], a[232:235], v[200:203]
    s_waitcnt lgkmcnt(8)
    v_mfma_f32_16x16x32_bf16 v[204:207], v[128:131], a[236:239], v[204:207]
    s_waitcnt lgkmcnt(7)
    v_mfma_f32_16x16x32_bf16 v[208:211], v[128:131], a[240:243], v[208:211]
    s_waitcnt lgkmcnt(6)
    v_mfma_f32_16x16x32_bf16 v[212:215], v[128:131], a[244:247], v[212:215]
    buffer_load_dwordx4 v60, s[4:7], s32 offen offset:3072 sc1 lds
    s_waitcnt lgkmcnt(3)
    v_mfma_f32_16x16x32_bf16 v[216:219], v[128:131], a[248:251], v[216:219]
    s_add_u32 s32, s32, 0x20000
    s_waitcnt lgkmcnt(2)
    v_mfma_f32_16x16x32_bf16 v[220:223], v[128:131], a[252:255], v[220:223]
    v_mfma_f32_16x16x32_bf16 v[252:255], v[132:135], a[252:255], v[252:255]
    ds_read_b64_tr_b16 v[144:145], v56 offset:45056
    v_mfma_f32_16x16x32_bf16 v[248:251], v[132:135], a[248:251], v[248:251]
    ds_read_b64_tr_b16 v[146:147], v56 offset:47104
    v_mfma_f32_16x16x32_bf16 v[244:247], v[132:135], a[244:247], v[244:247]
    v_mfma_f32_16x16x32_bf16 v[240:243], v[132:135], a[240:243], v[240:243]
    v_mfma_f32_16x16x32_bf16 v[236:239], v[132:135], a[236:239], v[236:239]
    s_add_u32 m0, s38, 0
    v_mfma_f32_16x16x32_bf16 v[232:235], v[132:135], a[232:235], v[232:235]
    buffer_load_dwordx4 v61, s[8:11], s33 offen lds
    v_mfma_f32_16x16x32_bf16 v[228:231], v[132:135], a[228:231], v[228:231]
    v_mfma_f32_16x16x32_bf16 v[224:227], v[132:135], a[224:227], v[224:227]
    v_mfma_f32_16x16x32_bf16 v[64:67], v[136:139], a[224:227], v[64:67]
    ds_read_b64_tr_b16 v[128:129], v57 offset:45056
    v_mfma_f32_16x16x32_bf16 v[68:71], v[136:139], a[228:231], v[68:71]
    ds_read_b64_tr_b16 v[130:131], v57 offset:47104
    v_mfma_f32_16x16x32_bf16 v[72:75], v[136:139], a[232:235], v[72:75]
    v_mfma_f32_16x16x32_bf16 v[76:79], v[136:139], a[236:239], v[76:79]
    v_mfma_f32_16x16x32_bf16 v[80:83], v[136:139], a[240:243], v[80:83]
    s_add_u32 m0, s38, 4096
    v_mfma_f32_16x16x32_bf16 v[84:87], v[136:139], a[244:247], v[84:87]
    buffer_load_dwordx4 v61, s[12:15], s33 offen lds
    v_mfma_f32_16x16x32_bf16 v[88:91], v[136:139], a[248:251], v[88:91]
    s_add_u32 s33, s33, 229376
    v_mfma_f32_16x16x32_bf16 v[92:95], v[136:139], a[252:255], v[92:95]
    s_waitcnt lgkmcnt(4)
    v_mfma_f32_16x16x32_bf16 v[124:127], v[140:143], a[252:255], v[124:127]
    ds_read_b64_tr_b16 v[132:133], v56 offset:49152
    v_mfma_f32_16x16x32_bf16 v[120:123], v[140:143], a[248:251], v[120:123]
    ds_read_b64_tr_b16 v[134:135], v56 offset:51200
    v_mfma_f32_16x16x32_bf16 v[116:119], v[140:143], a[244:247], v[116:119]
    v_mfma_f32_16x16x32_bf16 v[112:115], v[140:143], a[240:243], v[112:115]
    v_mfma_f32_16x16x32_bf16 v[108:111], v[140:143], a[236:239], v[108:111]
    s_add_u32 m0, s38, 8192
    v_mfma_f32_16x16x32_bf16 v[104:107], v[140:143], a[232:235], v[104:107]
    buffer_load_dwordx4 v63, s[16:19], s35 offen lds
    v_mfma_f32_16x16x32_bf16 v[100:103], v[140:143], a[228:231], v[100:103]
    v_mfma_f32_16x16x32_bf16 v[96:99], v[140:143], a[224:227], v[96:99]
    s_waitcnt lgkmcnt(4)
    v_mfma_f32_16x16x32_bf16 a[0:3], v[144:147], a[224:227], a[0:3]
    ds_read_b64_tr_b16 v[136:137], v57 offset:49152
    v_mfma_f32_16x16x32_bf16 a[4:7], v[144:147], a[228:231], a[4:7]
    ds_read_b64_tr_b16 v[138:139], v57 offset:51200
    v_mfma_f32_16x16x32_bf16 a[8:11], v[144:147], a[232:235], a[8:11]
    v_mfma_f32_16x16x32_bf16 a[12:15], v[144:147], a[236:239], a[12:15]
    v_mfma_f32_16x16x32_bf16 a[16:19], v[144:147], a[240:243], a[16:19]
    s_add_u32 m0, s38, 12288
    v_mfma_f32_16x16x32_bf16 a[20:23], v[144:147], a[244:247], a[20:23]
    buffer_load_dwordx4 v63, s[20:23], s35 offen lds
    v_mfma_f32_16x16x32_bf16 a[24:27], v[144:147], a[248:251], a[24:27]
    s_add_u32 s35, s35, s36
    v_mfma_f32_16x16x32_bf16 a[28:31], v[144:147], a[252:255], a[28:31]
    s_waitcnt lgkmcnt(4)
    v_mfma_f32_16x16x32_bf16 a[60:63], v[128:131], a[252:255], a[60:63]
    ds_read_b64_tr_b16 v[140:141], v56 offset:53248
    v_mfma_f32_16x16x32_bf16 a[56:59], v[128:131], a[248:251], a[56:59]
    ds_read_b64_tr_b16 v[142:143], v56 offset:55296
    v_mfma_f32_16x16x32_bf16 a[52:55], v[128:131], a[244:247], a[52:55]
    v_mfma_f32_16x16x32_bf16 a[48:51], v[128:131], a[240:243], a[48:51]
    v_mfma_f32_16x16x32_bf16 a[44:47], v[128:131], a[236:239], a[44:47]
    s_add_u32 m0, s38, 16384
    v_mfma_f32_16x16x32_bf16 a[40:43], v[128:131], a[232:235], a[40:43]
    buffer_load_dwordx4 v62, s[24:27], s34 offen lds
    v_mfma_f32_16x16x32_bf16 a[36:39], v[128:131], a[228:231], a[36:39]
    s_add_u32 s34, s34, 196608
    v_mfma_f32_16x16x32_bf16 a[32:35], v[128:131], a[224:227], a[32:35]
    s_waitcnt lgkmcnt(4)
    v_mfma_f32_16x16x32_bf16 a[64:67], v[132:135], a[224:227], a[64:67]
    ds_read_b64_tr_b16 v[144:145], v57 offset:53248
    v_mfma_f32_16x16x32_bf16 a[68:71], v[132:135], a[228:231], a[68:71]
    ds_read_b64_tr_b16 v[146:147], v57 offset:55296
    v_mfma_f32_16x16x32_bf16 a[72:75], v[132:135], a[232:235], a[72:75]
    v_mfma_f32_16x16x32_bf16 a[76:79], v[132:135], a[236:239], a[76:79]
    v_mfma_f32_16x16x32_bf16 a[80:83], v[132:135], a[240:243], a[80:83]
    v_mfma_f32_16x16x32_bf16 a[84:87], v[132:135], a[244:247], a[84:87]
    buffer_load_dword v163, v18, s[48:51], s100 offen
    v_mfma_f32_16x16x32_bf16 a[88:91], v[132:135], a[248:251], a[88:91]
    s_add_u32 s100, s100, s3
    v_mfma_f32_16x16x32_bf16 a[92:95], v[132:135], a[252:255], a[92:95]
    s_waitcnt vmcnt(21) lgkmcnt(0)
    s_barrier
    v_mfma_f32_16x16x32_bf16 a[124:127], v[136:139], a[252:255], a[124:127]
    ds_read_b64_tr_b16 v[128:129], v58 offset:0
    v_mfma_f32_16x16x32_bf16 a[120:123], v[136:139], a[248:251], a[120:123]
    ds_read_b64_tr_b16 v[130:131], v58 offset:2048
    v_mfma_f32_16x16x32_bf16 a[116:119], v[136:139], a[244:247], a[116:119]
    ds_read_b128 a[192:195], v55 offset:0
    v_mfma_f32_16x16x32_bf16 a[112:115], v[136:139], a[240:243], a[112:115]
    ds_read_b128 a[196:199], v55 offset:1024
    v_mfma_f32_16x16x32_bf16 a[108:111], v[136:139], a[236:239], a[108:111]
    ds_read_b128 a[200:203], v55 offset:2048
    s_add_u32 m0, s37, 36864
    v_mfma_f32_16x16x32_bf16 a[104:107], v[136:139], a[232:235], a[104:107]
    buffer_load_dwordx4 v60, s[4:7], s32 offen sc1 lds
    v_mfma_f32_16x16x32_bf16 a[100:103], v[136:139], a[228:231], a[100:103]
    v_mfma_f32_16x16x32_bf16 a[96:99], v[136:139], a[224:227], a[96:99]
    v_mfma_f32_16x16x32_bf16 a[128:131], v[140:143], a[224:227], a[128:131]
    ds_read_b64_tr_b16 v[132:133], v59 offset:0
    v_mfma_f32_16x16x32_bf16 a[132:135], v[140:143], a[228:231], a[132:135]
    ds_read_b64_tr_b16 v[134:135], v59 offset:2048
    v_mfma_f32_16x16x32_bf16 a[136:139], v[140:143], a[232:235], a[136:139]
    ds_read_b128 a[204:207], v55 offset:3072
    v_mfma_f32_16x16x32_bf16 a[140:143], v[140:143], a[236:239], a[140:143]
    ds_read_b128 a[208:211], v55 offset:4096
    v_mfma_f32_16x16x32_bf16 a[144:147], v[140:143], a[240:243], a[144:147]
    ds_read_b128 a[212:215], v55 offset:5120
    v_mfma_f32_16x16x32_bf16 a[148:151], v[140:143], a[244:247], a[148:151]
    buffer_load_dwordx4 v60, s[4:7], s32 offen offset:1024 sc1 lds
    v_mfma_f32_16x16x32_bf16 a[152:155], v[140:143], a[248:251], a[152:155]
    v_mfma_f32_16x16x32_bf16 a[156:159], v[140:143], a[252:255], a[156:159]
    v_mfma_f32_16x16x32_bf16 a[188:191], v[144:147], a[252:255], a[188:191]
    ds_read_b64_tr_b16 v[136:137], v58 offset:4096
    v_mfma_f32_16x16x32_bf16 a[184:187], v[144:147], a[248:251], a[184:187]
    ds_read_b64_tr_b16 v[138:139], v58 offset:6144
    v_mfma_f32_16x16x32_bf16 a[180:183], v[144:147], a[244:247], a[180:183]
    ds_read_b128 a[216:219], v55 offset:6144
    v_mfma_f32_16x16x32_bf16 a[176:179], v[144:147], a[240:243], a[176:179]
    ds_read_b128 a[220:223], v55 offset:7168
    v_mfma_f32_16x16x32_bf16 a[172:175], v[144:147], a[236:239], a[172:175]
    v_mfma_f32_16x16x32_bf16 a[168:171], v[144:147], a[232:235], a[168:171]
    buffer_load_dwordx4 v60, s[4:7], s32 offen offset:2048 sc1 lds
    v_mfma_f32_16x16x32_bf16 a[164:167], v[144:147], a[228:231], a[164:167]
    v_mfma_f32_16x16x32_bf16 a[160:163], v[144:147], a[224:227], a[160:163]
    s_waitcnt lgkmcnt(11)
    v_mfma_f32_16x16x32_bf16 v[192:195], v[128:131], a[192:195], v[192:195]
    ds_read_b64_tr_b16 v[140:141], v59 offset:4096
    s_waitcnt lgkmcnt(11)
    v_mfma_f32_16x16x32_bf16 v[196:199], v[128:131], a[196:199], v[196:199]
    ds_read_b64_tr_b16 v[142:143], v59 offset:6144
    s_waitcnt lgkmcnt(11)
    v_mfma_f32_16x16x32_bf16 v[200:203], v[128:131], a[200:203], v[200:203]
    s_waitcnt lgkmcnt(8)
    v_mfma_f32_16x16x32_bf16 v[204:207], v[128:131], a[204:207], v[204:207]
    s_waitcnt lgkmcnt(7)
    v_mfma_f32_16x16x32_bf16 v[208:211], v[128:131], a[208:211], v[208:211]
    s_waitcnt lgkmcnt(6)
    v_mfma_f32_16x16x32_bf16 v[212:215], v[128:131], a[212:215], v[212:215]
    buffer_load_dwordx4 v60, s[4:7], s32 offen offset:3072 sc1 lds
    s_waitcnt lgkmcnt(3)
    v_mfma_f32_16x16x32_bf16 v[216:219], v[128:131], a[216:219], v[216:219]
    s_add_u32 s32, s32, 0x20000
    s_waitcnt lgkmcnt(2)
    v_mfma_f32_16x16x32_bf16 v[220:223], v[128:131], a[220:223], v[220:223]
    v_mfma_f32_16x16x32_bf16 v[252:255], v[132:135], a[220:223], v[252:255]
    ds_read_b64_tr_b16 v[144:145], v58 offset:8192
    v_mfma_f32_16x16x32_bf16 v[248:251], v[132:135], a[216:219], v[248:251]
    ds_read_b64_tr_b16 v[146:147], v58 offset:10240
    v_mfma_f32_16x16x32_bf16 v[244:247], v[132:135], a[212:215], v[244:247]
    v_mfma_f32_16x16x32_bf16 v[240:243], v[132:135], a[208:211], v[240:243]
    v_mfma_f32_16x16x32_bf16 v[236:239], v[132:135], a[204:207], v[236:239]
    s_add_u32 m0, s38, 36864
    v_mfma_f32_16x16x32_bf16 v[232:235], v[132:135], a[200:203], v[232:235]
    buffer_load_dwordx4 v61, s[8:11], s33 offen lds
    v_mfma_f32_16x16x32_bf16 v[228:231], v[132:135], a[196:199], v[228:231]
    v_mfma_f32_16x16x32_bf16 v[224:227], v[132:135], a[192:195], v[224:227]
    v_mfma_f32_16x16x32_bf16 v[64:67], v[136:139], a[192:195], v[64:67]
    ds_read_b64_tr_b16 v[128:129], v59 offset:8192
    v_mfma_f32_16x16x32_bf16 v[68:71], v[136:139], a[196:199], v[68:71]
    ds_read_b64_tr_b16 v[130:131], v59 offset:10240
    v_mfma_f32_16x16x32_bf16 v[72:75], v[136:139], a[200:203], v[72:75]
    v_mfma_f32_16x16x32_bf16 v[76:79], v[136:139], a[204:207], v[76:79]
    v_mfma_f32_16x16x32_bf16 v[80:83], v[136:139], a[208:211], v[80:83]
    s_add_u32 m0, s38, 40960
    v_mfma_f32_16x16x32_bf16 v[84:87], v[136:139], a[212:215], v[84:87]
    buffer_load_dwordx4 v61, s[12:15], s33 offen lds
    v_mfma_f32_16x16x32_bf16 v[88:91], v[136:139], a[216:219], v[88:91]
    s_add_u32 s33, s33, 229376
    v_mfma_f32_16x16x32_bf16 v[92:95], v[136:139], a[220:223], v[92:95]
    s_waitcnt lgkmcnt(4)
    v_mfma_f32_16x16x32_bf16 v[124:127], v[140:143], a[220:223], v[124:127]
    ds_read_b64_tr_b16 v[132:133], v58 offset:12288
    v_mfma_f32_16x16x32_bf16 v[120:123], v[140:143], a[216:219], v[120:123]
    ds_read_b64_tr_b16 v[134:135], v58 offset:14336
    v_mfma_f32_16x16x32_bf16 v[116:119], v[140:143], a[212:215], v[116:119]
    v_mfma_f32_16x16x32_bf16 v[112:115], v[140:143], a[208:211], v[112:115]
    v_mfma_f32_16x16x32_bf16 v[108:111], v[140:143], a[204:207], v[108:111]
    s_add_u32 m0, s38, 45056
    v_mfma_f32_16x16x32_bf16 v[104:107], v[140:143], a[200:203], v[104:107]
    buffer_load_dwordx4 v63, s[16:19], s35 offen lds
    v_mfma_f32_16x16x32_bf16 v[100:103], v[140:143], a[196:199], v[100:103]
    v_mfma_f32_16x16x32_bf16 v[96:99], v[140:143], a[192:195], v[96:99]
    s_waitcnt lgkmcnt(4)
    v_mfma_f32_16x16x32_bf16 a[0:3], v[144:147], a[192:195], a[0:3]
    ds_read_b64_tr_b16 v[136:137], v59 offset:12288
    v_mfma_f32_16x16x32_bf16 a[4:7], v[144:147], a[196:199], a[4:7]
    ds_read_b64_tr_b16 v[138:139], v59 offset:14336
    v_mfma_f32_16x16x32_bf16 a[8:11], v[144:147], a[200:203], a[8:11]
    v_mfma_f32_16x16x32_bf16 a[12:15], v[144:147], a[204:207], a[12:15]
    v_mfma_f32_16x16x32_bf16 a[16:19], v[144:147], a[208:211], a[16:19]
    s_add_u32 m0, s38, 49152
    v_mfma_f32_16x16x32_bf16 a[20:23], v[144:147], a[212:215], a[20:23]
    buffer_load_dwordx4 v63, s[20:23], s35 offen lds
    v_mfma_f32_16x16x32_bf16 a[24:27], v[144:147], a[216:219], a[24:27]
    s_add_u32 s35, s35, s36
    v_mfma_f32_16x16x32_bf16 a[28:31], v[144:147], a[220:223], a[28:31]
    s_waitcnt lgkmcnt(4)
    v_mfma_f32_16x16x32_bf16 a[60:63], v[128:131], a[220:223], a[60:63]
    ds_read_b64_tr_b16 v[140:141], v58 offset:16384
    v_mfma_f32_16x16x32_bf16 a[56:59], v[128:131], a[216:219], a[56:59]
    ds_read_b64_tr_b16 v[142:143], v58 offset:18432
    v_mfma_f32_16x16x32_bf16 a[52:55], v[128:131], a[212:215], a[52:55]
    v_mfma_f32_16x16x32_bf16 a[48:51], v[128:131], a[208:211], a[48:51]
    v_mfma_f32_16x16x32_bf16 a[44:47], v[128:131], a[204:207], a[44:47]
    s_add_u32 m0, s38, 53248
    v_mfma_f32_16x16x32_bf16 a[40:43], v[128:131], a[200:203], a[40:43]
    buffer_load_dwordx4 v62, s[24:27], s34 offen lds
    v_mfma_f32_16x16x32_bf16 a[36:39], v[128:131], a[196:199], a[36:39]
    s_add_u32 s34, s34, 196608
    v_mfma_f32_16x16x32_bf16 a[32:35], v[128:131], a[192:195], a[32:35]
    s_waitcnt lgkmcnt(4)
    v_mfma_f32_16x16x32_bf16 a[64:67], v[132:135], a[192:195], a[64:67]
    ds_read_b64_tr_b16 v[144:145], v59 offset:16384
    v_mfma_f32_16x16x32_bf16 a[68:71], v[132:135], a[196:199], a[68:71]
    ds_read_b64_tr_b16 v[146:147], v59 offset:18432
    v_mfma_f32_16x16x32_bf16 a[72:75], v[132:135], a[200:203], a[72:75]
    v_mfma_f32_16x16x32_bf16 a[76:79], v[132:135], a[204:207], a[76:79]
    v_mfma_f32_16x16x32_bf16 a[80:83], v[132:135], a[208:211], a[80:83]
    v_mfma_f32_16x16x32_bf16 a[84:87], v[132:135], a[212:215], a[84:87]
    buffer_load_dword v163, v18, s[48:51], s100 offen
    v_mfma_f32_16x16x32_bf16 a[88:91], v[132:135], a[216:219], a[88:91]
    s_add_u32 s100, s100, s3
    v_mfma_f32_16x16x32_bf16 a[92:95], v[132:135], a[220:223], a[92:95]
    s_waitcnt vmcnt(22) lgkmcnt(0)
    s_barrier
    v_mfma_f32_16x16x32_bf16 a[124:127], v[136:139], a[220:223], a[124:127]
    ds_read_b64_tr_b16 v[128:129], v58 offset:36864
    v_mfma_f32_16x16x32_bf16 a[120:123], v[136:139], a[216:219], a[120:123]
    ds_read_b64_tr_b16 v[130:131], v58 offset:38912
    v_mfma_f32_16x16x32_bf16 a[116:119], v[136:139], a[212:215], a[116:119]
    ds_read_b128 a[224:227], v55 offset:36864
    v_mfma_f32_16x16x32_bf16 a[112:115], v[136:139], a[208:211], a[112:115]
    ds_read_b128 a[228:231], v55 offset:37888
    v_mfma_f32_16x16x32_bf16 a[108:111], v[136:139], a[204:207], a[108:111]
    ds_read_b128 a[232:235], v55 offset:38912
    s_add_u32 m0, s37, 73728
    v_mfma_f32_16x16x32_bf16 a[104:107], v[136:139], a[200:203], a[104:107]
    buffer_load_dwordx4 v60, s[4:7], s32 offen sc1 lds
    v_mfma_f32_16x16x32_bf16 a[100:103], v[136:139], a[196:199], a[100:103]
    v_mfma_f32_16x16x32_bf16 a[96:99], v[136:139], a[192:195], a[96:99]
    v_mfma_f32_16x16x32_bf16 a[128:131], v[140:143], a[192:195], a[128:131]
    ds_read_b64_tr_b16 v[132:133], v59 offset:36864
    v_mfma_f32_16x16x32_bf16 a[132:135], v[140:143], a[196:199], a[132:135]
    ds_read_b64_tr_b16 v[134:135], v59 offset:38912
    v_mfma_f32_16x16x32_bf16 a[136:139], v[140:143], a[200:203], a[136:139]
    ds_read_b128 a[236:239], v55 offset:39936
    v_mfma_f32_16x16x32_bf16 a[140:143], v[140:143], a[204:207], a[140:143]
    ds_read_b128 a[240:243], v55 offset:40960
    v_mfma_f32_16x16x32_bf16 a[144:147], v[140:143], a[208:211], a[144:147]
    ds_read_b128 a[244:247], v55 offset:41984
    v_mfma_f32_16x16x32_bf16 a[148:151], v[140:143], a[212:215], a[148:151]
    buffer_load_dwordx4 v60, s[4:7], s32 offen offset:1024 sc1 lds
    v_mfma_f32_16x16x32_bf16 a[152:155], v[140:143], a[216:219], a[152:155]
    v_mfma_f32_16x16x32_bf16 a[156:159], v[140:143], a[220:223], a[156:159]
    v_mfma_f32_16x16x32_bf16 a[188:191], v[144:147], a[220:223], a[188:191]
    ds_read_b64_tr_b16 v[136:137], v58 offset:40960
    v_mfma_f32_16x16x32_bf16 a[184:187], v[144:147], a[216:219], a[184:187]
    ds_read_b64_tr_b16 v[138:139], v58 offset:43008
    v_mfma_f32_16x16x32_bf16 a[180:183], v[144:147], a[212:215], a[180:183]
    ds_read_b128 a[248:251], v55 offset:43008
    v_mfma_f32_16x16x32_bf16 a[176:179], v[144:147], a[208:211], a[176:179]
    ds_read_b128 a[252:255], v55 offset:44032
    v_mfma_f32_16x16x32_bf16 a[172:175], v[144:147], a[204:207], a[172:175]
    v_mfma_f32_16x16x32_bf16 a[168:171], v[144:147], a[200:203], a[168:171]
    buffer_load_dwordx4 v60, s[4:7], s32 offen offset:2048 sc1 lds
    v_mfma_f32_16x16x32_bf16 a[164:167], v[144:147], a[196:199], a[164:167]
    v_mfma_f32_16x16x32_bf16 a[160:163], v[144:147], a[192:195], a[160:163]
    s_waitcnt lgkmcnt(11)
    v_mfma_f32_16x16x32_bf16 v[192:195], v[128:131], a[224:227], v[192:195]
    ds_read_b64_tr_b16 v[140:141], v59 offset:40960
    s_waitcnt lgkmcnt(11)
    v_mfma_f32_16x16x32_bf16 v[196:199], v[128:131], a[228:231], v[196:199]
    ds_read_b64_tr_b16 v[142:143], v59 offset:43008
    s_waitcnt lgkmcnt(11)
    v_mfma_f32_16x16x32_bf16 v[200:203], v[128:131], a[232:235], v[200:203]
    s_waitcnt lgkmcnt(8)
    v_mfma_f32_16x16x32_bf16 v[204:207], v[128:131], a[236:239], v[204:207]
    s_waitcnt lgkmcnt(7)
    v_mfma_f32_16x16x32_bf16 v[208:211], v[128:131], a[240:243], v[208:211]
    s_waitcnt lgkmcnt(6)
    v_mfma_f32_16x16x32_bf16 v[212:215], v[128:131], a[244:247], v[212:215]
    buffer_load_dwordx4 v60, s[4:7], s32 offen offset:3072 sc1 lds
    s_waitcnt lgkmcnt(3)
    v_mfma_f32_16x16x32_bf16 v[216:219], v[128:131], a[248:251], v[216:219]
    s_add_u32 s32, s32, 0x20000
    s_waitcnt lgkmcnt(2)
    v_mfma_f32_16x16x32_bf16 v[220:223], v[128:131], a[252:255], v[220:223]
    v_mfma_f32_16x16x32_bf16 v[252:255], v[132:135], a[252:255], v[252:255]
    ds_read_b64_tr_b16 v[144:145], v58 offset:45056
    v_mfma_f32_16x16x32_bf16 v[248:251], v[132:135], a[248:251], v[248:251]
    ds_read_b64_tr_b16 v[146:147], v58 offset:47104
    v_mfma_f32_16x16x32_bf16 v[244:247], v[132:135], a[244:247], v[244:247]
    v_mfma_f32_16x16x32_bf16 v[240:243], v[132:135], a[240:243], v[240:243]
    v_mfma_f32_16x16x32_bf16 v[236:239], v[132:135], a[236:239], v[236:239]
    s_add_u32 m0, s38, 73728
    v_mfma_f32_16x16x32_bf16 v[232:235], v[132:135], a[232:235], v[232:235]
    buffer_load_dwordx4 v61, s[8:11], s33 offen lds
    v_mfma_f32_16x16x32_bf16 v[228:231], v[132:135], a[228:231], v[228:231]
    v_mfma_f32_16x16x32_bf16 v[224:227], v[132:135], a[224:227], v[224:227]
    v_mfma_f32_16x16x32_bf16 v[64:67], v[136:139], a[224:227], v[64:67]
    ds_read_b64_tr_b16 v[128:129], v59 offset:45056
    v_mfma_f32_16x16x32_bf16 v[68:71], v[136:139], a[228:231], v[68:71]
    ds_read_b64_tr_b16 v[130:131], v59 offset:47104
    v_mfma_f32_16x16x32_bf16 v[72:75], v[136:139], a[232:235], v[72:75]
    v_mfma_f32_16x16x32_bf16 v[76:79], v[136:139], a[236:239], v[76:79]
    v_mfma_f32_16x16x32_bf16 v[80:83], v[136:139], a[240:243], v[80:83]
    s_add_u32 m0, s38, 77824
    v_mfma_f32_16x16x32_bf16 v[84:87], v[136:139], a[244:247], v[84:87]
    buffer_load_dwordx4 v61, s[12:15], s33 offen lds
    v_mfma_f32_16x16x32_bf16 v[88:91], v[136:139], a[248:251], v[88:91]
    s_add_u32 s33, s33, 229376
    v_mfma_f32_16x16x32_bf16 v[92:95], v[136:139], a[252:255], v[92:95]
    s_waitcnt lgkmcnt(4)
    v_mfma_f32_16x16x32_bf16 v[124:127], v[140:143], a[252:255], v[124:127]
    ds_read_b64_tr_b16 v[132:133], v58 offset:49152
    v_mfma_f32_16x16x32_bf16 v[120:123], v[140:143], a[248:251], v[120:123]
    ds_read_b64_tr_b16 v[134:135], v58 offset:51200
    v_mfma_f32_16x16x32_bf16 v[116:119], v[140:143], a[244:247], v[116:119]
    v_mfma_f32_16x16x32_bf16 v[112:115], v[140:143], a[240:243], v[112:115]
    v_mfma_f32_16x16x32_bf16 v[108:111], v[140:143], a[236:239], v[108:111]
    s_add_u32 m0, s38, 81920
    v_mfma_f32_16x16x32_bf16 v[104:107], v[140:143], a[232:235], v[104:107]
    buffer_load_dwordx4 v63, s[16:19], s35 offen lds
    v_mfma_f32_16x16x32_bf16 v[100:103], v[140:143], a[228:231], v[100:103]
    v_mfma_f32_16x16x32_bf16 v[96:99], v[140:143], a[224:227], v[96:99]
    s_waitcnt lgkmcnt(4)
    v_mfma_f32_16x16x32_bf16 a[0:3], v[144:147], a[224:227], a[0:3]
    ds_read_b64_tr_b16 v[136:137], v59 offset:49152
    v_mfma_f32_16x16x32_bf16 a[4:7], v[144:147], a[228:231], a[4:7]
    ds_read_b64_tr_b16 v[138:139], v59 offset:51200
    v_mfma_f32_16x16x32_bf16 a[8:11], v[144:147], a[232:235], a[8:11]
    v_mfma_f32_16x16x32_bf16 a[12:15], v[144:147], a[236:239], a[12:15]
    v_mfma_f32_16x16x32_bf16 a[16:19], v[144:147], a[240:243], a[16:19]
    s_add_u32 m0, s38, 86016
    v_mfma_f32_16x16x32_bf16 a[20:23], v[144:147], a[244:247], a[20:23]
    buffer_load_dwordx4 v63, s[20:23], s35 offen lds
    v_mfma_f32_16x16x32_bf16 a[24:27], v[144:147], a[248:251], a[24:27]
    s_add_u32 s35, s35, s36
    v_mfma_f32_16x16x32_bf16 a[28:31], v[144:147], a[252:255], a[28:31]
    s_waitcnt lgkmcnt(4)
    v_mfma_f32_16x16x32_bf16 a[60:63], v[128:131], a[252:255], a[60:63]
    ds_read_b64_tr_b16 v[140:141], v58 offset:53248
    v_mfma_f32_16x16x32_bf16 a[56:59], v[128:131], a[248:251], a[56:59]
    ds_read_b64_tr_b16 v[142:143], v58 offset:55296
    v_mfma_f32_16x16x32_bf16 a[52:55], v[128:131], a[244:247], a[52:55]
    v_mfma_f32_16x16x32_bf16 a[48:51], v[128:131], a[240:243], a[48:51]
    v_mfma_f32_16x16x32_bf16 a[44:47], v[128:131], a[236:239], a[44:47]
    s_add_u32 m0, s38, 90112
    v_mfma_f32_16x16x32_bf16 a[40:43], v[128:131], a[232:235], a[40:43]
    buffer_load_dwordx4 v62, s[24:27], s34 offen lds
    v_mfma_f32_16x16x32_bf16 a[36:39], v[128:131], a[228:231], a[36:39]
    s_add_u32 s34, s34, 196608
    v_mfma_f32_16x16x32_bf16 a[32:35], v[128:131], a[224:227], a[32:35]
    s_waitcnt lgkmcnt(4)
    v_mfma_f32_16x16x32_bf16 a[64:67], v[132:135], a[224:227], a[64:67]
    ds_read_b64_tr_b16 v[144:145], v59 offset:53248
    v_mfma_f32_16x16x32_bf16 a[68:71], v[132:135], a[228:231], a[68:71]
    ds_read_b64_tr_b16 v[146:147], v59 offset:55296
    v_mfma_f32_16x16x32_bf16 a[72:75], v[132:135], a[232:235], a[72:75]
    v_mfma_f32_16x16x32_bf16 a[76:79], v[132:135], a[236:239], a[76:79]
    v_mfma_f32_16x16x32_bf16 a[80:83], v[132:135], a[240:243], a[80:83]
    v_mfma_f32_16x16x32_bf16 a[84:87], v[132:135], a[244:247], a[84:87]
    buffer_load_dword v163, v18, s[48:51], s100 offen
    v_mfma_f32_16x16x32_bf16 a[88:91], v[132:135], a[248:251], a[88:91]
    s_add_u32 s100, s100, s3
    v_mfma_f32_16x16x32_bf16 a[92:95], v[132:135], a[252:255], a[92:95]
    s_waitcnt vmcnt(21) lgkmcnt(0)
    s_barrier
    v_mfma_f32_16x16x32_bf16 a[124:127], v[136:139], a[252:255], a[124:127]
    ds_read_b64_tr_b16 v[128:129], v56 offset:0
    v_mfma_f32_16x16x32_bf16 a[120:123], v[136:139], a[248:251], a[120:123]
    ds_read_b64_tr_b16 v[130:131], v56 offset:2048
    v_mfma_f32_16x16x32_bf16 a[116:119], v[136:139], a[244:247], a[116:119]
    ds_read_b128 a[192:195], v54 offset:0
    v_mfma_f32_16x16x32_bf16 a[112:115], v[136:139], a[240:243], a[112:115]
    ds_read_b128 a[196:199], v54 offset:1024
    v_mfma_f32_16x16x32_bf16 a[108:111], v[136:139], a[236:239], a[108:111]
    ds_read_b128 a[200:203], v54 offset:2048
    s_add_u32 m0, s37, 110592
    v_mfma_f32_16x16x32_bf16 a[104:107], v[136:139], a[232:235], a[104:107]
    buffer_load_dwordx4 v60, s[4:7], s32 offen sc1 lds
    v_mfma_f32_16x16x32_bf16 a[100:103], v[136:139], a[228:231], a[100:103]
    v_mfma_f32_16x16x32_bf16 a[96:99], v[136:139], a[224:227], a[96:99]
    v_mfma_f32_16x16x32_bf16 a[128:131], v[140:143], a[224:227], a[128:131]
    ds_read_b64_tr_b16 v[132:133], v57 offset:0
    v_mfma_f32_16x16x32_bf16 a[132:135], v[140:143], a[228:231], a[132:135]
    ds_read_b64_tr_b16 v[134:135], v57 offset:2048
    v_mfma_f32_16x16x32_bf16 a[136:139], v[140:143], a[232:235], a[136:139]
    ds_read_b128 a[204:207], v54 offset:3072
    v_mfma_f32_16x16x32_bf16 a[140:143], v[140:143], a[236:239], a[140:143]
    ds_read_b128 a[208:211], v54 offset:4096
    v_mfma_f32_16x16x32_bf16 a[144:147], v[140:143], a[240:243], a[144:147]
    ds_read_b128 a[212:215], v54 offset:5120
    v_mfma_f32_16x16x32_bf16 a[148:151], v[140:143], a[244:247], a[148:151]
    buffer_load_dwordx4 v60, s[4:7], s32 offen offset:1024 sc1 lds
    v_mfma_f32_16x16x32_bf16 a[152:155], v[140:143], a[248:251], a[152:155]
    v_mfma_f32_16x16x32_bf16 a[156:159], v[140:143], a[252:255], a[156:159]
    v_mfma_f32_16x16x32_bf16 a[188:191], v[144:147], a[252:255], a[188:191]
    ds_read_b64_tr_b16 v[136:137], v56 offset:4096
    v_mfma_f32_16x16x32_bf16 a[184:187], v[144:147], a[248:251], a[184:187]
    ds_read_b64_tr_b16 v[138:139], v56 offset:6144
    v_mfma_f32_16x16x32_bf16 a[180:183], v[144:147], a[244:247], a[180:183]
    ds_read_b128 a[216:219], v54 offset:6144
    v_mfma_f32_16x16x32_bf16 a[176:179], v[144:147], a[240:243], a[176:179]
    ds_read_b128 a[220:223], v54 offset:7168
    v_mfma_f32_16x16x32_bf16 a[172:175], v[144:147], a[236:239], a[172:175]
    v_mfma_f32_16x16x32_bf16 a[168:171], v[144:147], a[232:235], a[168:171]
    buffer_load_dwordx4 v60, s[4:7], s32 offen offset:2048 sc1 lds
    v_mfma_f32_16x16x32_bf16 a[164:167], v[144:147], a[228:231], a[164:167]
    v_mfma_f32_16x16x32_bf16 a[160:163], v[144:147], a[224:227], a[160:163]
    s_sub_u32 s39, s39, 1
    s_cmp_lg_u32 s39, 0
    s_cbranch_scc1 L_g1_loop
L_g1_tail:
    s_waitcnt lgkmcnt(11)
    v_mfma_f32_16x16x32_bf16 v[192:195], v[128:131], a[192:195], v[192:195]
    ds_read_b64_tr_b16 v[140:141], v57 offset:4096
    s_mov_b32 s48, s64
    s_waitcnt lgkmcnt(11)
    v_mfma_f32_16x16x32_bf16 v[196:199], v[128:131], a[196:199], v[196:199]
    ds_read_b64_tr_b16 v[142:143], v57 offset:6144
    s_mov_b32 s49, s65
    s_waitcnt lgkmcnt(11)
    v_mfma_f32_16x16x32_bf16 v[200:203], v[128:131], a[200:203], v[200:203]
    s_mov_b32 s50, 2097152
    s_mov_b32 s51, 0x20000
    s_waitcnt lgkmcnt(8)
    v_mfma_f32_16x16x32_bf16 v[204:207], v[128:131], a[204:207], v[204:207]
    s_lshl_b32 s100, s2, 2
    s_add_u32 s100, s100, s77
    s_waitcnt lgkmcnt(7)
    v_mfma_f32_16x16x32_bf16 v[208:211], v[128:131], a[208:211], v[208:211]
    s_lshl_b32 s100, s100, 11
    v_and_b32 v18, 15, v0
    s_waitcnt lgkmcnt(6)
    v_mfma_f32_16x16x32_bf16 v[212:215], v[128:131], a[212:215], v[212:215]
    buffer_load_dwordx4 v60, s[4:7], s32 offen offset:3072 sc1 lds
    v_lshlrev_b32 v18, 7, v18
    s_waitcnt lgkmcnt(3)
    v_mfma_f32_16x16x32_bf16 v[216:219], v[128:131], a[216:219], v[216:219]
    s_add_u32 s32, s32, 0x20000
    s_waitcnt lgkmcnt(2)
    v_mfma_f32_16x16x32_bf16 v[220:223], v[128:131], a[220:223], v[220:223]
    v_mfma_f32_16x16x32_bf16 v[252:255], v[132:135], a[220:223], v[252:255]
    ds_read_b64_tr_b16 v[144:145], v56 offset:8192
    v_mfma_f32_16x16x32_bf16 v[248:251], v[132:135], a[216:219], v[248:251]
    ds_read_b64_tr_b16 v[146:147], v56 offset:10240
    v_mfma_f32_16x16x32_bf16 v[244:247], v[132:135], a[212:215], v[244:247]
    v_mfma_f32_16x16x32_bf16 v[240:243], v[132:135], a[208:211], v[240:243]
    v_mfma_f32_16x16x32_bf16 v[236:239], v[132:135], a[204:207], v[236:239]
    s_add_u32 m0, s38, 110592
    v_mfma_f32_16x16x32_bf16 v[232:235], v[132:135], a[200:203], v[232:235]
    buffer_load_dwordx4 v61, s[8:11], s33 offen lds
    v_mfma_f32_16x16x32_bf16 v[228:231], v[132:135], a[196:199], v[228:231]
    v_mfma_f32_16x16x32_bf16 v[224:227], v[132:135], a[192:195], v[224:227]
    v_mfma_f32_16x16x32_bf16 v[64:67], v[136:139], a[192:195], v[64:67]
    ds_read_b64_tr_b16 v[128:129], v57 offset:8192
    v_mfma_f32_16x16x32_bf16 v[68:71], v[136:139], a[196:199], v[68:71]
    ds_read_b64_tr_b16 v[130:131], v57 offset:10240
    v_mfma_f32_16x16x32_bf16 v[72:75], v[136:139], a[200:203], v[72:75]
    v_mfma_f32_16x16x32_bf16 v[76:79], v[136:139], a[204:207], v[76:79]
    v_mfma_f32_16x16x32_bf16 v[80:83], v[136:139], a[208:211], v[80:83]
    s_add_u32 m0, s38, 114688
    v_mfma_f32_16x16x32_bf16 v[84:87], v[136:139], a[212:215], v[84:87]
    buffer_load_dwordx4 v61, s[12:15], s33 offen lds
    v_mfma_f32_16x16x32_bf16 v[88:91], v[136:139], a[216:219], v[88:91]
    s_add_u32 s33, s33, 229376
    v_mfma_f32_16x16x32_bf16 v[92:95], v[136:139], a[220:223], v[92:95]
    s_waitcnt lgkmcnt(4)
    v_mfma_f32_16x16x32_bf16 v[124:127], v[140:143], a[220:223], v[124:127]
    ds_read_b64_tr_b16 v[132:133], v56 offset:12288
    v_mfma_f32_16x16x32_bf16 v[120:123], v[140:143], a[216:219], v[120:123]
    ds_read_b64_tr_b16 v[134:135], v56 offset:14336
    v_mfma_f32_16x16x32_bf16 v[116:119], v[140:143], a[212:215], v[116:119]
    v_mfma_f32_16x16x32_bf16 v[112:115], v[140:143], a[208:211], v[112:115]
    v_mfma_f32_16x16x32_bf16 v[108:111], v[140:143], a[204:207], v[108:111]
    s_add_u32 m0, s38, 118784
    v_mfma_f32_16x16x32_bf16 v[104:107], v[140:143], a[200:203], v[104:107]
    buffer_load_dwordx4 v63, s[16:19], s35 offen lds
    v_mfma_f32_16x16x32_bf16 v[100:103], v[140:143], a[196:199], v[100:103]
    v_mfma_f32_16x16x32_bf16 v[96:99], v[140:143], a[192:195], v[96:99]
    s_waitcnt lgkmcnt(4)
    v_mfma_f32_16x16x32_bf16 a[0:3], v[144:147], a[192:195], a[0:3]
    ds_read_b64_tr_b16 v[136:137], v57 offset:12288
    v_mfma_f32_16x16x32_bf16 a[4:7], v[144:147], a[196:199], a[4:7]
    ds_read_b64_tr_b16 v[138:139], v57 offset:14336
    v_mfma_f32_16x16x32_bf16 a[8:11], v[144:147], a[200:203], a[8:11]
    v_mfma_f32_16x16x32_bf16 a[12:15], v[144:147], a[204:207], a[12:15]
    v_mfma_f32_16x16x32_bf16 a[16:19], v[144:147], a[208:211], a[16:19]
    s_add_u32 m0, s38, 122880
    v_mfma_f32_16x16x32_bf16 a[20:23], v[144:147], a[212:215], a[20:23]
    buffer_load_dwordx4 v63, s[20:23], s35 offen lds
    v_mfma_f32_16x16x32_bf16 a[24:27], v[144:147], a[216:219], a[24:27]
    s_add_u32 s35, s35, s36
    v_mfma_f32_16x16x32_bf16 a[28:31], v[144:147], a[220:223], a[28:31]
    s_waitcnt lgkmcnt(4)
    v_mfma_f32_16x16x32_bf16 a[60:63], v[128:131], a[220:223], a[60:63]
    ds_read_b64_tr_b16 v[140:141], v56 offset:16384
    v_mfma_f32_16x16x32_bf16 a[56:59], v[128:131], a[216:219], a[56:59]
    ds_read_b64_tr_b16 v[142:143], v56 offset:18432
    v_mfma_f32_16x16x32_bf16 a[52:55], v[128:131], a[212:215], a[52:55]
    v_mfma_f32_16x16x32_bf16 a[48:51], v[128:131], a[208:211], a[48:51]
    v_mfma_f32_16x16x32_bf16 a[44:47], v[128:131], a[204:207], a[44:47]
    s_add_u32 m0, s38, 126976
    v_mfma_f32_16x16x32_bf16 a[40:43], v[128:131], a[200:203], a[40:43]
    buffer_load_dwordx4 v62, s[24:27], s34 offen lds
    v_mfma_f32_16x16x32_bf16 a[36:39], v[128:131], a[196:199], a[36:39]
    s_add_u32 s34, s34, 196608
    v_mfma_f32_16x16x32_bf16 a[32:35], v[128:131], a[192:195], a[32:35]
    s_waitcnt lgkmcnt(4)
    v_mfma_f32_16x16x32_bf16 a[64:67], v[132:135], a[192:195], a[64:67]
    ds_read_b64_tr_b16 v[144:145], v57 offset:16384
    v_mfma_f32_16x16x32_bf16 a[68:71], v[132:135], a[196:199], a[68:71]
    ds_read_b64_tr_b16 v[146:147], v57 offset:18432
    v_mfma_f32_16x16x32_bf16 a[72:75], v[132:135], a[200:203], a[72:75]
    v_mfma_f32_16x16x32_bf16 a[76:79], v[132:135], a[204:207], a[76:79]
    v_mfma_f32_16x16x32_bf16 a[80:83], v[132:135], a[208:211], a[80:83]
    v_mfma_f32_16x16x32_bf16 a[84:87], v[132:135], a[212:215], a[84:87]
    buffer_load_dword v163, v18, s[48:51], s100 offen
    v_mfma_f32_16x16x32_bf16 a[88:91], v[132:135], a[216:219], a[88:91]
    v_mfma_f32_16x16x32_bf16 a[92:95], v[132:135], a[220:223], a[92:95]
    s_waitcnt vmcnt(19) lgkmcnt(0)
    s_barrier
    v_mfma_f32_16x16x32_bf16 a[124:127], v[136:139], a[220:223], a[124:127]
    ds_read_b64_tr_b16 v[128:129], v56 offset:36864
    v_mfma_f32_16x16x32_bf16 a[120:123], v[136:139], a[216:219], a[120:123]
    ds_read_b64_tr_b16 v[130:131], v56 offset:38912
    v_mfma_f32_16x16x32_bf16 a[116:119], v[136:139], a[212:215], a[116:119]
    ds_read_b128 a[224:227], v54 offset:36864
    v_mfma_f32_16x16x32_bf16 a[112:115], v[136:139], a[208:211], a[112:115]
    ds_read_b128 a[228:231], v54 offset:37888
    v_mfma_f32_16x16x32_bf16 a[108:111], v[136:139], a[204:207], a[108:111]
    ds_read_b128 a[232:235], v54 offset:38912
    v_mfma_f32_16x16x32_bf16 a[104:107], v[136:139], a[200:203], a[104:107]
    v_mfma_f32_16x16x32_bf16 a[100:103], v[136:139], a[196:199], a[100:103]
    v_mfma_f32_16x16x32_bf16 a[96:99], v[136:139], a[192:195], a[96:99]
    v_mfma_f32_16x16x32_bf16 a[128:131], v[140:143], a[192:195], a[128:131]
    ds_read_b64_tr_b16 v[132:133], v57 offset:36864
    v_mfma_f32_16x16x32_bf16 a[132:135], v[140:143], a[196:199], a[132:135]
    ds_read_b64_tr_b16 v[134:135], v57 offset:38912
    v_mfma_f32_16x16x32_bf16 a[136:139], v[140:143], a[200:203], a[136:139]
    ds_read_b128 a[236:239], v54 offset:39936
    v_mfma_f32_16x16x32_bf16 a[140:143], v[140:143], a[204:207], a[140:143]
    ds_read_b128 a[240:243], v54 offset:40960
    v_mfma_f32_16x16x32_bf16 a[144:147], v[140:143], a[208:211], a[144:147]
    ds_read_b128 a[244:247], v54 offset:41984
    v_mfma_f32_16x16x32_bf16 a[148:151], v[140:143], a[212:215], a[148:151]
    v_mfma_f32_16x16x32_bf16 a[152:155], v[140:143], a[216:219], a[152:155]
    v_mfma_f32_16x16x32_bf16 a[156:159], v[140:143], a[220:223], a[156:159]
    v_mfma_f32_16x16x32_bf16 a[188:191], v[144:147], a[220:223], a[188:191]
    ds_read_b64_tr_b16 v[136:137], v56 offset:40960
    v_mfma_f32_16x16x32_bf16 a[184:187], v[144:147], a[216:219], a[184:187]
    ds_read_b64_tr_b16 v[138:139], v56 offset:43008
    v_mfma_f32_16x16x32_bf16 a[180:183], v[144:147], a[212:215], a[180:183]
    ds_read_b128 a[248:251], v54 offset:43008
    v_mfma_f32_16x16x32_bf16 a[176:179], v[144:147], a[208:211], a[176:179]
    ds_read_b128 a[252:255], v54 offset:44032
    v_mfma_f32_16x16x32_bf16 a[172:175], v[144:147], a[204:207], a[172:175]
    v_mfma_f32_16x16x32_bf16 a[168:171], v[144:147], a[200:203], a[168:171]
    v_mfma_f32_16x16x32_bf16 a[164:167], v[144:147], a[196:199], a[164:167]
    v_mfma_f32_16x16x32_bf16 a[160:163], v[144:147], a[192:195], a[160:163]
    s_waitcnt lgkmcnt(11)
    v_mfma_f32_16x16x32_bf16 v[192:195], v[128:131], a[224:227], v[192:195]
    ds_read_b64_tr_b16 v[140:141], v57 offset:40960
    s_add_u32 s88, s52, L_p2_tail-L_g1_tail
    s_waitcnt lgkmcnt(11)
    v_mfma_f32_16x16x32_bf16 v[196:199], v[128:131], a[228:231], v[196:199]
    ds_read_b64_tr_b16 v[142:143], v57 offset:43008
    s_addc_u32 s89, s53, 0
    s_waitcnt lgkmcnt(11)
    v_mfma_f32_16x16x32_bf16 v[200:203], v[128:131], a[232:235], v[200:203]
    s_mov_b32 s90, L_end-L_p2_tail
    s_mov_b32 s91, 0x20000
    s_waitcnt lgkmcnt(8)
    v_mfma_f32_16x16x32_bf16 v[204:207], v[128:131], a[236:239], v[204:207]
    s_mov_b32 s28, s74
    s_mov_b32 s29, s75
    s_waitcnt lgkmcnt(7)
    v_mfma_f32_16x16x32_bf16 v[208:211], v[128:131], a[240:243], v[208:211]
    s_mov_b32 s30, 33554432
    s_mov_b32 s31, 0x20000
    s_waitcnt lgkmcnt(6)
    v_mfma_f32_16x16x32_bf16 v[212:215], v[128:131], a[244:247], v[212:215]
    s_lshl_b32 s54, s44, 14
    s_lshl_b32 s55, s41, 13
    s_waitcnt lgkmcnt(3)
    v_mfma_f32_16x16x32_bf16 v[216:219], v[128:131], a[248:251], v[216:219]
    s_add_u32 s54, s54, s55
    s_lshl_b32 s55, s42, 17
    s_waitcnt lgkmcnt(2)
    v_mfma_f32_16x16x32_bf16 v[220:223], v[128:131], a[252:255], v[220:223]
    s_add_u32 s54, s54, s55
    s_lshl_b32 s49, s43, 7
    v_mfma_f32_16x16x32_bf16 v[252:255], v[132:135], a[252:255], v[252:255]
    ds_read_b64_tr_b16 v[144:145], v56 offset:45056
    s_lshl_b32 s55, s44, 4
    v_mfma_f32_16x16x32_bf16 v[248:251], v[132:135], a[248:251], v[248:251]
    ds_read_b64_tr_b16 v[146:147], v56 offset:47104
    s_add_u32 s49, s49, s55
    v_mfma_f32_16x16x32_bf16 v[244:247], v[132:135], a[244:247], v[244:247]
    s_lshl_b32 s55, s77, 2
    s_add_u32 s49, s49, s55
    v_mfma_f32_16x16x32_bf16 v[240:243], v[132:135], a[240:243], v[240:243]
    s_add_u32 s49, s49, 8192
    s_lshl_b32 s78, s44, 1
    v_mfma_f32_16x16x32_bf16 v[236:239], v[132:135], a[236:239], v[236:239]
    s_add_u32 s78, s78, s41
    s_lshl_b32 s78, s78, 8
    v_mfma_f32_16x16x32_bf16 v[232:235], v[132:135], a[232:235], v[232:235]
    s_lshl_b32 s55, s43, 3
    s_add_u32 s78, s78, s55
    v_mfma_f32_16x16x32_bf16 v[228:231], v[132:135], a[228:231], v[228:231]
    s_lshl_b32 s55, s42, 2
    s_add_u32 s78, s78, s55
    v_mfma_f32_16x16x32_bf16 v[224:227], v[132:135], a[224:227], v[224:227]
    s_add_u32 s78, s78, 16384
    s_sub_u32 s56, s43, 24
    v_mfma_f32_16x16x32_bf16 v[64:67], v[136:139], a[224:227], v[64:67]
    ds_read_b64_tr_b16 v[128:129], v57 offset:45056
    s_lshl_b32 s100, s40, 18
    v_mfma_f32_16x16x32_bf16 v[68:71], v[136:139], a[228:231], v[68:71]
    ds_read_b64_tr_b16 v[130:131], v57 offset:47104
    s_add_u32 s100, s100, s54
    v_mfma_f32_16x16x32_bf16 v[72:75], v[136:139], a[232:235], v[72:75]
    s_add_u32 s100, s100, 4194304
    s_lshl_b32 s57, s43, 19
    v_mfma_f32_16x16x32_bf16 v[76:79], v[136:139], a[236:239], v[76:79]
    s_lshl_b32 s58, s56, 18
    s_add_u32 s58, s58, 12582912
    v_mfma_f32_16x16x32_bf16 v[80:83], v[136:139], a[240:243], v[80:83]
    s_cmp_eq_u32 s45, 0
    s_cselect_b32 s3, s57, s58
    v_mfma_f32_16x16x32_bf16 v[84:87], v[136:139], a[244:247], v[84:87]
    s_add_u32 s3, s3, s54
    s_add_u32 s20, s3, 262144
    v_mfma_f32_16x16x32_bf16 v[88:91], v[136:139], a[248:251], v[88:91]
    s_cmp_eq_u32 s45, 0
    s_cselect_b32 s20, s20, 0x70000000
    v_mfma_f32_16x16x32_bf16 v[92:95], v[136:139], a[252:255], v[92:95]
    s_cmp_lt_u32 s40, 16
    s_cselect_b32 s101, 0x3e8293ee, 1.0
    s_waitcnt lgkmcnt(4)
    v_mfma_f32_16x16x32_bf16 v[124:127], v[140:143], a[252:255], v[124:127]
    ds_read_b64_tr_b16 v[132:133], v56 offset:49152
    s_mov_b32 s59, s45
    v_mfma_f32_16x16x32_bf16 v[120:123], v[140:143], a[248:251], v[120:123]
    ds_read_b64_tr_b16 v[134:135], v56 offset:51200
    v_mov_b32 v154, 0xc0135761
    v_mfma_f32_16x16x32_bf16 v[116:119], v[140:143], a[244:247], v[116:119]
    v_mov_b32 v155, 0xc0135761
    v_add_u32 v185, 4096, v184
    v_mfma_f32_16x16x32_bf16 v[112:115], v[140:143], a[240:243], v[112:115]
    s_and_b32 s21, s2, 7
    s_lshl_b32 s21, s21, 2
    v_mfma_f32_16x16x32_bf16 v[108:111], v[140:143], a[236:239], v[108:111]
    s_bfe_u32 s50, s2, 0x20003
    s_add_u32 s21, s21, s50
    v_mfma_f32_16x16x32_bf16 v[104:107], v[140:143], a[232:235], v[104:107]
    s_lshr_b32 s22, s2, 5
    s_lshl_b32 s50, s21, 17
    v_mfma_f32_16x16x32_bf16 v[100:103], v[140:143], a[228:231], v[100:103]
    s_add_u32 s51, s50, 4194304
    s_add_u32 s52, s51, 4194304
    v_mfma_f32_16x16x32_bf16 v[96:99], v[140:143], a[224:227], v[96:99]
    s_add_u32 s53, s51, 8388608
    s_add_u32 s54, s50, 33554432
    s_waitcnt lgkmcnt(4)
    v_mfma_f32_16x16x32_bf16 a[0:3], v[144:147], a[224:227], a[0:3]
    ds_read_b64_tr_b16 v[136:137], v57 offset:49152
    s_add_u32 s8, s74, s52
    v_mfma_f32_16x16x32_bf16 a[4:7], v[144:147], a[228:231], a[4:7]
    ds_read_b64_tr_b16 v[138:139], v57 offset:51200
    s_addc_u32 s9, s75, 0
    v_mfma_f32_16x16x32_bf16 a[8:11], v[144:147], a[232:235], a[8:11]
    s_mov_b32 s10, 131072
    s_mov_b32 s11, 0x20000
    v_mfma_f32_16x16x32_bf16 a[12:15], v[144:147], a[236:239], a[12:15]
    s_add_u32 s12, s74, s53
    s_addc_u32 s13, s75, 0
    v_mfma_f32_16x16x32_bf16 a[16:19], v[144:147], a[240:243], a[16:19]
    s_mov_b32 s14, 131072
    s_mov_b32 s15, 0x20000
    v_mfma_f32_16x16x32_bf16 a[20:23], v[144:147], a[244:247], a[20:23]
    s_add_u32 s4, s74, s51
    s_addc_u32 s5, s75, 0
    v_mfma_f32_16x16x32_bf16 a[24:27], v[144:147], a[248:251], a[24:27]
    s_mov_b32 s6, 131072
    s_mov_b32 s7, 0x20000
    v_mfma_f32_16x16x32_bf16 a[28:31], v[144:147], a[252:255], a[28:31]
    s_add_u32 s16, s74, s54
    s_addc_u32 s17, s75, 0
    s_waitcnt lgkmcnt(4)
    v_mfma_f32_16x16x32_bf16 a[60:63], v[128:131], a[252:255], a[60:63]
    ds_read_b64_tr_b16 v[140:141], v56 offset:53248
    s_mov_b32 s18, 131072
    v_mfma_f32_16x16x32_bf16 a[56:59], v[128:131], a[248:251], a[56:59]
    ds_read_b64_tr_b16 v[142:143], v56 offset:55296
    s_mov_b32 s19, 0x20000
    v_mfma_f32_16x16x32_bf16 a[52:55], v[128:131], a[244:247], a[52:55]
    s_lshl_b32 s24, s77, 11
    s_lshl_b32 s27, s22, 14
    v_mfma_f32_16x16x32_bf16 a[48:51], v[128:131], a[240:243], a[48:51]
    s_lshl_b32 s50, s77, 12
    s_add_u32 s27, s27, s50
    v_mfma_f32_16x16x32_bf16 a[44:47], v[128:131], a[236:239], a[44:47]
    s_bfe_u32 s50, s2, 0x20001
    s_lshl_b32 s50, s50, 2
    v_mfma_f32_16x16x32_bf16 a[40:43], v[128:131], a[232:235], a[40:43]
    s_bfe_u32 s51, s2, 0x20006
    s_add_u32 s44, s50, s51
    v_mfma_f32_16x16x32_bf16 a[36:39], v[128:131], a[228:231], a[36:39]
    s_and_b32 s50, s2, 1
    s_lshl_b32 s50, s50, 3
    v_mfma_f32_16x16x32_bf16 a[32:35], v[128:131], a[224:227], a[32:35]
    s_bfe_u32 s51, s2, 0x30003
    s_add_u32 s45, s50, s51
    s_waitcnt lgkmcnt(4)
    v_mfma_f32_16x16x32_bf16 a[64:67], v[132:135], a[224:227], a[64:67]
    ds_read_b64_tr_b16 v[144:145], v57 offset:53248
    s_add_u32 s32, s74, 16777216
    v_mfma_f32_16x16x32_bf16 a[68:71], v[132:135], a[228:231], a[68:71]
    ds_read_b64_tr_b16 v[146:147], v57 offset:55296
    s_addc_u32 s33, s75, 0
    v_mfma_f32_16x16x32_bf16 a[72:75], v[132:135], a[232:235], a[72:75]
    s_mov_b32 s34, 14680064
    s_mov_b32 s35, 0x20000
    v_mfma_f32_16x16x32_bf16 a[76:79], v[132:135], a[236:239], a[76:79]
    s_mov_b32 s36, s70
    s_mov_b32 s37, s71
    v_mfma_f32_16x16x32_bf16 a[80:83], v[132:135], a[240:243], a[80:83]
    s_mov_b32 s38, 7340032
    s_mov_b32 s39, 0x20000
    v_mfma_f32_16x16x32_bf16 a[84:87], v[132:135], a[244:247], a[84:87]
    s_add_u32 s40, s74, 41943040
    s_addc_u32 s41, s75, 0
    v_mfma_f32_16x16x32_bf16 a[88:91], v[132:135], a[248:251], a[88:91]
    s_mov_b32 s42, 2097152
    s_mov_b32 s43, 0x20000
    v_mfma_f32_16x16x32_bf16 a[92:95], v[132:135], a[252:255], a[92:95]
    s_lshl_b32 s48, s77, 14
    s_add_u32 s48, s48, 65536
    s_waitcnt vmcnt(10) lgkmcnt(0)
    s_barrier
    v_mfma_f32_16x16x32_bf16 a[124:127], v[136:139], a[252:255], a[124:127]
    ds_read_b64_tr_b16 v[128:129], v58 offset:16384
    s_mov_b32 s46, 0
    v_mfma_f32_16x16x32_bf16 a[120:123], v[136:139], a[248:251], a[120:123]
    ds_read_b64_tr_b16 v[130:131], v58 offset:18432
    s_mov_b32 s47, 0
    v_mfma_f32_16x16x32_bf16 a[116:119], v[136:139], a[244:247], a[116:119]
    ds_read_b128 a[192:195], v55 offset:0
    v_mov_b32 v36, 0
    v_mfma_f32_16x16x32_bf16 a[112:115], v[136:139], a[240:243], a[112:115]
    ds_read_b128 a[196:199], v55 offset:1024
    v_mov_b32 v37, 0
    v_mfma_f32_16x16x32_bf16 a[108:111], v[136:139], a[236:239], a[108:111]
    ds_read_b128 a[200:203], v55 offset:2048
    v_mov_b32 v38, 0
    v_mfma_f32_16x16x32_bf16 a[104:107], v[136:139], a[232:235], a[104:107]
    v_mov_b32 v39, 0
    v_mov_b32 v40, 0
    v_mfma_f32_16x16x32_bf16 a[100:103], v[136:139], a[228:231], a[100:103]
    v_mov_b32 v41, 0
    v_mov_b32 v42, 0
    v_mfma_f32_16x16x32_bf16 a[96:99], v[136:139], a[224:227], a[96:99]
    v_mov_b32 v43, 0
    v_mov_b32 v44, 0
    v_mfma_f32_16x16x32_bf16 a[128:131], v[140:143], a[224:227], a[128:131]
    ds_read_b64_tr_b16 v[132:133], v59 offset:16384
    v_mov_b32 v45, 0
    v_mfma_f32_16x16x32_bf16 a[132:135], v[140:143], a[228:231], a[132:135]
    ds_read_b64_tr_b16 v[134:135], v59 offset:18432
    v_mov_b32 v46, 0
    v_mfma_f32_16x16x32_bf16 a[136:139], v[140:143], a[232:235], a[136:139]
    ds_read_b128 a[204:207], v55 offset:3072
    v_mov_b32 v47, 0
    v_mfma_f32_16x16x32_bf16 a[140:143], v[140:143], a[236:239], a[140:143]
    ds_read_b128 a[208:211], v55 offset:4096
    v_mov_b32 v48, 0
    v_mfma_f32_16x16x32_bf16 a[144:147], v[140:143], a[240:243], a[144:147]
    ds_read_b128 a[212:215], v55 offset:5120
    v_mov_b32 v49, 0
    v_mfma_f32_16x16x32_bf16 a[148:151], v[140:143], a[244:247], a[148:151]
    v_mov_b32 v50, 0
    v_mov_b32 v51, 0
    v_mfma_f32_16x16x32_bf16 a[152:155], v[140:143], a[248:251], a[152:155]
    v_mov_b32 v60, 0
    v_mov_b32 v61, 0
    v_mfma_f32_16x16x32_bf16 a[156:159], v[140:143], a[252:255], a[156:159]
    v_mov_b32 v62, 0
    v_mov_b32 v63, 0
    v_mfma_f32_16x16x32_bf16 a[188:191], v[144:147], a[252:255], a[188:191]
    ds_read_b64_tr_b16 v[136:137], v58 offset:12288
    s_lshl_b32 s78, s78, 5
    v_mfma_f32_16x16x32_bf16 a[184:187], v[144:147], a[248:251], a[184:187]
    ds_read_b64_tr_b16 v[138:139], v58 offset:14336
    v_mov_b32 v160, s76
    v_mfma_f32_16x16x32_bf16 a[180:183], v[144:147], a[244:247], a[180:183]
    ds_read_b128 a[216:219], v55 offset:6144
    s_mov_b32 s50, 0xbdd2d3e8
    v_mfma_f32_16x16x32_bf16 a[176:179], v[144:147], a[240:243], a[176:179]
    ds_read_b128 a[220:223], v55 offset:7168
    s_mov_b32 s51, s50
    v_mfma_f32_16x16x32_bf16 a[172:175], v[144:147], a[236:239], a[172:175]
    v_mfma_f32_16x16x32_bf16 a[168:171], v[144:147], a[232:235], a[168:171]
    v_mfma_f32_16x16x32_bf16 a[164:167], v[144:147], a[228:231], a[164:167]
    v_mfma_f32_16x16x32_bf16 a[160:163], v[144:147], a[224:227], a[160:163]
    s_waitcnt lgkmcnt(11)
    v_mfma_f32_16x16x32_bf16 a[128:131], v[128:131], a[192:195], a[128:131]
    ds_read_b64_tr_b16 v[140:141], v59 offset:12288
    s_waitcnt lgkmcnt(11)
    v_mfma_f32_16x16x32_bf16 a[132:135], v[128:131], a[196:199], a[132:135]
    ds_read_b64_tr_b16 v[142:143], v59 offset:14336
    s_waitcnt lgkmcnt(11)
    v_mfma_f32_16x16x32_bf16 a[136:139], v[128:131], a[200:203], a[136:139]
    s_waitcnt lgkmcnt(8)
    v_mfma_f32_16x16x32_bf16 a[140:143], v[128:131], a[204:207], a[140:143]
    s_waitcnt lgkmcnt(7)
    v_mfma_f32_16x16x32_bf16 a[144:147], v[128:131], a[208:211], a[144:147]
    s_waitcnt lgkmcnt(6)
    v_mfma_f32_16x16x32_bf16 a[148:151], v[128:131], a[212:215], a[148:151]
    s_waitcnt lgkmcnt(3)
    v_mfma_f32_16x16x32_bf16 a[152:155], v[128:131], a[216:219], a[152:155]
    s_waitcnt lgkmcnt(2)
    v_mfma_f32_16x16x32_bf16 a[156:159], v[128:131], a[220:223], a[156:159]
    s_waitcnt vmcnt(1)
    s_barrier
    v_mfma_f32_16x16x32_bf16 a[188:191], v[132:135], a[220:223], a[188:191]
    ds_read_b64_tr_b16 v[144:145], v58 offset:53248
    v_mfma_f32_16x16x32_bf16 a[184:187], v[132:135], a[216:219], a[184:187]
    ds_read_b64_tr_b16 v[146:147], v58 offset:55296
    v_mfma_f32_16x16x32_bf16 a[180:183], v[132:135], a[212:215], a[180:183]
    ds_read_b128 a[224:227], v55 offset:36864
    v_mfma_f32_16x16x32_bf16 a[176:179], v[132:135], a[208:211], a[176:179]
    ds_read_b128 a[228:231], v55 offset:37888
    v_mfma_f32_16x16x32_bf16 a[172:175], v[132:135], a[204:207], a[172:175]
    ds_read_b128 a[232:235], v55 offset:38912
    v_mfma_f32_16x16x32_bf16 a[168:171], v[132:135], a[200:203], a[168:171]
    v_mfma_f32_16x16x32_bf16 a[164:167], v[132:135], a[196:199], a[164:167]
    v_mfma_f32_16x16x32_bf16 a[160:163], v[132:135], a[192:195], a[160:163]
    v_mfma_f32_16x16x32_bf16 a[64:67], v[136:139], a[192:195], a[64:67]
    ds_read_b64_tr_b16 v[128:129], v59 offset:53248
    v_mfma_f32_16x16x32_bf16 a[68:71], v[136:139], a[196:199], a[68:71]
    ds_read_b64_tr_b16 v[130:131], v59 offset:55296
    v_mfma_f32_16x16x32_bf16 a[72:75], v[136:139], a[200:203], a[72:75]
    ds_read_b128 a[236:239], v55 offset:39936
    v_mfma_f32_16x16x32_bf16 a[76:79], v[136:139], a[204:207], a[76:79]
    ds_read_b128 a[240:243], v55 offset:40960
    v_mfma_f32_16x16x32_bf16 a[80:83], v[136:139], a[208:211], a[80:83]
    ds_read_b128 a[244:247], v55 offset:41984
    v_mfma_f32_16x16x32_bf16 a[84:87], v[136:139], a[212:215], a[84:87]
    v_mfma_f32_16x16x32_bf16 a[88:91], v[136:139], a[216:219], a[88:91]
    v_mfma_f32_16x16x32_bf16 a[92:95], v[136:139], a[220:223], a[92:95]
    s_waitcnt lgkmcnt(10)
    v_mfma_f32_16x16x32_bf16 a[124:127], v[140:143], a[220:223], a[124:127]
    ds_read_b64_tr_b16 v[132:133], v58 offset:49152
    v_mfma_f32_16x16x32_bf16 a[120:123], v[140:143], a[216:219], a[120:123]
    ds_read_b64_tr_b16 v[134:135], v58 offset:51200
    v_mfma_f32_16x16x32_bf16 a[116:119], v[140:143], a[212:215], a[116:119]
    ds_read_b128 a[248:251], v55 offset:43008
    v_mfma_f32_16x16x32_bf16 a[112:115], v[140:143], a[208:211], a[112:115]
    ds_read_b128 a[252:255], v55 offset:44032
    v_mfma_f32_16x16x32_bf16 a[108:111], v[140:143], a[204:207], a[108:111]
    v_mfma_f32_16x16x32_bf16 a[104:107], v[140:143], a[200:203], a[104:107]
    v_mfma_f32_16x16x32_bf16 a[100:103], v[140:143], a[196:199], a[100:103]
    v_mfma_f32_16x16x32_bf16 a[96:99], v[140:143], a[192:195], a[96:99]
    s_waitcnt lgkmcnt(11)
    v_mfma_f32_16x16x32_bf16 a[128:131], v[144:147], a[224:227], a[128:131]
    ds_read_b64_tr_b16 v[136:137], v59 offset:49152
    s_waitcnt lgkmcnt(11)
    v_mfma_f32_16x16x32_bf16 a[132:135], v[144:147], a[228:231], a[132:135]
    ds_read_b64_tr_b16 v[138:139], v59 offset:51200
    s_waitcnt lgkmcnt(11)
    v_mfma_f32_16x16x32_bf16 a[136:139], v[144:147], a[232:235], a[136:139]
    s_waitcnt lgkmcnt(8)
    v_mfma_f32_16x16x32_bf16 a[140:143], v[144:147], a[236:239], a[140:143]
    s_waitcnt lgkmcnt(7)
    v_mfma_f32_16x16x32_bf16 a[144:147], v[144:147], a[240:243], a[144:147]
    s_waitcnt lgkmcnt(6)
    v_mfma_f32_16x16x32_bf16 a[148:151], v[144:147], a[244:247], a[148:151]
    s_waitcnt lgkmcnt(3)
    v_mfma_f32_16x16x32_bf16 a[152:155], v[144:147], a[248:251], a[152:155]
    s_waitcnt lgkmcnt(2)
    v_mfma_f32_16x16x32_bf16 a[156:159], v[144:147], a[252:255], a[156:159]
    v_mfma_f32_16x16x32_bf16 a[188:191], v[128:131], a[252:255], a[188:191]
    ds_read_b64_tr_b16 v[140:141], v58 offset:8192
    v_mfma_f32_16x16x32_bf16 a[184:187], v[128:131], a[248:251], a[184:187]
    ds_read_b64_tr_b16 v[142:143], v58 offset:10240
    v_mfma_f32_16x16x32_bf16 a[180:183], v[128:131], a[244:247], a[180:183]
    v_mfma_f32_16x16x32_bf16 a[176:179], v[128:131], a[240:243], a[176:179]
    v_mfma_f32_16x16x32_bf16 a[172:175], v[128:131], a[236:239], a[172:175]
    v_mfma_f32_16x16x32_bf16 a[168:171], v[128:131], a[232:235], a[168:171]
    v_mfma_f32_16x16x32_bf16 a[164:167], v[128:131], a[228:231], a[164:167]
    v_mfma_f32_16x16x32_bf16 a[160:163], v[128:131], a[224:227], a[160:163]
    v_mfma_f32_16x16x32_bf16 a[64:67], v[132:135], a[224:227], a[64:67]
    ds_read_b64_tr_b16 v[144:145], v59 offset:8192
    v_mfma_f32_16x16x32_bf16 a[68:71], v[132:135], a[228:231], a[68:71]
    ds_read_b64_tr_b16 v[146:147], v59 offset:10240
    v_mfma_f32_16x16x32_bf16 a[72:75], v[132:135], a[232:235], a[72:75]
    v_mfma_f32_16x16x32_bf16 a[76:79], v[132:135], a[236:239], a[76:79]
    v_mfma_f32_16x16x32_bf16 a[80:83], v[132:135], a[240:243], a[80:83]
    v_mfma_f32_16x16x32_bf16 a[84:87], v[132:135], a[244:247], a[84:87]
    v_mfma_f32_16x16x32_bf16 a[88:91], v[132:135], a[248:251], a[88:91]
    v_mfma_f32_16x16x32_bf16 a[92:95], v[132:135], a[252:255], a[92:95]
    s_cmp_eq_u32 s59, 0
    s_cbranch_scc0 L_g1_lastC
    s_waitcnt lgkmcnt(4)
    v_mfma_f32_16x16x32_bf16 a[124:127], v[136:139], a[252:255], a[124:127]
    ds_read_b64_tr_b16 v[128:129], v58 offset:45056
    v_accvgpr_read_b32 v12, a128
    v_mfma_f32_16x16x32_bf16 a[120:123], v[136:139], a[248:251], a[120:123]
    ds_read_b64_tr_b16 v[130:131], v58 offset:47104
    v_accvgpr_read_b32 v13, a129
    v_mfma_f32_16x16x32_bf16 a[116:119], v[136:139], a[244:247], a[116:119]
    v_accvgpr_read_b32 v14, a130
    v_accvgpr_read_b32 v15, a131
    v_mfma_f32_16x16x32_bf16 a[112:115], v[136:139], a[240:243], a[112:115]
    v_accvgpr_read_b32 v16, a160
    v_accvgpr_read_b32 v17, a161
    v_mfma_f32_16x16x32_bf16 a[108:111], v[136:139], a[236:239], a[108:111]
    v_accvgpr_read_b32 v18, a162
    v_accvgpr_read_b32 v19, a163
    v_mfma_f32_16x16x32_bf16 a[104:107], v[136:139], a[232:235], a[104:107]
    v_mul_f32 v12, s101, v12
    v_mul_f32 v13, s101, v13
    v_mfma_f32_16x16x32_bf16 a[100:103], v[136:139], a[228:231], a[100:103]
    v_mul_f32 v14, s101, v14
    v_mul_f32 v15, s101, v15
    v_mfma_f32_16x16x32_bf16 a[96:99], v[136:139], a[224:227], a[96:99]
    v_mul_f32 v16, s101, v16
    v_mul_f32 v17, s101, v17
    s_waitcnt lgkmcnt(4)
    v_mfma_f32_16x16x32_bf16 a[0:3], v[140:143], a[192:195], a[0:3]
    ds_read_b64_tr_b16 v[132:133], v59 offset:45056
    v_mul_f32 v18, s101, v18
    v_mfma_f32_16x16x32_bf16 a[4:7], v[140:143], a[196:199], a[4:7]
    ds_read_b64_tr_b16 v[134:135], v59 offset:47104
    v_mul_f32 v19, s101, v19
    v_mfma_f32_16x16x32_bf16 a[8:11], v[140:143], a[200:203], a[8:11]
    v_cvt_pk_bf16_f32 v20, v12, v13
    v_cvt_pk_bf16_f32 v21, v14, v15
    v_mfma_f32_16x16x32_bf16 a[12:15], v[140:143], a[204:207], a[12:15]
    v_cvt_pk_bf16_f32 v22, v16, v17
    v_cvt_pk_bf16_f32 v23, v18, v19
    v_mfma_f32_16x16x32_bf16 a[16:19], v[140:143], a[208:211], a[16:19]
    buffer_store_dwordx4 v[20:23], v184, s[28:31], s100 offen offset:0 sc1
    v_mfma_f32_16x16x32_bf16 a[20:23], v[140:143], a[212:215], a[20:23]
    v_accvgpr_read_b32 v24, a132
    v_accvgpr_read_b32 v25, a133
    v_mfma_f32_16x16x32_bf16 a[24:27], v[140:143], a[216:219], a[24:27]
    v_accvgpr_read_b32 v26, a134
    v_accvgpr_read_b32 v27, a135
    v_mfma_f32_16x16x32_bf16 a[28:31], v[140:143], a[220:223], a[28:31]
    v_accvgpr_read_b32 v28, a164
    v_accvgpr_read_b32 v29, a165
    s_waitcnt lgkmcnt(4)
    v_mfma_f32_16x16x32_bf16 a[60:63], v[144:147], a[220:223], a[60:63]
    ds_read_b64_tr_b16 v[136:137], v58 offset:0
    v_accvgpr_read_b32 v30, a166
    v_mfma_f32_16x16x32_bf16 a[56:59], v[144:147], a[216:219], a[56:59]
    ds_read_b64_tr_b16 v[138:139], v58 offset:2048
    v_accvgpr_read_b32 v31, a167
    v_mfma_f32_16x16x32_bf16 a[52:55], v[144:147], a[212:215], a[52:55]
    v_mul_f32 v24, s101, v24
    v_mul_f32 v25, s101, v25
    v_mfma_f32_16x16x32_bf16 a[48:51], v[144:147], a[208:211], a[48:51]
    v_mul_f32 v26, s101, v26
    v_mul_f32 v27, s101, v27
    v_mfma_f32_16x16x32_bf16 a[44:47], v[144:147], a[204:207], a[44:47]
    v_mul_f32 v28, s101, v28
    v_mul_f32 v29, s101, v29
    v_mfma_f32_16x16x32_bf16 a[40:43], v[144:147], a[200:203], a[40:43]
    v_mul_f32 v30, s101, v30
    v_mul_f32 v31, s101, v31
    v_mfma_f32_16x16x32_bf16 a[36:39], v[144:147], a[196:199], a[36:39]
    v_cvt_pk_bf16_f32 v32, v24, v25
    v_cvt_pk_bf16_f32 v33, v26, v27
    v_mfma_f32_16x16x32_bf16 a[32:35], v[144:147], a[192:195], a[32:35]
    v_cvt_pk_bf16_f32 v34, v28, v29
    v_cvt_pk_bf16_f32 v35, v30, v31
    s_waitcnt lgkmcnt(4)
    v_mfma_f32_16x16x32_bf16 a[0:3], v[128:131], a[224:227], a[0:3]
    ds_read_b64_tr_b16 v[140:141], v59 offset:0
    v_mfma_f32_16x16x32_bf16 a[4:7], v[128:131], a[228:231], a[4:7]
    ds_read_b64_tr_b16 v[142:143], v59 offset:2048
    v_mfma_f32_16x16x32_bf16 a[8:11], v[128:131], a[232:235], a[8:11]
    buffer_store_dwordx4 v[32:35], v184, s[28:31], s100 offen offset:1024 sc1
    v_mfma_f32_16x16x32_bf16 a[12:15], v[128:131], a[236:239], a[12:15]
    v_accvgpr_read_b32 v12, a136
    v_accvgpr_read_b32 v13, a137
    v_mfma_f32_16x16x32_bf16 a[16:19], v[128:131], a[240:243], a[16:19]
    v_accvgpr_read_b32 v14, a138
    v_accvgpr_read_b32 v15, a139
    v_mfma_f32_16x16x32_bf16 a[20:23], v[128:131], a[244:247], a[20:23]
    v_accvgpr_read_b32 v16, a168
    v_accvgpr_read_b32 v17, a169
    v_mfma_f32_16x16x32_bf16 a[24:27], v[128:131], a[248:251], a[24:27]
    v_accvgpr_read_b32 v18, a170
    v_accvgpr_read_b32 v19, a171
    v_mfma_f32_16x16x32_bf16 a[28:31], v[128:131], a[252:255], a[28:31]
    v_mul_f32 v12, s101, v12
    v_mul_f32 v13, s101, v13
    s_waitcnt lgkmcnt(4)
    v_mfma_f32_16x16x32_bf16 a[60:63], v[132:135], a[252:255], a[60:63]
    ds_read_b64_tr_b16 v[144:145], v58 offset:4096
    v_mul_f32 v14, s101, v14
    v_mfma_f32_16x16x32_bf16 a[56:59], v[132:135], a[248:251], a[56:59]
    ds_read_b64_tr_b16 v[146:147], v58 offset:6144
    v_mul_f32 v15, s101, v15
    v_mfma_f32_16x16x32_bf16 a[52:55], v[132:135], a[244:247], a[52:55]
    v_mul_f32 v16, s101, v16
    v_mul_f32 v17, s101, v17
    v_mfma_f32_16x16x32_bf16 a[48:51], v[132:135], a[240:243], a[48:51]
    v_mul_f32 v18, s101, v18
    v_mul_f32 v19, s101, v19
    v_mfma_f32_16x16x32_bf16 a[44:47], v[132:135], a[236:239], a[44:47]
    v_cvt_pk_bf16_f32 v20, v12, v13
    v_cvt_pk_bf16_f32 v21, v14, v15
    v_mfma_f32_16x16x32_bf16 a[40:43], v[132:135], a[232:235], a[40:43]
    v_cvt_pk_bf16_f32 v22, v16, v17
    v_cvt_pk_bf16_f32 v23, v18, v19
    v_mfma_f32_16x16x32_bf16 a[36:39], v[132:135], a[228:231], a[36:39]
    buffer_store_dwordx4 v[20:23], v184, s[28:31], s100 offen offset:2048 sc1
    v_mfma_f32_16x16x32_bf16 a[32:35], v[132:135], a[224:227], a[32:35]
    v_accvgpr_read_b32 v24, a140
    v_accvgpr_read_b32 v25, a141
    s_waitcnt lgkmcnt(4)
    v_mfma_f32_16x16x32_bf16 v[192:195], v[136:139], a[192:195], v[192:195]
    ds_read_b64_tr_b16 v[128:129], v59 offset:4096
    v_accvgpr_read_b32 v26, a142
    v_mfma_f32_16x16x32_bf16 v[196:199], v[136:139], a[196:199], v[196:199]
    ds_read_b64_tr_b16 v[130:131], v59 offset:6144
    v_accvgpr_read_b32 v27, a143
    v_mfma_f32_16x16x32_bf16 v[200:203], v[136:139], a[200:203], v[200:203]
    v_accvgpr_read_b32 v28, a172
    v_accvgpr_read_b32 v29, a173
    v_mfma_f32_16x16x32_bf16 v[204:207], v[136:139], a[204:207], v[204:207]
    v_accvgpr_read_b32 v30, a174
    v_accvgpr_read_b32 v31, a175
    v_mfma_f32_16x16x32_bf16 v[208:211], v[136:139], a[208:211], v[208:211]
    v_mul_f32 v24, s101, v24
    v_mul_f32 v25, s101, v25
    v_mfma_f32_16x16x32_bf16 v[212:215], v[136:139], a[212:215], v[212:215]
    v_mul_f32 v26, s101, v26
    v_mul_f32 v27, s101, v27
    v_mfma_f32_16x16x32_bf16 v[216:219], v[136:139], a[216:219], v[216:219]
    v_mul_f32 v28, s101, v28
    v_mul_f32 v29, s101, v29
    v_mfma_f32_16x16x32_bf16 v[220:223], v[136:139], a[220:223], v[220:223]
    v_mul_f32 v30, s101, v30
    v_mul_f32 v31, s101, v31
    s_waitcnt lgkmcnt(4)
    v_mfma_f32_16x16x32_bf16 v[252:255], v[140:143], a[220:223], v[252:255]
    ds_read_b64_tr_b16 v[132:133], v58 offset:36864
    v_cvt_pk_bf16_f32 v32, v24, v25
    v_mfma_f32_16x16x32_bf16 v[248:251], v[140:143], a[216:219], v[248:251]
    ds_read_b64_tr_b16 v[134:135], v58 offset:38912
    v_cvt_pk_bf16_f32 v33, v26, v27
    v_mfma_f32_16x16x32_bf16 v[244:247], v[140:143], a[212:215], v[244:247]
    v_cvt_pk_bf16_f32 v34, v28, v29
    v_cvt_pk_bf16_f32 v35, v30, v31
    v_mfma_f32_16x16x32_bf16 v[240:243], v[140:143], a[208:211], v[240:243]
    buffer_store_dwordx4 v[32:35], v184, s[28:31], s100 offen offset:3072 sc1
    v_mfma_f32_16x16x32_bf16 v[236:239], v[140:143], a[204:207], v[236:239]
    v_accvgpr_read_b32 v12, a144
    v_accvgpr_read_b32 v13, a145
    v_mfma_f32_16x16x32_bf16 v[232:235], v[140:143], a[200:203], v[232:235]
    v_accvgpr_read_b32 v14, a146
    v_accvgpr_read_b32 v15, a147
    v_mfma_f32_16x16x32_bf16 v[228:231], v[140:143], a[196:199], v[228:231]
    v_accvgpr_read_b32 v16, a176
    v_accvgpr_read_b32 v17, a177
    v_mfma_f32_16x16x32_bf16 v[224:227], v[140:143], a[192:195], v[224:227]
    v_accvgpr_read_b32 v18, a178
    v_accvgpr_read_b32 v19, a179
    s_waitcnt lgkmcnt(4)
    v_mfma_f32_16x16x32_bf16 v[64:67], v[144:147], a[192:195], v[64:67]
    ds_read_b64_tr_b16 v[136:137], v59 offset:36864
    v_mul_f32 v12, s101, v12
    v_mfma_f32_16x16x32_bf16 v[68:71], v[144:147], a[196:199], v[68:71]
    ds_read_b64_tr_b16 v[138:139], v59 offset:38912
    v_mul_f32 v13, s101, v13
    v_mfma_f32_16x16x32_bf16 v[72:75], v[144:147], a[200:203], v[72:75]
    v_mul_f32 v14, s101, v14
    v_mul_f32 v15, s101, v15
    v_mfma_f32_16x16x32_bf16 v[76:79], v[144:147], a[204:207], v[76:79]
    v_mul_f32 v16, s101, v16
    v_mul_f32 v17, s101, v17
    v_mfma_f32_16x16x32_bf16 v[80:83], v[144:147], a[208:211], v[80:83]
    v_mul_f32 v18, s101, v18
    v_mul_f32 v19, s101, v19
    v_mfma_f32_16x16x32_bf16 v[84:87], v[144:147], a[212:215], v[84:87]
    v_cvt_pk_bf16_f32 v20, v12, v13
    v_cvt_pk_bf16_f32 v21, v14, v15
    v_mfma_f32_16x16x32_bf16 v[88:91], v[144:147], a[216:219], v[88:91]
    v_cvt_pk_bf16_f32 v22, v16, v17
    v_cvt_pk_bf16_f32 v23, v18, v19
    v_mfma_f32_16x16x32_bf16 v[92:95], v[144:147], a[220:223], v[92:95]
    buffer_store_dwordx4 v[20:23], v185, s[28:31], s100 offen offset:0 sc1
    s_waitcnt lgkmcnt(4)
    v_mfma_f32_16x16x32_bf16 v[124:127], v[128:131], a[220:223], v[124:127]
    ds_read_b64_tr_b16 v[140:141], v58 offset:40960
    v_accvgpr_read_b32 v24, a148
    v_mfma_f32_16x16x32_bf16 v[120:123], v[128:131], a[216:219], v[120:123]
    ds_read_b64_tr_b16 v[142:143], v58 offset:43008
    v_accvgpr_read_b32 v25, a149
    v_mfma_f32_16x16x32_bf16 v[116:119], v[128:131], a[212:215], v[116:119]
    v_accvgpr_read_b32 v26, a150
    v_accvgpr_read_b32 v27, a151
    v_mfma_f32_16x16x32_bf16 v[112:115], v[128:131], a[208:211], v[112:115]
    v_accvgpr_read_b32 v28, a180
    v_accvgpr_read_b32 v29, a181
    v_mfma_f32_16x16x32_bf16 v[108:111], v[128:131], a[204:207], v[108:111]
    v_accvgpr_read_b32 v30, a182
    v_accvgpr_read_b32 v31, a183
    v_mfma_f32_16x16x32_bf16 v[104:107], v[128:131], a[200:203], v[104:107]
    v_mul_f32 v24, s101, v24
    v_mul_f32 v25, s101, v25
    v_mfma_f32_16x16x32_bf16 v[100:103], v[128:131], a[196:199], v[100:103]
    v_mul_f32 v26, s101, v26
    v_mul_f32 v27, s101, v27
    v_mfma_f32_16x16x32_bf16 v[96:99], v[128:131], a[192:195], v[96:99]
    v_mul_f32 v28, s101, v28
    v_mul_f32 v29, s101, v29
    s_waitcnt lgkmcnt(4)
    v_mfma_f32_16x16x32_bf16 v[192:195], v[132:135], a[224:227], v[192:195]
    ds_read_b64_tr_b16 v[144:145], v59 offset:40960
    v_mul_f32 v30, s101, v30
    v_mfma_f32_16x16x32_bf16 v[196:199], v[132:135], a[228:231], v[196:199]
    ds_read_b64_tr_b16 v[146:147], v59 offset:43008
    v_mul_f32 v31, s101, v31
    v_mfma_f32_16x16x32_bf16 v[200:203], v[132:135], a[232:235], v[200:203]
    v_cvt_pk_bf16_f32 v32, v24, v25
    v_cvt_pk_bf16_f32 v33, v26, v27
    v_mfma_f32_16x16x32_bf16 v[204:207], v[132:135], a[236:239], v[204:207]
    v_cvt_pk_bf16_f32 v34, v28, v29
    v_cvt_pk_bf16_f32 v35, v30, v31
    v_mfma_f32_16x16x32_bf16 v[208:211], v[132:135], a[240:243], v[208:211]
    buffer_store_dwordx4 v[32:35], v185, s[28:31], s100 offen offset:1024 sc1
    v_mfma_f32_16x16x32_bf16 v[212:215], v[132:135], a[244:247], v[212:215]
    v_accvgpr_read_b32 v12, a152
    v_accvgpr_read_b32 v13, a153
    v_mfma_f32_16x16x32_bf16 v[216:219], v[132:135], a[248:251], v[216:219]
    v_accvgpr_read_b32 v14, a154
    v_accvgpr_read_b32 v15, a155
    v_mfma_f32_16x16x32_bf16 v[220:223], v[132:135], a[252:255], v[220:223]
    v_accvgpr_read_b32 v16, a184
    v_accvgpr_read_b32 v17, a185
    s_waitcnt lgkmcnt(4)
    v_mfma_f32_16x16x32_bf16 v[252:255], v[136:139], a[252:255], v[252:255]
    v_accvgpr_read_b32 v18, a186
    v_accvgpr_read_b32 v19, a187
    v_mfma_f32_16x16x32_bf16 v[248:251], v[136:139], a[248:251], v[248:251]
    v_mul_f32 v12, s101, v12
    v_mul_f32 v13, s101, v13
    v_mfma_f32_16x16x32_bf16 v[244:247], v[136:139], a[244:247], v[244:247]
    v_mul_f32 v14, s101, v14
    v_mul_f32 v15, s101, v15
    v_mfma_f32_16x16x32_bf16 v[240:243], v[136:139], a[240:243], v[240:243]
    v_mul_f32 v16, s101, v16
    v_mul_f32 v17, s101, v17
    v_mfma_f32_16x16x32_bf16 v[236:239], v[136:139], a[236:239], v[236:239]
    v_mul_f32 v18, s101, v18
    v_mul_f32 v19, s101, v19
    v_mfma_f32_16x16x32_bf16 v[232:235], v[136:139], a[232:235], v[232:235]
    v_cvt_pk_bf16_f32 v20, v12, v13
    v_cvt_pk_bf16_f32 v21, v14, v15
    v_mfma_f32_16x16x32_bf16 v[228:231], v[136:139], a[228:231], v[228:231]
    v_cvt_pk_bf16_f32 v22, v16, v17
    v_cvt_pk_bf16_f32 v23, v18, v19
    v_mfma_f32_16x16x32_bf16 v[224:227], v[136:139], a[224:227], v[224:227]
    buffer_store_dwordx4 v[20:23], v185, s[28:31], s100 offen offset:2048 sc1
    s_waitcnt lgkmcnt(2)
    v_mfma_f32_16x16x32_bf16 v[64:67], v[140:143], a[224:227], v[64:67]
    v_accvgpr_read_b32 v24, a156
    v_accvgpr_read_b32 v25, a157
    v_mfma_f32_16x16x32_bf16 v[68:71], v[140:143], a[228:231], v[68:71]
    v_accvgpr_read_b32 v26, a158
    v_accvgpr_read_b32 v27, a159
    v_mfma_f32_16x16x32_bf16 v[72:75], v[140:143], a[232:235], v[72:75]
    v_accvgpr_read_b32 v28, a188
    v_accvgpr_read_b32 v29, a189
    v_mfma_f32_16x16x32_bf16 v[76:79], v[140:143], a[236:239], v[76:79]
    v_accvgpr_read_b32 v30, a190
    v_accvgpr_read_b32 v31, a191
    v_mfma_f32_16x16x32_bf16 v[80:83], v[140:143], a[240:243], v[80:83]
    v_mul_f32 v24, s101, v24
    v_mul_f32 v25, s101, v25
    v_mfma_f32_16x16x32_bf16 v[84:87], v[140:143], a[244:247], v[84:87]
    v_mul_f32 v26, s101, v26
    v_mul_f32 v27, s101, v27
    v_mfma_f32_16x16x32_bf16 v[88:91], v[140:143], a[248:251], v[88:91]
    v_mul_f32 v28, s101, v28
    v_mul_f32 v29, s101, v29
    v_mfma_f32_16x16x32_bf16 v[92:95], v[140:143], a[252:255], v[92:95]
    v_mul_f32 v30, s101, v30
    v_mul_f32 v31, s101, v31
    s_waitcnt lgkmcnt(0)
    v_mfma_f32_16x16x32_bf16 v[124:127], v[144:147], a[252:255], v[124:127]
    v_cvt_pk_bf16_f32 v32, v24, v25
    v_cvt_pk_bf16_f32 v33, v26, v27
    v_mfma_f32_16x16x32_bf16 v[120:123], v[144:147], a[248:251], v[120:123]
    v_cvt_pk_bf16_f32 v34, v28, v29
    v_cvt_pk_bf16_f32 v35, v30, v31
    v_mfma_f32_16x16x32_bf16 v[116:119], v[144:147], a[244:247], v[116:119]
    buffer_store_dwordx4 v[32:35], v185, s[28:31], s100 offen offset:3072 sc1
    v_mfma_f32_16x16x32_bf16 v[112:115], v[144:147], a[240:243], v[112:115]
    v_mfma_f32_16x16x32_bf16 v[108:111], v[144:147], a[236:239], v[108:111]
    v_mfma_f32_16x16x32_bf16 v[104:107], v[144:147], a[232:235], v[104:107]
    v_mfma_f32_16x16x32_bf16 v[100:103], v[144:147], a[228:231], v[100:103]
    v_mfma_f32_16x16x32_bf16 v[96:99], v[144:147], a[224:227], v[96:99]
    s_barrier
    v_accvgpr_read_b32 v12, a0
    v_accvgpr_read_b32 v13, a1
    v_accvgpr_read_b32 v14, a2
    v_accvgpr_read_b32 v15, a3
    v_accvgpr_read_b32 v16, a32
    v_accvgpr_read_b32 v17, a33
    v_accvgpr_read_b32 v18, a34
    v_accvgpr_read_b32 v19, a35
    v_accvgpr_read_b32 v20, a64
    v_accvgpr_read_b32 v21, a65
    v_accvgpr_read_b32 v22, a66
    v_accvgpr_read_b32 v23, a67
    v_accvgpr_read_b32 v24, a96
    v_accvgpr_read_b32 v25, a97
    v_accvgpr_read_b32 v26, a98
    v_accvgpr_read_b32 v27, a99
    v_pk_mul_f32 v[128:129], v[12:13], v[12:13]
    v_pk_mul_f32 v[130:131], v[14:15], v[14:15]
    v_pk_mul_f32 v[132:133], v[16:17], v[16:17]
    v_pk_mul_f32 v[134:135], v[18:19], v[18:19]
    v_pk_fma_f32 v[128:129], v[128:129], s[50:51], v[154:155]
    v_pk_fma_f32 v[130:131], v[130:131], s[50:51], v[154:155]
    v_pk_fma_f32 v[132:133], v[132:133], s[50:51], v[154:155]
    v_pk_fma_f32 v[134:135], v[134:135], s[50:51], v[154:155]
    v_pk_mul_f32 v[128:129], v[128:129], v[12:13]
    v_pk_mul_f32 v[130:131], v[130:131], v[14:15]
    v_pk_mul_f32 v[132:133], v[132:133], v[16:17]
    v_pk_mul_f32 v[134:135], v[134:135], v[18:19]
    v_exp_f32 v128, v128
    v_exp_f32 v129, v129
    v_exp_f32 v130, v130
    v_exp_f32 v131, v131
    v_exp_f32 v132, v132
    v_exp_f32 v133, v133
    v_exp_f32 v134, v134
    v_exp_f32 v135, v135
    v_pk_mul_f32 v[12:13], v[12:13], v[20:21]
    v_pk_mul_f32 v[14:15], v[14:15], v[22:23]
    v_pk_mul_f32 v[16:17], v[16:17], v[24:25]
    v_pk_mul_f32 v[18:19], v[18:19], v[26:27]
    v_pk_add_f32 v[128:129], v[128:129], 1.0 op_sel_hi:[1,0]
    v_pk_add_f32 v[130:131], v[130:131], 1.0 op_sel_hi:[1,0]
    v_pk_add_f32 v[132:133], v[132:133], 1.0 op_sel_hi:[1,0]
    v_pk_add_f32 v[134:135], v[134:135], 1.0 op_sel_hi:[1,0]
    v_rcp_f32 v128, v128
    v_rcp_f32 v129, v129
    v_rcp_f32 v130, v130
    v_rcp_f32 v131, v131
    v_rcp_f32 v132, v132
    v_rcp_f32 v133, v133
    v_rcp_f32 v134, v134
    v_rcp_f32 v135, v135
    s_nop 0
    v_pk_mul_f32 v[128:129], v[128:129], v[12:13]
    v_pk_mul_f32 v[130:131], v[130:131], v[14:15]
    v_pk_mul_f32 v[132:133], v[132:133], v[16:17]
    v_pk_mul_f32 v[134:135], v[134:135], v[18:19]
    v_cvt_pk_bf16_f32 v28, v128, v129
    v_cvt_pk_bf16_f32 v29, v130, v131
    v_cvt_pk_bf16_f32 v30, v132, v133
    v_cvt_pk_bf16_f32 v31, v134, v135
    buffer_store_dwordx4 v[28:31], v184, s[32:35], s20 offen offset:0 sc1
    s_waitcnt vmcnt(1)
    s_lshl_b32 s49, s49, 5
    v_lshlrev_b32 v157, 2, v0
    v_mov_b32 v158, s76
    s_mov_b32 exec_hi, 0
    buffer_store_dword v158, v157, s[40:43], s49 offen sc1
    s_mov_b64 exec, -1
    v_accvgpr_read_b32 v12, a4
    v_accvgpr_read_b32 v13, a5
    v_accvgpr_read_b32 v14, a6
    v_accvgpr_read_b32 v15, a7
    v_accvgpr_read_b32 v16, a36
    v_accvgpr_read_b32 v17, a37
    v_accvgpr_read_b32 v18, a38
    v_accvgpr_read_b32 v19, a39
    v_accvgpr_read_b32 v20, a68
    v_accvgpr_read_b32 v21, a69
    v_accvgpr_read_b32 v22, a70
    v_accvgpr_read_b32 v23, a71
    v_accvgpr_read_b32 v24, a100
    v_accvgpr_read_b32 v25, a101
    v_accvgpr_read_b32 v26, a102
    v_accvgpr_read_b32 v27, a103
    v_pk_mul_f32 v[136:137], v[12:13], v[12:13]
    v_pk_mul_f32 v[138:139], v[14:15], v[14:15]
    v_pk_mul_f32 v[140:141], v[16:17], v[16:17]
    v_pk_mul_f32 v[142:143], v[18:19], v[18:19]
    v_pk_fma_f32 v[136:137], v[136:137], s[50:51], v[154:155]
    v_pk_fma_f32 v[138:139], v[138:139], s[50:51], v[154:155]
    v_pk_fma_f32 v[140:141], v[140:141], s[50:51], v[154:155]
    v_pk_fma_f32 v[142:143], v[142:143], s[50:51], v[154:155]
    v_pk_mul_f32 v[136:137], v[136:137], v[12:13]
    v_pk_mul_f32 v[138:139], v[138:139], v[14:15]
    v_pk_mul_f32 v[140:141], v[140:141], v[16:17]
    v_pk_mul_f32 v[142:143], v[142:143], v[18:19]
    v_exp_f32 v136, v136
    v_exp_f32 v137, v137
    v_exp_f32 v138, v138
    v_exp_f32 v139, v139
    v_exp_f32 v140, v140
    v_exp_f32 v141, v141
    v_exp_f32 v142, v142
    v_exp_f32 v143, v143
    v_pk_mul_f32 v[12:13], v[12:13], v[20:21]
    v_pk_mul_f32 v[14:15], v[14:15], v[22:23]
    v_pk_mul_f32 v[16:17], v[16:17], v[24:25]
    v_pk_mul_f32 v[18:19], v[18:19], v[26:27]
    v_pk_add_f32 v[136:137], v[136:137], 1.0 op_sel_hi:[1,0]
    v_pk_add_f32 v[138:139], v[138:139], 1.0 op_sel_hi:[1,0]
    v_pk_add_f32 v[140:141], v[140:141], 1.0 op_sel_hi:[1,0]
    v_pk_add_f32 v[142:143], v[142:143], 1.0 op_sel_hi:[1,0]
    v_rcp_f32 v136, v136
    v_rcp_f32 v137, v137
    v_rcp_f32 v138, v138
    v_rcp_f32 v139, v139
    v_rcp_f32 v140, v140
    v_rcp_f32 v141, v141
    v_rcp_f32 v142, v142
    v_rcp_f32 v143, v143
    s_nop 0
    v_pk_mul_f32 v[136:137], v[136:137], v[12:13]
    v_pk_mul_f32 v[138:139], v[138:139], v[14:15]
    v_pk_mul_f32 v[140:141], v[140:141], v[16:17]
    v_pk_mul_f32 v[142:143], v[142:143], v[18:19]
    v_cvt_pk_bf16_f32 v32, v136, v137
    v_cvt_pk_bf16_f32 v33, v138, v139
    v_cvt_pk_bf16_f32 v34, v140, v141
    v_cvt_pk_bf16_f32 v35, v142, v143
    buffer_store_dwordx4 v[32:35], v184, s[32:35], s20 offen offset:1024 sc1
    v_accvgpr_read_b32 v12, a8
    v_accvgpr_read_b32 v13, a9
    v_accvgpr_read_b32 v14, a10
    v_accvgpr_read_b32 v15, a11
    v_accvgpr_read_b32 v16, a40
    v_accvgpr_read_b32 v17, a41
    v_accvgpr_read_b32 v18, a42
    v_accvgpr_read_b32 v19, a43
    v_accvgpr_read_b32 v20, a72
    v_accvgpr_read_b32 v21, a73
    v_accvgpr_read_b32 v22, a74
    v_accvgpr_read_b32 v23, a75
    v_accvgpr_read_b32 v24, a104
    v_accvgpr_read_b32 v25, a105
    v_accvgpr_read_b32 v26, a106
    v_accvgpr_read_b32 v27, a107
    v_pk_mul_f32 v[128:129], v[12:13], v[12:13]
    v_pk_mul_f32 v[130:131], v[14:15], v[14:15]
    v_pk_mul_f32 v[132:133], v[16:17], v[16:17]
    v_pk_mul_f32 v[134:135], v[18:19], v[18:19]
    v_pk_fma_f32 v[128:129], v[128:129], s[50:51], v[154:155]
    v_pk_fma_f32 v[130:131], v[130:131], s[50:51], v[154:155]
    v_pk_fma_f32 v[132:133], v[132:133], s[50:51], v[154:155]
    v_pk_fma_f32 v[134:135], v[134:135], s[50:51], v[154:155]
    v_pk_mul_f32 v[128:129], v[128:129], v[12:13]
    v_pk_mul_f32 v[130:131], v[130:131], v[14:15]
    v_pk_mul_f32 v[132:133], v[132:133], v[16:17]
    v_pk_mul_f32 v[134:135], v[134:135], v[18:19]
    v_exp_f32 v128, v128
    v_exp_f32 v129, v129
    v_exp_f32 v130, v130
    v_exp_f32 v131, v131
    v_exp_f32 v132, v132
    v_exp_f32 v133, v133
    v_exp_f32 v134, v134
    v_exp_f32 v135, v135
    v_pk_mul_f32 v[12:13], v[12:13], v[20:21]
    v_pk_mul_f32 v[14:15], v[14:15], v[22:23]
    v_pk_mul_f32 v[16:17], v[16:17], v[24:25]
    v_pk_mul_f32 v[18:19], v[18:19], v[26:27]
    v_pk_add_f32 v[128:129], v[128:129], 1.0 op_sel_hi:[1,0]
    v_pk_add_f32 v[130:131], v[130:131], 1.0 op_sel_hi:[1,0]
    v_pk_add_f32 v[132:133], v[132:133], 1.0 op_sel_hi:[1,0]
    v_pk_add_f32 v[134:135], v[134:135], 1.0 op_sel_hi:[1,0]
    v_rcp_f32 v128, v128
    v_rcp_f32 v129, v129
    v_rcp_f32 v130, v130
    v_rcp_f32 v131, v131
    v_rcp_f32 v132, v132
    v_rcp_f32 v133, v133
    v_rcp_f32 v134, v134
    v_rcp_f32 v135, v135
    s_nop 0
    v_pk_mul_f32 v[128:129], v[128:129], v[12:13]
    v_pk_mul_f32 v[130:131], v[130:131], v[14:15]
    v_pk_mul_f32 v[132:133], v[132:133], v[16:17]
    v_pk_mul_f32 v[134:135], v[134:135], v[18:19]
    v_cvt_pk_bf16_f32 v28, v128, v129
    v_cvt_pk_bf16_f32 v29, v130, v131
    v_cvt_pk_bf16_f32 v30, v132, v133
    v_cvt_pk_bf16_f32 v31, v134, v135
    buffer_store_dwordx4 v[28:31], v184, s[32:35], s20 offen offset:2048 sc1
    v_accvgpr_read_b32 v12, a12
    v_accvgpr_read_b32 v13, a13
    v_accvgpr_read_b32 v14, a14
    v_accvgpr_read_b32 v15, a15
    v_accvgpr_read_b32 v16, a44
    v_accvgpr_read_b32 v17, a45
    v_accvgpr_read_b32 v18, a46
    v_accvgpr_read_b32 v19, a47
    v_accvgpr_read_b32 v20, a76
    v_accvgpr_read_b32 v21, a77
    v_accvgpr_read_b32 v22, a78
    v_accvgpr_read_b32 v23, a79
    v_accvgpr_read_b32 v24, a108
    v_accvgpr_read_b32 v25, a109
    v_accvgpr_read_b32 v26, a110
    v_accvgpr_read_b32 v27, a111
    v_pk_mul_f32 v[136:137], v[12:13], v[12:13]
    v_pk_mul_f32 v[138:139], v[14:15], v[14:15]
    v_pk_mul_f32 v[140:141], v[16:17], v[16:17]
    v_pk_mul_f32 v[142:143], v[18:19], v[18:19]
    v_pk_fma_f32 v[136:137], v[136:137], s[50:51], v[154:155]
    v_pk_fma_f32 v[138:139], v[138:139], s[50:51], v[154:155]
    v_pk_fma_f32 v[140:141], v[140:141], s[50:51], v[154:155]
    v_pk_fma_f32 v[142:143], v[142:143], s[50:51], v[154:155]
    v_pk_mul_f32 v[136:137], v[136:137], v[12:13]
    v_pk_mul_f32 v[138:139], v[138:139], v[14:15]
    v_pk_mul_f32 v[140:141], v[140:141], v[16:17]
    v_pk_mul_f32 v[142:143], v[142:143], v[18:19]
    v_exp_f32 v136, v136
    v_exp_f32 v137, v137
    v_exp_f32 v138, v138
    v_exp_f32 v139, v139
    v_exp_f32 v140, v140
    v_exp_f32 v141, v141
    v_exp_f32 v142, v142
    v_exp_f32 v143, v143
    v_pk_mul_f32 v[12:13], v[12:13], v[20:21]
    v_pk_mul_f32 v[14:15], v[14:15], v[22:23]
    v_pk_mul_f32 v[16:17], v[16:17], v[24:25]
    v_pk_mul_f32 v[18:19], v[18:19], v[26:27]
    v_pk_add_f32 v[136:137], v[136:137], 1.0 op_sel_hi:[1,0]
    v_pk_add_f32 v[138:139], v[138:139], 1.0 op_sel_hi:[1,0]
    v_pk_add_f32 v[140:141], v[140:141], 1.0 op_sel_hi:[1,0]
    v_pk_add_f32 v[142:143], v[142:143], 1.0 op_sel_hi:[1,0]
    v_rcp_f32 v136, v136
    v_rcp_f32 v137, v137
    v_rcp_f32 v138, v138
    v_rcp_f32 v139, v139
    v_rcp_f32 v140, v140
    v_rcp_f32 v141, v141
    v_rcp_f32 v142, v142
    v_rcp_f32 v143, v143
    s_nop 0
    v_pk_mul_f32 v[136:137], v[136:137], v[12:13]
    v_pk_mul_f32 v[138:139], v[138:139], v[14:15]
    v_pk_mul_f32 v[140:141], v[140:141], v[16:17]
    v_pk_mul_f32 v[142:143], v[142:143], v[18:19]
    v_cvt_pk_bf16_f32 v32, v136, v137
    v_cvt_pk_bf16_f32 v33, v138, v139
    v_cvt_pk_bf16_f32 v34, v140, v141
    v_cvt_pk_bf16_f32 v35, v142, v143
    buffer_store_dwordx4 v[32:35], v184, s[32:35], s20 offen offset:3072 sc1
    v_accvgpr_read_b32 v12, a16
    v_accvgpr_read_b32 v13, a17
    v_accvgpr_read_b32 v14, a18
    v_accvgpr_read_b32 v15, a19
    v_accvgpr_read_b32 v16, a48
    v_accvgpr_read_b32 v17, a49
    v_accvgpr_read_b32 v18, a50
    v_accvgpr_read_b32 v19, a51
    v_accvgpr_read_b32 v20, a80
    v_accvgpr_read_b32 v21, a81
    v_accvgpr_read_b32 v22, a82
    v_accvgpr_read_b32 v23, a83
    v_accvgpr_read_b32 v24, a112
    v_accvgpr_read_b32 v25, a113
    v_accvgpr_read_b32 v26, a114
    v_accvgpr_read_b32 v27, a115
    v_pk_mul_f32 v[128:129], v[12:13], v[12:13]
    v_pk_mul_f32 v[130:131], v[14:15], v[14:15]
    v_pk_mul_f32 v[132:133], v[16:17], v[16:17]
    v_pk_mul_f32 v[134:135], v[18:19], v[18:19]
    v_pk_fma_f32 v[128:129], v[128:129], s[50:51], v[154:155]
    v_pk_fma_f32 v[130:131], v[130:131], s[50:51], v[154:155]
    v_pk_fma_f32 v[132:133], v[132:133], s[50:51], v[154:155]
    v_pk_fma_f32 v[134:135], v[134:135], s[50:51], v[154:155]
    v_pk_mul_f32 v[128:129], v[128:129], v[12:13]
    v_pk_mul_f32 v[130:131], v[130:131], v[14:15]
    v_pk_mul_f32 v[132:133], v[132:133], v[16:17]
    v_pk_mul_f32 v[134:135], v[134:135], v[18:19]
    v_exp_f32 v128, v128
    v_exp_f32 v129, v129
    v_exp_f32 v130, v130
    v_exp_f32 v131, v131
    v_exp_f32 v132, v132
    v_exp_f32 v133, v133
    v_exp_f32 v134, v134
    v_exp_f32 v135, v135
    v_pk_mul_f32 v[12:13], v[12:13], v[20:21]
    v_pk_mul_f32 v[14:15], v[14:15], v[22:23]
    v_pk_mul_f32 v[16:17], v[16:17], v[24:25]
    v_pk_mul_f32 v[18:19], v[18:19], v[26:27]
    v_pk_add_f32 v[128:129], v[128:129], 1.0 op_sel_hi:[1,0]
    v_pk_add_f32 v[130:131], v[130:131], 1.0 op_sel_hi:[1,0]
    v_pk_add_f32 v[132:133], v[132:133], 1.0 op_sel_hi:[1,0]
    v_pk_add_f32 v[134:135], v[134:135], 1.0 op_sel_hi:[1,0]
    v_rcp_f32 v128, v128
    v_rcp_f32 v129, v129
    v_rcp_f32 v130, v130
    v_rcp_f32 v131, v131
    v_rcp_f32 v132, v132
    v_rcp_f32 v133, v133
    v_rcp_f32 v134, v134
    v_rcp_f32 v135, v135
    s_nop 0
    v_pk_mul_f32 v[128:129], v[128:129], v[12:13]
    v_pk_mul_f32 v[130:131], v[130:131], v[14:15]
    v_pk_mul_f32 v[132:133], v[132:133], v[16:17]
    v_pk_mul_f32 v[134:135], v[134:135], v[18:19]
    v_cvt_pk_bf16_f32 v28, v128, v129
    v_cvt_pk_bf16_f32 v29, v130, v131
    v_cvt_pk_bf16_f32 v30, v132, v133
    v_cvt_pk_bf16_f32 v31, v134, v135
    buffer_store_dwordx4 v[28:31], v185, s[32:35], s20 offen offset:0 sc1
    v_accvgpr_read_b32 v12, a20
    v_accvgpr_read_b32 v13, a21
    v_accvgpr_read_b32 v14, a22
    v_accvgpr_read_b32 v15, a23
    v_accvgpr_read_b32 v16, a52
    v_accvgpr_read_b32 v17, a53
    v_accvgpr_read_b32 v18, a54
    v_accvgpr_read_b32 v19, a55
    v_accvgpr_read_b32 v20, a84
    v_accvgpr_read_b32 v21, a85
    v_accvgpr_read_b32 v22, a86
    v_accvgpr_read_b32 v23, a87
    v_accvgpr_read_b32 v24, a116
    v_accvgpr_read_b32 v25, a117
    v_accvgpr_read_b32 v26, a118
    v_accvgpr_read_b32 v27, a119
    v_pk_mul_f32 v[136:137], v[12:13], v[12:13]
    v_pk_mul_f32 v[138:139], v[14:15], v[14:15]
    v_pk_mul_f32 v[140:141], v[16:17], v[16:17]
    v_pk_mul_f32 v[142:143], v[18:19], v[18:19]
    v_pk_fma_f32 v[136:137], v[136:137], s[50:51], v[154:155]
    v_pk_fma_f32 v[138:139], v[138:139], s[50:51], v[154:155]
    v_pk_fma_f32 v[140:141], v[140:141], s[50:51], v[154:155]
    v_pk_fma_f32 v[142:143], v[142:143], s[50:51], v[154:155]
    v_pk_mul_f32 v[136:137], v[136:137], v[12:13]
    v_pk_mul_f32 v[138:139], v[138:139], v[14:15]
    v_pk_mul_f32 v[140:141], v[140:141], v[16:17]
    v_pk_mul_f32 v[142:143], v[142:143], v[18:19]
    v_exp_f32 v136, v136
    v_exp_f32 v137, v137
    v_exp_f32 v138, v138
    v_exp_f32 v139, v139
    v_exp_f32 v140, v140
    v_exp_f32 v141, v141
    v_exp_f32 v142, v142
    v_exp_f32 v143, v143
    v_pk_mul_f32 v[12:13], v[12:13], v[20:21]
    v_pk_mul_f32 v[14:15], v[14:15], v[22:23]
    v_pk_mul_f32 v[16:17], v[16:17], v[24:25]
    v_pk_mul_f32 v[18:19], v[18:19], v[26:27]
    v_pk_add_f32 v[136:137], v[136:137], 1.0 op_sel_hi:[1,0]
    v_pk_add_f32 v[138:139], v[138:139], 1.0 op_sel_hi:[1,0]
    v_pk_add_f32 v[140:141], v[140:141], 1.0 op_sel_hi:[1,0]
    v_pk_add_f32 v[142:143], v[142:143], 1.0 op_sel_hi:[1,0]
    v_rcp_f32 v136, v136
    v_rcp_f32 v137, v137
    v_rcp_f32 v138, v138
    v_rcp_f32 v139, v139
    v_rcp_f32 v140, v140
    v_rcp_f32 v141, v141
    v_rcp_f32 v142, v142
    v_rcp_f32 v143, v143
    s_nop 0
    v_pk_mul_f32 v[136:137], v[136:137], v[12:13]
    v_pk_mul_f32 v[138:139], v[138:139], v[14:15]
    v_pk_mul_f32 v[140:141], v[140:141], v[16:17]
    v_pk_mul_f32 v[142:143], v[142:143], v[18:19]
    v_cvt_pk_bf16_f32 v32, v136, v137
    v_cvt_pk_bf16_f32 v33, v138, v139
    v_cvt_pk_bf16_f32 v34, v140, v141
    v_cvt_pk_bf16_f32 v35, v142, v143
    buffer_store_dwordx4 v[32:35], v185, s[32:35], s20 offen offset:1024 sc1
    v_accvgpr_read_b32 v12, a24
    v_accvgpr_read_b32 v13, a25
    v_accvgpr_read_b32 v14, a26
    v_accvgpr_read_b32 v15, a27
    v_accvgpr_read_b32 v16, a56
    v_accvgpr_read_b32 v17, a57
    v_accvgpr_read_b32 v18, a58
    v_accvgpr_read_b32 v19, a59
    v_accvgpr_read_b32 v20, a88
    v_accvgpr_read_b32 v21, a89
    v_accvgpr_read_b32 v22, a90
    v_accvgpr_read_b32 v23, a91
    v_accvgpr_read_b32 v24, a120
    v_accvgpr_read_b32 v25, a121
    v_accvgpr_read_b32 v26, a122
    v_accvgpr_read_b32 v27, a123
    v_pk_mul_f32 v[128:129], v[12:13], v[12:13]
    v_pk_mul_f32 v[130:131], v[14:15], v[14:15]
    v_pk_mul_f32 v[132:133], v[16:17], v[16:17]
    v_pk_mul_f32 v[134:135], v[18:19], v[18:19]
    v_pk_fma_f32 v[128:129], v[128:129], s[50:51], v[154:155]
    v_pk_fma_f32 v[130:131], v[130:131], s[50:51], v[154:155]
    v_pk_fma_f32 v[132:133], v[132:133], s[50:51], v[154:155]
    v_pk_fma_f32 v[134:135], v[134:135], s[50:51], v[154:155]
    v_pk_mul_f32 v[128:129], v[128:129], v[12:13]
    v_pk_mul_f32 v[130:131], v[130:131], v[14:15]
    v_pk_mul_f32 v[132:133], v[132:133], v[16:17]
    v_pk_mul_f32 v[134:135], v[134:135], v[18:19]
    v_exp_f32 v128, v128
    v_exp_f32 v129, v129
    v_exp_f32 v130, v130
    v_exp_f32 v131, v131
    v_exp_f32 v132, v132
    v_exp_f32 v133, v133
    v_exp_f32 v134, v134
    v_exp_f32 v135, v135
    v_pk_mul_f32 v[12:13], v[12:13], v[20:21]
    v_pk_mul_f32 v[14:15], v[14:15], v[22:23]
    v_pk_mul_f32 v[16:17], v[16:17], v[24:25]
    v_pk_mul_f32 v[18:19], v[18:19], v[26:27]
    v_pk_add_f32 v[128:129], v[128:129], 1.0 op_sel_hi:[1,0]
    v_pk_add_f32 v[130:131], v[130:131], 1.0 op_sel_hi:[1,0]
    v_pk_add_f32 v[132:133], v[132:133], 1.0 op_sel_hi:[1,0]
    v_pk_add_f32 v[134:135], v[134:135], 1.0 op_sel_hi:[1,0]
    v_rcp_f32 v128, v128
    v_rcp_f32 v129, v129
    v_rcp_f32 v130, v130
    v_rcp_f32 v131, v131
    v_rcp_f32 v132, v132
    v_rcp_f32 v133, v133
    v_rcp_f32 v134, v134
    v_rcp_f32 v135, v135
    s_nop 0
    v_pk_mul_f32 v[128:129], v[128:129], v[12:13]
    v_pk_mul_f32 v[130:131], v[130:131], v[14:15]
    v_pk_mul_f32 v[132:133], v[132:133], v[16:17]
    v_pk_mul_f32 v[134:135], v[134:135], v[18:19]
    v_cvt_pk_bf16_f32 v28, v128, v129
    v_cvt_pk_bf16_f32 v29, v130, v131
    v_cvt_pk_bf16_f32 v30, v132, v133
    v_cvt_pk_bf16_f32 v31, v134, v135
    buffer_store_dwordx4 v[28:31], v185, s[32:35], s20 offen offset:2048 sc1
    v_accvgpr_read_b32 v12, a28
    v_accvgpr_read_b32 v13, a29
    v_accvgpr_read_b32 v14, a30
    v_accvgpr_read_b32 v15, a31
    v_accvgpr_read_b32 v16, a60
    v_accvgpr_read_b32 v17, a61
    v_accvgpr_read_b32 v18, a62
    v_accvgpr_read_b32 v19, a63
    v_accvgpr_read_b32 v20, a92
    v_accvgpr_read_b32 v21, a93
    v_accvgpr_read_b32 v22, a94
    v_accvgpr_read_b32 v23, a95
    v_accvgpr_read_b32 v24, a124
    v_accvgpr_read_b32 v25, a125
    v_accvgpr_read_b32 v26, a126
    v_accvgpr_read_b32 v27, a127
    v_pk_mul_f32 v[136:137], v[12:13], v[12:13]
    v_pk_mul_f32 v[138:139], v[14:15], v[14:15]
    v_pk_mul_f32 v[140:141], v[16:17], v[16:17]
    v_pk_mul_f32 v[142:143], v[18:19], v[18:19]
    v_pk_fma_f32 v[136:137], v[136:137], s[50:51], v[154:155]
    v_pk_fma_f32 v[138:139], v[138:139], s[50:51], v[154:155]
    v_pk_fma_f32 v[140:141], v[140:141], s[50:51], v[154:155]
    v_pk_fma_f32 v[142:143], v[142:143], s[50:51], v[154:155]
    v_pk_mul_f32 v[136:137], v[136:137], v[12:13]
    v_pk_mul_f32 v[138:139], v[138:139], v[14:15]
    v_pk_mul_f32 v[140:141], v[140:141], v[16:17]
    v_pk_mul_f32 v[142:143], v[142:143], v[18:19]
    v_exp_f32 v136, v136
    v_exp_f32 v137, v137
    v_exp_f32 v138, v138
    v_exp_f32 v139, v139
    v_exp_f32 v140, v140
    v_exp_f32 v141, v141
    v_exp_f32 v142, v142
    v_exp_f32 v143, v143
    v_pk_mul_f32 v[12:13], v[12:13], v[20:21]
    v_pk_mul_f32 v[14:15], v[14:15], v[22:23]
    v_pk_mul_f32 v[16:17], v[16:17], v[24:25]
    v_pk_mul_f32 v[18:19], v[18:19], v[26:27]
    v_pk_add_f32 v[136:137], v[136:137], 1.0 op_sel_hi:[1,0]
    v_pk_add_f32 v[138:139], v[138:139], 1.0 op_sel_hi:[1,0]
    v_pk_add_f32 v[140:141], v[140:141], 1.0 op_sel_hi:[1,0]
    v_pk_add_f32 v[142:143], v[142:143], 1.0 op_sel_hi:[1,0]
    v_rcp_f32 v136, v136
    v_rcp_f32 v137, v137
    v_rcp_f32 v138, v138
    v_rcp_f32 v139, v139
    v_rcp_f32 v140, v140
    v_rcp_f32 v141, v141
    v_rcp_f32 v142, v142
    v_rcp_f32 v143, v143
    s_nop 0
    v_pk_mul_f32 v[136:137], v[136:137], v[12:13]
    v_pk_mul_f32 v[138:139], v[138:139], v[14:15]
    v_pk_mul_f32 v[140:141], v[140:141], v[16:17]
    v_pk_mul_f32 v[142:143], v[142:143], v[18:19]
    v_cvt_pk_bf16_f32 v32, v136, v137
    v_cvt_pk_bf16_f32 v33, v138, v139
    v_cvt_pk_bf16_f32 v34, v140, v141
    v_cvt_pk_bf16_f32 v35, v142, v143
    buffer_store_dwordx4 v[32:35], v185, s[32:35], s20 offen offset:3072 sc1
    s_branch L_g1_epiD
L_g1_lastC:
    s_waitcnt lgkmcnt(4)
    v_mfma_f32_16x16x32_bf16 a[124:127], v[136:139], a[252:255], a[124:127]
    ds_read_b64_tr_b16 v[128:129], v58 offset:45056
    v_accvgpr_read_b32 v12, a128
    v_accvgpr_read_b32 v13, a129
    v_accvgpr_read_b32 v14, a130
    v_accvgpr_read_b32 v15, a131
    v_accvgpr_read_b32 v16, a160
    v_mfma_f32_16x16x32_bf16 a[120:123], v[136:139], a[248:251], a[120:123]
    ds_read_b64_tr_b16 v[130:131], v58 offset:47104
    v_accvgpr_read_b32 v17, a161
    v_accvgpr_read_b32 v18, a162
    v_accvgpr_read_b32 v19, a163
    v_cvt_pk_bf16_f32 v20, v12, v13
    v_cvt_pk_bf16_f32 v21, v14, v15
    v_mfma_f32_16x16x32_bf16 a[116:119], v[136:139], a[244:247], a[116:119]
    v_cvt_pk_bf16_f32 v22, v16, v17
    v_cvt_pk_bf16_f32 v23, v18, v19
    v_mfma_f32_16x16x32_bf16 a[112:115], v[136:139], a[240:243], a[112:115]
    buffer_store_dwordx4 v[20:23], v184, s[28:31], s100 offen offset:0 sc1
    v_accvgpr_read_b32 v24, a132
    v_accvgpr_read_b32 v25, a133
    v_accvgpr_read_b32 v26, a134
    v_accvgpr_read_b32 v27, a135
    v_mfma_f32_16x16x32_bf16 a[108:111], v[136:139], a[236:239], a[108:111]
    v_accvgpr_read_b32 v28, a164
    v_accvgpr_read_b32 v29, a165
    v_accvgpr_read_b32 v30, a166
    v_accvgpr_read_b32 v31, a167
    v_cvt_pk_bf16_f32 v32, v24, v25
    v_cvt_pk_bf16_f32 v33, v26, v27
    v_mfma_f32_16x16x32_bf16 a[104:107], v[136:139], a[232:235], a[104:107]
    v_cvt_pk_bf16_f32 v34, v28, v29
    v_cvt_pk_bf16_f32 v35, v30, v31
    v_mfma_f32_16x16x32_bf16 a[100:103], v[136:139], a[228:231], a[100:103]
    buffer_store_dwordx4 v[32:35], v184, s[28:31], s100 offen offset:1024 sc1
    v_accvgpr_read_b32 v12, a136
    v_accvgpr_read_b32 v13, a137
    v_accvgpr_read_b32 v14, a138
    v_accvgpr_read_b32 v15, a139
    v_mfma_f32_16x16x32_bf16 a[96:99], v[136:139], a[224:227], a[96:99]
    v_accvgpr_read_b32 v16, a168
    v_accvgpr_read_b32 v17, a169
    v_accvgpr_read_b32 v18, a170
    v_accvgpr_read_b32 v19, a171
    v_cvt_pk_bf16_f32 v20, v12, v13
    v_cvt_pk_bf16_f32 v21, v14, v15
    s_waitcnt lgkmcnt(4)
    v_mfma_f32_16x16x32_bf16 a[0:3], v[140:143], a[192:195], a[0:3]
    ds_read_b64_tr_b16 v[132:133], v59 offset:45056
    v_cvt_pk_bf16_f32 v22, v16, v17
    v_cvt_pk_bf16_f32 v23, v18, v19
    v_mfma_f32_16x16x32_bf16 a[4:7], v[140:143], a[196:199], a[4:7]
    ds_read_b64_tr_b16 v[134:135], v59 offset:47104
    buffer_store_dwordx4 v[20:23], v184, s[28:31], s100 offen offset:2048 sc1
    v_accvgpr_read_b32 v24, a140
    v_accvgpr_read_b32 v25, a141
    v_accvgpr_read_b32 v26, a142
    v_mfma_f32_16x16x32_bf16 a[8:11], v[140:143], a[200:203], a[8:11]
    v_accvgpr_read_b32 v27, a143
    v_accvgpr_read_b32 v28, a172
    v_accvgpr_read_b32 v29, a173
    v_accvgpr_read_b32 v30, a174
    v_accvgpr_read_b32 v31, a175
    v_cvt_pk_bf16_f32 v32, v24, v25
    v_mfma_f32_16x16x32_bf16 a[12:15], v[140:143], a[204:207], a[12:15]
    v_cvt_pk_bf16_f32 v33, v26, v27
    v_cvt_pk_bf16_f32 v34, v28, v29
    v_cvt_pk_bf16_f32 v35, v30, v31
    v_mfma_f32_16x16x32_bf16 a[16:19], v[140:143], a[208:211], a[16:19]
    buffer_store_dwordx4 v[32:35], v184, s[28:31], s100 offen offset:3072 sc1
    v_accvgpr_read_b32 v12, a144
    v_accvgpr_read_b32 v13, a145
    v_accvgpr_read_b32 v14, a146
    v_accvgpr_read_b32 v15, a147
    v_mfma_f32_16x16x32_bf16 a[20:23], v[140:143], a[212:215], a[20:23]
    v_accvgpr_read_b32 v16, a176
    v_accvgpr_read_b32 v17, a177
    v_accvgpr_read_b32 v18, a178
    v_accvgpr_read_b32 v19, a179
    v_cvt_pk_bf16_f32 v20, v12, v13
    v_cvt_pk_bf16_f32 v21, v14, v15
    v_mfma_f32_16x16x32_bf16 a[24:27], v[140:143], a[216:219], a[24:27]
    v_cvt_pk_bf16_f32 v22, v16, v17
    v_cvt_pk_bf16_f32 v23, v18, v19
    v_mfma_f32_16x16x32_bf16 a[28:31], v[140:143], a[220:223], a[28:31]
    buffer_store_dwordx4 v[20:23], v185, s[28:31], s100 offen offset:0 sc1
    v_accvgpr_read_b32 v24, a148
    v_accvgpr_read_b32 v25, a149
    v_accvgpr_read_b32 v26, a150
    v_accvgpr_read_b32 v27, a151
    s_waitcnt lgkmcnt(4)
    v_mfma_f32_16x16x32_bf16 a[60:63], v[144:147], a[220:223], a[60:63]
    ds_read_b64_tr_b16 v[136:137], v58 offset:0
    v_accvgpr_read_b32 v28, a180
    v_accvgpr_read_b32 v29, a181
    v_accvgpr_read_b32 v30, a182
    v_accvgpr_read_b32 v31, a183
    v_cvt_pk_bf16_f32 v32, v24, v25
    v_mfma_f32_16x16x32_bf16 a[56:59], v[144:147], a[216:219], a[56:59]
    ds_read_b64_tr_b16 v[138:139], v58 offset:2048
    v_cvt_pk_bf16_f32 v33, v26, v27
    v_cvt_pk_bf16_f32 v34, v28, v29
    v_cvt_pk_bf16_f32 v35, v30, v31
    v_mfma_f32_16x16x32_bf16 a[52:55], v[144:147], a[212:215], a[52:55]
    buffer_store_dwordx4 v[32:35], v185, s[28:31], s100 offen offset:1024 sc1
    v_accvgpr_read_b32 v12, a152
    v_accvgpr_read_b32 v13, a153
    v_accvgpr_read_b32 v14, a154
    v_accvgpr_read_b32 v15, a155
    v_mfma_f32_16x16x32_bf16 a[48:51], v[144:147], a[208:211], a[48:51]
    v_accvgpr_read_b32 v16, a184
    v_accvgpr_read_b32 v17, a185
    v_accvgpr_read_b32 v18, a186
    v_accvgpr_read_b32 v19, a187
    v_cvt_pk_bf16_f32 v20, v12, v13
    v_cvt_pk_bf16_f32 v21, v14, v15
    v_mfma_f32_16x16x32_bf16 a[44:47], v[144:147], a[204:207], a[44:47]
    v_cvt_pk_bf16_f32 v22, v16, v17
    v_cvt_pk_bf16_f32 v23, v18, v19
    v_mfma_f32_16x16x32_bf16 a[40:43], v[144:147], a[200:203], a[40:43]
    buffer_store_dwordx4 v[20:23], v185, s[28:31], s100 offen offset:2048 sc1
    v_accvgpr_read_b32 v24, a156
    v_accvgpr_read_b32 v25, a157
    v_accvgpr_read_b32 v26, a158
    v_accvgpr_read_b32 v27, a159
    v_mfma_f32_16x16x32_bf16 a[36:39], v[144:147], a[196:199], a[36:39]
    v_accvgpr_read_b32 v28, a188
    v_accvgpr_read_b32 v29, a189
    v_accvgpr_read_b32 v30, a190
    v_accvgpr_read_b32 v31, a191
    v_cvt_pk_bf16_f32 v32, v24, v25
    v_cvt_pk_bf16_f32 v33, v26, v27
    v_mfma_f32_16x16x32_bf16 a[32:35], v[144:147], a[192:195], a[32:35]
    v_cvt_pk_bf16_f32 v34, v28, v29
    v_cvt_pk_bf16_f32 v35, v30, v31
    s_waitcnt lgkmcnt(4)
    v_mfma_f32_16x16x32_bf16 a[0:3], v[128:131], a[224:227], a[0:3]
    ds_read_b64_tr_b16 v[140:141], v59 offset:0
    buffer_store_dwordx4 v[32:35], v185, s[28:31], s100 offen offset:3072 sc1
    s_sub_u32 s100, s100, 262144
    v_accvgpr_read_b32 v12, a64
    v_accvgpr_read_b32 v13, a65
    v_mfma_f32_16x16x32_bf16 a[4:7], v[128:131], a[228:231], a[4:7]
    ds_read_b64_tr_b16 v[142:143], v59 offset:2048
    v_accvgpr_read_b32 v14, a66
    v_accvgpr_read_b32 v15, a67
    v_accvgpr_read_b32 v16, a96
    v_accvgpr_read_b32 v17, a97
    v_accvgpr_read_b32 v18, a98
    v_mfma_f32_16x16x32_bf16 a[8:11], v[128:131], a[232:235], a[8:11]
    v_accvgpr_read_b32 v19, a99
    v_cvt_pk_bf16_f32 v20, v12, v13
    v_cvt_pk_bf16_f32 v21, v14, v15
    v_cvt_pk_bf16_f32 v22, v16, v17
    v_cvt_pk_bf16_f32 v23, v18, v19
    v_mfma_f32_16x16x32_bf16 a[12:15], v[128:131], a[236:239], a[12:15]
    buffer_store_dwordx4 v[20:23], v184, s[28:31], s100 offen offset:0 sc1
    v_accvgpr_read_b32 v24, a68
    v_accvgpr_read_b32 v25, a69
    v_accvgpr_read_b32 v26, a70
    v_accvgpr_read_b32 v27, a71
    v_mfma_f32_16x16x32_bf16 a[16:19], v[128:131], a[240:243], a[16:19]
    v_accvgpr_read_b32 v28, a100
    v_accvgpr_read_b32 v29, a101
    v_accvgpr_read_b32 v30, a102
    v_accvgpr_read_b32 v31, a103
    v_cvt_pk_bf16_f32 v32, v24, v25
    v_cvt_pk_bf16_f32 v33, v26, v27
    v_mfma_f32_16x16x32_bf16 a[20:23], v[128:131], a[244:247], a[20:23]
    v_cvt_pk_bf16_f32 v34, v28, v29
    v_cvt_pk_bf16_f32 v35, v30, v31
    v_mfma_f32_16x16x32_bf16 a[24:27], v[128:131], a[248:251], a[24:27]
    buffer_store_dwordx4 v[32:35], v184, s[28:31], s100 offen offset:1024 sc1
    v_accvgpr_read_b32 v12, a72
    v_accvgpr_read_b32 v13, a73
    v_accvgpr_read_b32 v14, a74
    v_accvgpr_read_b32 v15, a75
    v_mfma_f32_16x16x32_bf16 a[28:31], v[128:131], a[252:255], a[28:31]
    v_accvgpr_read_b32 v16, a104
    v_accvgpr_read_b32 v17, a105
    v_accvgpr_read_b32 v18, a106
    v_accvgpr_read_b32 v19, a107
    v_cvt_pk_bf16_f32 v20, v12, v13
    v_cvt_pk_bf16_f32 v21, v14, v15
    s_waitcnt lgkmcnt(4)
    v_mfma_f32_16x16x32_bf16 a[60:63], v[132:135], a[252:255], a[60:63]
    ds_read_b64_tr_b16 v[144:145], v58 offset:4096
    v_cvt_pk_bf16_f32 v22, v16, v17
    v_cvt_pk_bf16_f32 v23, v18, v19
    v_mfma_f32_16x16x32_bf16 a[56:59], v[132:135], a[248:251], a[56:59]
    ds_read_b64_tr_b16 v[146:147], v58 offset:6144
    buffer_store_dwordx4 v[20:23], v184, s[28:31], s100 offen offset:2048 sc1
    v_accvgpr_read_b32 v24, a76
    v_accvgpr_read_b32 v25, a77
    v_accvgpr_read_b32 v26, a78
    v_mfma_f32_16x16x32_bf16 a[52:55], v[132:135], a[244:247], a[52:55]
    v_accvgpr_read_b32 v27, a79
    v_accvgpr_read_b32 v28, a108
    v_accvgpr_read_b32 v29, a109
    v_accvgpr_read_b32 v30, a110
    v_accvgpr_read_b32 v31, a111
    v_cvt_pk_bf16_f32 v32, v24, v25
    v_mfma_f32_16x16x32_bf16 a[48:51], v[132:135], a[240:243], a[48:51]
    v_cvt_pk_bf16_f32 v33, v26, v27
    v_cvt_pk_bf16_f32 v34, v28, v29
    v_cvt_pk_bf16_f32 v35, v30, v31
    v_mfma_f32_16x16x32_bf16 a[44:47], v[132:135], a[236:239], a[44:47]
    buffer_store_dwordx4 v[32:35], v184, s[28:31], s100 offen offset:3072 sc1
    v_accvgpr_read_b32 v12, a80
    v_accvgpr_read_b32 v13, a81
    v_accvgpr_read_b32 v14, a82
    v_accvgpr_read_b32 v15, a83
    v_mfma_f32_16x16x32_bf16 a[40:43], v[132:135], a[232:235], a[40:43]
    v_accvgpr_read_b32 v16, a112
    v_accvgpr_read_b32 v17, a113
    v_accvgpr_read_b32 v18, a114
    v_accvgpr_read_b32 v19, a115
    v_cvt_pk_bf16_f32 v20, v12, v13
    v_cvt_pk_bf16_f32 v21, v14, v15
    v_mfma_f32_16x16x32_bf16 a[36:39], v[132:135], a[228:231], a[36:39]
    v_cvt_pk_bf16_f32 v22, v16, v17
    v_cvt_pk_bf16_f32 v23, v18, v19
    v_mfma_f32_16x16x32_bf16 a[32:35], v[132:135], a[224:227], a[32:35]
    buffer_store_dwordx4 v[20:23], v185, s[28:31], s100 offen offset:0 sc1
    v_accvgpr_read_b32 v24, a84
    v_accvgpr_read_b32 v25, a85
    v_accvgpr_read_b32 v26, a86
    v_accvgpr_read_b32 v27, a87
    s_waitcnt lgkmcnt(4)
    v_mfma_f32_16x16x32_bf16 v[192:195], v[136:139], a[192:195], v[192:195]
    ds_read_b64_tr_b16 v[128:129], v59 offset:4096
    v_accvgpr_read_b32 v28, a116
    v_accvgpr_read_b32 v29, a117
    v_accvgpr_read_b32 v30, a118
    v_accvgpr_read_b32 v31, a119
    v_cvt_pk_bf16_f32 v32, v24, v25
    v_mfma_f32_16x16x32_bf16 v[196:199], v[136:139], a[196:199], v[196:199]
    ds_read_b64_tr_b16 v[130:131], v59 offset:6144
    v_cvt_pk_bf16_f32 v33, v26, v27
    v_cvt_pk_bf16_f32 v34, v28, v29
    v_cvt_pk_bf16_f32 v35, v30, v31
    v_mfma_f32_16x16x32_bf16 v[200:203], v[136:139], a[200:203], v[200:203]
    buffer_store_dwordx4 v[32:35], v185, s[28:31], s100 offen offset:1024 sc1
    v_accvgpr_read_b32 v12, a88
    v_accvgpr_read_b32 v13, a89
    v_accvgpr_read_b32 v14, a90
    v_accvgpr_read_b32 v15, a91
    v_mfma_f32_16x16x32_bf16 v[204:207], v[136:139], a[204:207], v[204:207]
    v_accvgpr_read_b32 v16, a120
    v_accvgpr_read_b32 v17, a121
    v_accvgpr_read_b32 v18, a122
    v_accvgpr_read_b32 v19, a123
    v_cvt_pk_bf16_f32 v20, v12, v13
    v_cvt_pk_bf16_f32 v21, v14, v15
    v_mfma_f32_16x16x32_bf16 v[208:211], v[136:139], a[208:211], v[208:211]
    v_cvt_pk_bf16_f32 v22, v16, v17
    v_cvt_pk_bf16_f32 v23, v18, v19
    v_mfma_f32_16x16x32_bf16 v[212:215], v[136:139], a[212:215], v[212:215]
    buffer_store_dwordx4 v[20:23], v185, s[28:31], s100 offen offset:2048 sc1
    v_accvgpr_read_b32 v24, a92
    v_accvgpr_read_b32 v25, a93
    v_accvgpr_read_b32 v26, a94
    v_accvgpr_read_b32 v27, a95
    v_mfma_f32_16x16x32_bf16 v[216:219], v[136:139], a[216:219], v[216:219]
    v_accvgpr_read_b32 v28, a124
    v_accvgpr_read_b32 v29, a125
    v_accvgpr_read_b32 v30, a126
    v_accvgpr_read_b32 v31, a127
    v_cvt_pk_bf16_f32 v32, v24, v25
    v_cvt_pk_bf16_f32 v33, v26, v27
    v_mfma_f32_16x16x32_bf16 v[220:223], v[136:139], a[220:223], v[220:223]
    v_cvt_pk_bf16_f32 v34, v28, v29
    v_cvt_pk_bf16_f32 v35, v30, v31
    s_waitcnt lgkmcnt(4)
    v_mfma_f32_16x16x32_bf16 v[252:255], v[140:143], a[220:223], v[252:255]
    ds_read_b64_tr_b16 v[132:133], v58 offset:36864
    buffer_store_dwordx4 v[32:35], v185, s[28:31], s100 offen offset:3072 sc1
    s_sub_u32 s100, s100, 3932160
    v_accvgpr_read_b32 v12, a0
    v_accvgpr_read_b32 v13, a1
    v_mfma_f32_16x16x32_bf16 v[248:251], v[140:143], a[216:219], v[248:251]
    ds_read_b64_tr_b16 v[134:135], v58 offset:38912
    v_accvgpr_read_b32 v14, a2
    v_accvgpr_read_b32 v15, a3
    v_accvgpr_read_b32 v16, a32
    v_accvgpr_read_b32 v17, a33
    v_accvgpr_read_b32 v18, a34
    v_mfma_f32_16x16x32_bf16 v[244:247], v[140:143], a[212:215], v[244:247]
    v_accvgpr_read_b32 v19, a35
    v_cvt_pk_bf16_f32 v20, v12, v13
    v_cvt_pk_bf16_f32 v21, v14, v15
    v_cvt_pk_bf16_f32 v22, v16, v17
    v_cvt_pk_bf16_f32 v23, v18, v19
    v_mfma_f32_16x16x32_bf16 v[240:243], v[140:143], a[208:211], v[240:243]
    buffer_store_dwordx4 v[20:23], v184, s[28:31], s100 offen offset:0 sc1
    v_accvgpr_read_b32 v24, a4
    v_accvgpr_read_b32 v25, a5
    v_accvgpr_read_b32 v26, a6
    v_accvgpr_read_b32 v27, a7
    v_mfma_f32_16x16x32_bf16 v[236:239], v[140:143], a[204:207], v[236:239]
    v_accvgpr_read_b32 v28, a36
    v_accvgpr_read_b32 v29, a37
    v_accvgpr_read_b32 v30, a38
    v_accvgpr_read_b32 v31, a39
    v_cvt_pk_bf16_f32 v32, v24, v25
    v_cvt_pk_bf16_f32 v33, v26, v27
    v_mfma_f32_16x16x32_bf16 v[232:235], v[140:143], a[200:203], v[232:235]
    v_cvt_pk_bf16_f32 v34, v28, v29
    v_cvt_pk_bf16_f32 v35, v30, v31
    v_mfma_f32_16x16x32_bf16 v[228:231], v[140:143], a[196:199], v[228:231]
    buffer_store_dwordx4 v[32:35], v184, s[28:31], s100 offen offset:1024 sc1
    v_accvgpr_read_b32 v12, a8
    v_accvgpr_read_b32 v13, a9
    v_accvgpr_read_b32 v14, a10
    v_accvgpr_read_b32 v15, a11
    v_mfma_f32_16x16x32_bf16 v[224:227], v[140:143], a[192:195], v[224:227]
    v_accvgpr_read_b32 v16, a40
    v_accvgpr_read_b32 v17, a41
    v_accvgpr_read_b32 v18, a42
    v_accvgpr_read_b32 v19, a43
    v_cvt_pk_bf16_f32 v20, v12, v13
    v_cvt_pk_bf16_f32 v21, v14, v15
    s_waitcnt lgkmcnt(4)
    v_mfma_f32_16x16x32_bf16 v[64:67], v[144:147], a[192:195], v[64:67]
    ds_read_b64_tr_b16 v[136:137], v59 offset:36864
    v_cvt_pk_bf16_f32 v22, v16, v17
    v_cvt_pk_bf16_f32 v23, v18, v19
    v_mfma_f32_16x16x32_bf16 v[68:71], v[144:147], a[196:199], v[68:71]
    ds_read_b64_tr_b16 v[138:139], v59 offset:38912
    buffer_store_dwordx4 v[20:23], v184, s[28:31], s100 offen offset:2048 sc1
    v_accvgpr_read_b32 v24, a12
    v_accvgpr_read_b32 v25, a13
    v_accvgpr_read_b32 v26, a14
    v_mfma_f32_16x16x32_bf16 v[72:75], v[144:147], a[200:203], v[72:75]
    v_accvgpr_read_b32 v27, a15
    v_accvgpr_read_b32 v28, a44
    v_accvgpr_read_b32 v29, a45
    v_accvgpr_read_b32 v30, a46
    v_accvgpr_read_b32 v31, a47
    v_cvt_pk_bf16_f32 v32, v24, v25
    v_mfma_f32_16x16x32_bf16 v[76:79], v[144:147], a[204:207], v[76:79]
    v_cvt_pk_bf16_f32 v33, v26, v27
    v_cvt_pk_bf16_f32 v34, v28, v29
    v_cvt_pk_bf16_f32 v35, v30, v31
    v_mfma_f32_16x16x32_bf16 v[80:83], v[144:147], a[208:211], v[80:83]
    buffer_store_dwordx4 v[32:35], v184, s[28:31], s100 offen offset:3072 sc1
    v_accvgpr_read_b32 v12, a16
    v_accvgpr_read_b32 v13, a17
    v_accvgpr_read_b32 v14, a18
    v_accvgpr_read_b32 v15, a19
    v_mfma_f32_16x16x32_bf16 v[84:87], v[144:147], a[212:215], v[84:87]
    v_accvgpr_read_b32 v16, a48
    v_accvgpr_read_b32 v17, a49
    v_accvgpr_read_b32 v18, a50
    v_accvgpr_read_b32 v19, a51
    v_cvt_pk_bf16_f32 v20, v12, v13
    v_cvt_pk_bf16_f32 v21, v14, v15
    v_mfma_f32_16x16x32_bf16 v[88:91], v[144:147], a[216:219], v[88:91]
    v_cvt_pk_bf16_f32 v22, v16, v17
    v_cvt_pk_bf16_f32 v23, v18, v19
    v_mfma_f32_16x16x32_bf16 v[92:95], v[144:147], a[220:223], v[92:95]
    buffer_store_dwordx4 v[20:23], v185, s[28:31], s100 offen offset:0 sc1
    v_accvgpr_read_b32 v24, a20
    v_accvgpr_read_b32 v25, a21
    v_accvgpr_read_b32 v26, a22
    v_accvgpr_read_b32 v27, a23
    s_waitcnt lgkmcnt(4)
    v_mfma_f32_16x16x32_bf16 v[124:127], v[128:131], a[220:223], v[124:127]
    ds_read_b64_tr_b16 v[140:141], v58 offset:40960
    v_accvgpr_read_b32 v28, a52
    v_accvgpr_read_b32 v29, a53
    v_accvgpr_read_b32 v30, a54
    v_accvgpr_read_b32 v31, a55
    v_cvt_pk_bf16_f32 v32, v24, v25
    v_mfma_f32_16x16x32_bf16 v[120:123], v[128:131], a[216:219], v[120:123]
    ds_read_b64_tr_b16 v[142:143], v58 offset:43008
    v_cvt_pk_bf16_f32 v33, v26, v27
    v_cvt_pk_bf16_f32 v34, v28, v29
    v_cvt_pk_bf16_f32 v35, v30, v31
    v_mfma_f32_16x16x32_bf16 v[116:119], v[128:131], a[212:215], v[116:119]
    buffer_store_dwordx4 v[32:35], v185, s[28:31], s100 offen offset:1024 sc1
    v_accvgpr_read_b32 v12, a24
    v_accvgpr_read_b32 v13, a25
    v_accvgpr_read_b32 v14, a26
    v_accvgpr_read_b32 v15, a27
    v_mfma_f32_16x16x32_bf16 v[112:115], v[128:131], a[208:211], v[112:115]
    v_accvgpr_read_b32 v16, a56
    v_accvgpr_read_b32 v17, a57
    v_accvgpr_read_b32 v18, a58
    v_accvgpr_read_b32 v19, a59
    v_cvt_pk_bf16_f32 v20, v12, v13
    v_cvt_pk_bf16_f32 v21, v14, v15
    v_mfma_f32_16x16x32_bf16 v[108:111], v[128:131], a[204:207], v[108:111]
    v_cvt_pk_bf16_f32 v22, v16, v17
    v_cvt_pk_bf16_f32 v23, v18, v19
    v_mfma_f32_16x16x32_bf16 v[104:107], v[128:131], a[200:203], v[104:107]
    buffer_store_dwordx4 v[20:23], v185, s[28:31], s100 offen offset:2048 sc1
    v_accvgpr_read_b32 v24, a28
    v_accvgpr_read_b32 v25, a29
    v_accvgpr_read_b32 v26, a30
    v_accvgpr_read_b32 v27, a31
    v_mfma_f32_16x16x32_bf16 v[100:103], v[128:131], a[196:199], v[100:103]
    v_accvgpr_read_b32 v28, a60
    v_accvgpr_read_b32 v29, a61
    v_accvgpr_read_b32 v30, a62
    v_accvgpr_read_b32 v31, a63
    v_cvt_pk_bf16_f32 v32, v24, v25
    v_cvt_pk_bf16_f32 v33, v26, v27
    v_mfma_f32_16x16x32_bf16 v[96:99], v[128:131], a[192:195], v[96:99]
    v_cvt_pk_bf16_f32 v34, v28, v29
    v_cvt_pk_bf16_f32 v35, v30, v31
    s_waitcnt lgkmcnt(4)
    v_mfma_f32_16x16x32_bf16 v[192:195], v[132:135], a[224:227], v[192:195]
    ds_read_b64_tr_b16 v[144:145], v59 offset:40960
    buffer_store_dwordx4 v[32:35], v185, s[28:31], s100 offen offset:3072 sc1
    v_mfma_f32_16x16x32_bf16 v[196:199], v[132:135], a[228:231], v[196:199]
    ds_read_b64_tr_b16 v[146:147], v59 offset:43008
    v_mfma_f32_16x16x32_bf16 v[200:203], v[132:135], a[232:235], v[200:203]
    v_mfma_f32_16x16x32_bf16 v[204:207], v[132:135], a[236:239], v[204:207]
    v_mfma_f32_16x16x32_bf16 v[208:211], v[132:135], a[240:243], v[208:211]
    v_mfma_f32_16x16x32_bf16 v[212:215], v[132:135], a[244:247], v[212:215]
    v_mfma_f32_16x16x32_bf16 v[216:219], v[132:135], a[248:251], v[216:219]
    v_mfma_f32_16x16x32_bf16 v[220:223], v[132:135], a[252:255], v[220:223]
    s_waitcnt lgkmcnt(4)
    v_mfma_f32_16x16x32_bf16 v[252:255], v[136:139], a[252:255], v[252:255]
    v_mfma_f32_16x16x32_bf16 v[248:251], v[136:139], a[248:251], v[248:251]
    v_mfma_f32_16x16x32_bf16 v[244:247], v[136:139], a[244:247], v[244:247]
    v_mfma_f32_16x16x32_bf16 v[240:243], v[136:139], a[240:243], v[240:243]
    v_mfma_f32_16x16x32_bf16 v[236:239], v[136:139], a[236:239], v[236:239]
    v_mfma_f32_16x16x32_bf16 v[232:235], v[136:139], a[232:235], v[232:235]
    v_mfma_f32_16x16x32_bf16 v[228:231], v[136:139], a[228:231], v[228:231]
    v_mfma_f32_16x16x32_bf16 v[224:227], v[136:139], a[224:227], v[224:227]
    s_waitcnt lgkmcnt(2)
    v_mfma_f32_16x16x32_bf16 v[64:67], v[140:143], a[224:227], v[64:67]
    v_mfma_f32_16x16x32_bf16 v[68:71], v[140:143], a[228:231], v[68:71]
    v_mfma_f32_16x16x32_bf16 v[72:75], v[140:143], a[232:235], v[72:75]
    v_mfma_f32_16x16x32_bf16 v[76:79], v[140:143], a[236:239], v[76:79]
    v_mfma_f32_16x16x32_bf16 v[80:83], v[140:143], a[240:243], v[80:83]
    v_mfma_f32_16x16x32_bf16 v[84:87], v[140:143], a[244:247], v[84:87]
    v_mfma_f32_16x16x32_bf16 v[88:91], v[140:143], a[248:251], v[88:91]
    v_mfma_f32_16x16x32_bf16 v[92:95], v[140:143], a[252:255], v[92:95]
    s_waitcnt lgkmcnt(0)
    v_mfma_f32_16x16x32_bf16 v[124:127], v[144:147], a[252:255], v[124:127]
    v_mfma_f32_16x16x32_bf16 v[120:123], v[144:147], a[248:251], v[120:123]
    v_mfma_f32_16x16x32_bf16 v[116:119], v[144:147], a[244:247], v[116:119]
    v_mfma_f32_16x16x32_bf16 v[112:115], v[144:147], a[240:243], v[112:115]
    v_mfma_f32_16x16x32_bf16 v[108:111], v[144:147], a[236:239], v[108:111]
    v_mfma_f32_16x16x32_bf16 v[104:107], v[144:147], a[232:235], v[104:107]
    v_mfma_f32_16x16x32_bf16 v[100:103], v[144:147], a[228:231], v[100:103]
    v_mfma_f32_16x16x32_bf16 v[96:99], v[144:147], a[224:227], v[96:99]
    s_waitcnt vmcnt(0)
    s_lshl_b32 s49, s49, 5
    v_lshlrev_b32 v157, 2, v0
    v_mov_b32 v158, s76
    s_mov_b32 exec_hi, 0
    buffer_store_dword v158, v157, s[40:43], s49 offen sc1
    s_mov_b64 exec, -1
    s_barrier
    s_nop 7
L_g1_epiD:
    v_pk_mul_f32 v[128:129], v[192:193], v[192:193]
    v_pk_mul_f32 v[130:131], v[194:195], v[194:195]
    v_pk_mul_f32 v[132:133], v[224:225], v[224:225]
    v_pk_mul_f32 v[134:135], v[226:227], v[226:227]
    v_pk_fma_f32 v[128:129], v[128:129], s[50:51], v[154:155]
    v_pk_fma_f32 v[130:131], v[130:131], s[50:51], v[154:155]
    v_pk_fma_f32 v[132:133], v[132:133], s[50:51], v[154:155]
    v_pk_fma_f32 v[134:135], v[134:135], s[50:51], v[154:155]
    v_pk_mul_f32 v[128:129], v[128:129], v[192:193]
    v_pk_mul_f32 v[130:131], v[130:131], v[194:195]
    v_pk_mul_f32 v[132:133], v[132:133], v[224:225]
    v_pk_mul_f32 v[134:135], v[134:135], v[226:227]
    v_exp_f32 v128, v128
    v_exp_f32 v129, v129
    v_exp_f32 v130, v130
    v_exp_f32 v131, v131
    v_exp_f32 v132, v132
    v_exp_f32 v133, v133
    v_exp_f32 v134, v134
    v_exp_f32 v135, v135
    v_pk_mul_f32 v[192:193], v[192:193], v[64:65]
    v_pk_mul_f32 v[194:195], v[194:195], v[66:67]
    v_pk_mul_f32 v[224:225], v[224:225], v[96:97]
    v_pk_mul_f32 v[226:227], v[226:227], v[98:99]
    v_pk_add_f32 v[128:129], v[128:129], 1.0 op_sel_hi:[1,0]
    v_pk_add_f32 v[130:131], v[130:131], 1.0 op_sel_hi:[1,0]
    v_pk_add_f32 v[132:133], v[132:133], 1.0 op_sel_hi:[1,0]
    v_pk_add_f32 v[134:135], v[134:135], 1.0 op_sel_hi:[1,0]
    v_rcp_f32 v128, v128
    v_rcp_f32 v129, v129
    v_rcp_f32 v130, v130
    v_rcp_f32 v131, v131
    v_rcp_f32 v132, v132
    v_rcp_f32 v133, v133
    v_rcp_f32 v134, v134
    v_rcp_f32 v135, v135
    s_nop 0
    v_pk_mul_f32 v[128:129], v[128:129], v[192:193]
    v_pk_mul_f32 v[130:131], v[130:131], v[194:195]
    v_pk_mul_f32 v[132:133], v[132:133], v[224:225]
    v_pk_mul_f32 v[134:135], v[134:135], v[226:227]
    v_cvt_pk_bf16_f32 v192, v128, v129
    v_cvt_pk_bf16_f32 v193, v130, v131
    v_cvt_pk_bf16_f32 v194, v132, v133
    v_cvt_pk_bf16_f32 v195, v134, v135
    v_pk_mul_f32 v[136:137], v[196:197], v[196:197]
    v_pk_mul_f32 v[138:139], v[198:199], v[198:199]
    v_pk_mul_f32 v[140:141], v[228:229], v[228:229]
    v_pk_mul_f32 v[142:143], v[230:231], v[230:231]
    v_pk_fma_f32 v[136:137], v[136:137], s[50:51], v[154:155]
    v_pk_fma_f32 v[138:139], v[138:139], s[50:51], v[154:155]
    v_pk_fma_f32 v[140:141], v[140:141], s[50:51], v[154:155]
    v_pk_fma_f32 v[142:143], v[142:143], s[50:51], v[154:155]
    v_pk_mul_f32 v[136:137], v[136:137], v[196:197]
    v_pk_mul_f32 v[138:139], v[138:139], v[198:199]
    v_pk_mul_f32 v[140:141], v[140:141], v[228:229]
    v_pk_mul_f32 v[142:143], v[142:143], v[230:231]
    v_exp_f32 v136, v136
    v_exp_f32 v137, v137
    v_exp_f32 v138, v138
    v_exp_f32 v139, v139
    v_exp_f32 v140, v140
    v_exp_f32 v141, v141
    v_exp_f32 v142, v142
    v_exp_f32 v143, v143
    v_pk_mul_f32 v[196:197], v[196:197], v[68:69]
    v_pk_mul_f32 v[198:199], v[198:199], v[70:71]
    v_pk_mul_f32 v[228:229], v[228:229], v[100:101]
    v_pk_mul_f32 v[230:231], v[230:231], v[102:103]
    v_pk_add_f32 v[136:137], v[136:137], 1.0 op_sel_hi:[1,0]
    v_pk_add_f32 v[138:139], v[138:139], 1.0 op_sel_hi:[1,0]
    v_pk_add_f32 v[140:141], v[140:141], 1.0 op_sel_hi:[1,0]
    v_pk_add_f32 v[142:143], v[142:143], 1.0 op_sel_hi:[1,0]
    v_rcp_f32 v136, v136
    v_rcp_f32 v137, v137
    v_rcp_f32 v138, v138
    v_rcp_f32 v139, v139
    v_rcp_f32 v140, v140
    v_rcp_f32 v141, v141
    v_rcp_f32 v142, v142
    v_rcp_f32 v143, v143
    s_nop 0
    v_pk_mul_f32 v[136:137], v[136:137], v[196:197]
    v_pk_mul_f32 v[138:139], v[138:139], v[198:199]
    v_pk_mul_f32 v[140:141], v[140:141], v[228:229]
    v_pk_mul_f32 v[142:143], v[142:143], v[230:231]
    v_cvt_pk_bf16_f32 v196, v136, v137
    v_cvt_pk_bf16_f32 v197, v138, v139
    v_cvt_pk_bf16_f32 v198, v140, v141
    v_cvt_pk_bf16_f32 v199, v142, v143
    buffer_load_dword v157, v156, s[40:43], 0 offen sc1
    v_pk_mul_f32 v[128:129], v[200:201], v[200:201]
    v_pk_mul_f32 v[130:131], v[202:203], v[202:203]
    v_pk_mul_f32 v[132:133], v[232:233], v[232:233]
    v_pk_mul_f32 v[134:135], v[234:235], v[234:235]
    v_pk_fma_f32 v[128:129], v[128:129], s[50:51], v[154:155]
    v_pk_fma_f32 v[130:131], v[130:131], s[50:51], v[154:155]
    v_pk_fma_f32 v[132:133], v[132:133], s[50:51], v[154:155]
    v_pk_fma_f32 v[134:135], v[134:135], s[50:51], v[154:155]
    v_pk_mul_f32 v[128:129], v[128:129], v[200:201]
    v_pk_mul_f32 v[130:131], v[130:131], v[202:203]
    v_pk_mul_f32 v[132:133], v[132:133], v[232:233]
    v_pk_mul_f32 v[134:135], v[134:135], v[234:235]
    v_exp_f32 v128, v128
    v_exp_f32 v129, v129
    v_exp_f32 v130, v130
    v_exp_f32 v131, v131
    v_exp_f32 v132, v132
    v_exp_f32 v133, v133
    v_exp_f32 v134, v134
    v_exp_f32 v135, v135
    v_pk_mul_f32 v[200:201], v[200:201], v[72:73]
    v_pk_mul_f32 v[202:203], v[202:203], v[74:75]
    v_pk_mul_f32 v[232:233], v[232:233], v[104:105]
    v_pk_mul_f32 v[234:235], v[234:235], v[106:107]
    v_pk_add_f32 v[128:129], v[128:129], 1.0 op_sel_hi:[1,0]
    v_pk_add_f32 v[130:131], v[130:131], 1.0 op_sel_hi:[1,0]
    v_pk_add_f32 v[132:133], v[132:133], 1.0 op_sel_hi:[1,0]
    v_pk_add_f32 v[134:135], v[134:135], 1.0 op_sel_hi:[1,0]
    v_rcp_f32 v128, v128
    v_rcp_f32 v129, v129
    v_rcp_f32 v130, v130
    v_rcp_f32 v131, v131
    v_rcp_f32 v132, v132
    v_rcp_f32 v133, v133
    v_rcp_f32 v134, v134
    v_rcp_f32 v135, v135
    s_nop 0
    v_pk_mul_f32 v[128:129], v[128:129], v[200:201]
    v_pk_mul_f32 v[130:131], v[130:131], v[202:203]
    v_pk_mul_f32 v[132:133], v[132:133], v[232:233]
    v_pk_mul_f32 v[134:135], v[134:135], v[234:235]
    v_cvt_pk_bf16_f32 v200, v128, v129
    v_cvt_pk_bf16_f32 v201, v130, v131
    v_cvt_pk_bf16_f32 v202, v132, v133
    v_cvt_pk_bf16_f32 v203, v134, v135
    v_pk_mul_f32 v[136:137], v[204:205], v[204:205]
    v_pk_mul_f32 v[138:139], v[206:207], v[206:207]
    v_pk_mul_f32 v[140:141], v[236:237], v[236:237]
    v_pk_mul_f32 v[142:143], v[238:239], v[238:239]
    v_pk_fma_f32 v[136:137], v[136:137], s[50:51], v[154:155]
    v_pk_fma_f32 v[138:139], v[138:139], s[50:51], v[154:155]
    v_pk_fma_f32 v[140:141], v[140:141], s[50:51], v[154:155]
    v_pk_fma_f32 v[142:143], v[142:143], s[50:51], v[154:155]
    v_pk_mul_f32 v[136:137], v[136:137], v[204:205]
    v_pk_mul_f32 v[138:139], v[138:139], v[206:207]
    v_pk_mul_f32 v[140:141], v[140:141], v[236:237]
    v_pk_mul_f32 v[142:143], v[142:143], v[238:239]
    v_exp_f32 v136, v136
    v_exp_f32 v137, v137
    v_exp_f32 v138, v138
    v_exp_f32 v139, v139
    v_exp_f32 v140, v140
    v_exp_f32 v141, v141
    v_exp_f32 v142, v142
    v_exp_f32 v143, v143
    v_pk_mul_f32 v[204:205], v[204:205], v[76:77]
    v_pk_mul_f32 v[206:207], v[206:207], v[78:79]
    v_pk_mul_f32 v[236:237], v[236:237], v[108:109]
    v_pk_mul_f32 v[238:239], v[238:239], v[110:111]
    v_pk_add_f32 v[136:137], v[136:137], 1.0 op_sel_hi:[1,0]
    v_pk_add_f32 v[138:139], v[138:139], 1.0 op_sel_hi:[1,0]
    v_pk_add_f32 v[140:141], v[140:141], 1.0 op_sel_hi:[1,0]
    v_pk_add_f32 v[142:143], v[142:143], 1.0 op_sel_hi:[1,0]
    v_rcp_f32 v136, v136
    v_rcp_f32 v137, v137
    v_rcp_f32 v138, v138
    v_rcp_f32 v139, v139
    v_rcp_f32 v140, v140
    v_rcp_f32 v141, v141
    v_rcp_f32 v142, v142
    v_rcp_f32 v143, v143
    s_nop 0
    v_pk_mul_f32 v[136:137], v[136:137], v[204:205]
    v_pk_mul_f32 v[138:139], v[138:139], v[206:207]
    v_pk_mul_f32 v[140:141], v[140:141], v[236:237]
    v_pk_mul_f32 v[142:143], v[142:143], v[238:239]
    v_cvt_pk_bf16_f32 v204, v136, v137
    v_cvt_pk_bf16_f32 v205, v138, v139
    v_cvt_pk_bf16_f32 v206, v140, v141
    v_cvt_pk_bf16_f32 v207, v142, v143
    s_cmp_lg_u32 s77, 0
    s_cbranch_scc1 L_f1_go
    s_waitcnt vmcnt(0)
    v_cmp_ne_u32 vcc, s76, v157
    s_cmp_eq_u64 vcc, 0
    s_cbranch_scc1 L_f1_go
    s_mov_b32 s58, 0x40000
L_f1_poll:
    buffer_load_dword v157, v156, s[40:43], 0 offen sc1
    s_waitcnt vmcnt(0)
    v_cmp_ne_u32 vcc, s76, v157
    s_cmp_eq_u64 vcc, 0
    s_cbranch_scc1 L_f1_go
    s_sleep 4
    s_sub_u32 s58, s58, 1
    s_cmp_lg_u32 s58, 0
    s_cbranch_scc1 L_f1_poll
L_f1_go:
    s_barrier
    s_mov_b32 s23, 0
    s_mov_b32 s25, s24
    s_mov_b32 s26, 0
    s_mov_b32 m0, s25
    s_nop 0
    buffer_load_dwordx4 v2, s[8:11], s23 offen sc1 lds
    buffer_load_dwordx4 v2, s[8:11], s23 offen offset:1024 sc1 lds
    v_pk_mul_f32 v[128:129], v[208:209], v[208:209]
    v_pk_mul_f32 v[130:131], v[210:211], v[210:211]
    v_pk_mul_f32 v[132:133], v[240:241], v[240:241]
    v_pk_mul_f32 v[134:135], v[242:243], v[242:243]
    v_pk_fma_f32 v[128:129], v[128:129], s[50:51], v[154:155]
    v_pk_fma_f32 v[130:131], v[130:131], s[50:51], v[154:155]
    v_pk_fma_f32 v[132:133], v[132:133], s[50:51], v[154:155]
    v_pk_fma_f32 v[134:135], v[134:135], s[50:51], v[154:155]
    v_pk_mul_f32 v[128:129], v[128:129], v[208:209]
    v_pk_mul_f32 v[130:131], v[130:131], v[210:211]
    v_pk_mul_f32 v[132:133], v[132:133], v[240:241]
    v_pk_mul_f32 v[134:135], v[134:135], v[242:243]
    buffer_load_dwordx4 v[12:15], v4, s[4:7], s27 offen offset:0 sc1
    buffer_load_dwordx4 v[16:19], v4, s[4:7], s27 offen offset:512 sc1
    v_exp_f32 v128, v128
    v_exp_f32 v129, v129
    v_exp_f32 v130, v130
    v_exp_f32 v131, v131
    v_exp_f32 v132, v132
    v_exp_f32 v133, v133
    v_exp_f32 v134, v134
    v_exp_f32 v135, v135
    v_pk_mul_f32 v[208:209], v[208:209], v[80:81]
    v_pk_mul_f32 v[210:211], v[210:211], v[82:83]
    v_pk_mul_f32 v[240:241], v[240:241], v[112:113]
    v_pk_mul_f32 v[242:243], v[242:243], v[114:115]
    v_pk_add_f32 v[128:129], v[128:129], 1.0 op_sel_hi:[1,0]
    v_pk_add_f32 v[130:131], v[130:131], 1.0 op_sel_hi:[1,0]
    v_pk_add_f32 v[132:133], v[132:133], 1.0 op_sel_hi:[1,0]
    v_pk_add_f32 v[134:135], v[134:135], 1.0 op_sel_hi:[1,0]
    buffer_load_dwordx4 v[20:23], v4, s[4:7], s27 offen offset:2048 sc1
    buffer_load_dwordx4 v[24:27], v4, s[4:7], s27 offen offset:2560 sc1
    v_rcp_f32 v128, v128
    v_rcp_f32 v129, v129
    v_rcp_f32 v130, v130
    v_rcp_f32 v131, v131
    v_rcp_f32 v132, v132
    v_rcp_f32 v133, v133
    v_rcp_f32 v134, v134
    v_rcp_f32 v135, v135
    s_nop 0
    v_pk_mul_f32 v[128:129], v[128:129], v[208:209]
    v_pk_mul_f32 v[130:131], v[130:131], v[210:211]
    v_pk_mul_f32 v[132:133], v[132:133], v[240:241]
    v_pk_mul_f32 v[134:135], v[134:135], v[242:243]
    v_cvt_pk_bf16_f32 v208, v128, v129
    v_cvt_pk_bf16_f32 v209, v130, v131
    v_cvt_pk_bf16_f32 v210, v132, v133
    v_cvt_pk_bf16_f32 v211, v134, v135
    s_add_u32 m0, s25, 8192
    s_nop 0
    buffer_load_dwordx4 v3, s[12:15], s23 offen sc1 lds
    buffer_load_dwordx4 v3, s[12:15], s23 offen offset:1024 sc1 lds
    s_add_u32 s23, s23, 8192
    s_add_u32 s25, s25, 16384
    s_and_b32 s25, s25, 65535
    v_pk_mul_f32 v[136:137], v[212:213], v[212:213]
    v_pk_mul_f32 v[138:139], v[214:215], v[214:215]
    v_pk_mul_f32 v[140:141], v[244:245], v[244:245]
    v_pk_mul_f32 v[142:143], v[246:247], v[246:247]
    v_pk_fma_f32 v[136:137], v[136:137], s[50:51], v[154:155]
    v_pk_fma_f32 v[138:139], v[138:139], s[50:51], v[154:155]
    v_pk_fma_f32 v[140:141], v[140:141], s[50:51], v[154:155]
    v_pk_fma_f32 v[142:143], v[142:143], s[50:51], v[154:155]
    v_pk_mul_f32 v[136:137], v[136:137], v[212:213]
    v_pk_mul_f32 v[138:139], v[138:139], v[214:215]
    v_pk_mul_f32 v[140:141], v[140:141], v[244:245]
    v_pk_mul_f32 v[142:143], v[142:143], v[246:247]
    v_exp_f32 v136, v136
    v_exp_f32 v137, v137
    v_exp_f32 v138, v138
    v_exp_f32 v139, v139
    v_exp_f32 v140, v140
    v_exp_f32 v141, v141
    v_exp_f32 v142, v142
    v_exp_f32 v143, v143
    s_mov_b32 m0, s25
    s_nop 0
    buffer_load_dwordx4 v2, s[8:11], s23 offen sc1 lds
    buffer_load_dwordx4 v2, s[8:11], s23 offen offset:1024 sc1 lds
    v_pk_mul_f32 v[212:213], v[212:213], v[84:85]
    v_pk_mul_f32 v[214:215], v[214:215], v[86:87]
    v_pk_mul_f32 v[244:245], v[244:245], v[116:117]
    v_pk_mul_f32 v[246:247], v[246:247], v[118:119]
    v_pk_add_f32 v[136:137], v[136:137], 1.0 op_sel_hi:[1,0]
    v_pk_add_f32 v[138:139], v[138:139], 1.0 op_sel_hi:[1,0]
    v_pk_add_f32 v[140:141], v[140:141], 1.0 op_sel_hi:[1,0]
    v_pk_add_f32 v[142:143], v[142:143], 1.0 op_sel_hi:[1,0]
    v_rcp_f32 v136, v136
    v_rcp_f32 v137, v137
    v_rcp_f32 v138, v138
    v_rcp_f32 v139, v139
    v_rcp_f32 v140, v140
    v_rcp_f32 v141, v141
    v_rcp_f32 v142, v142
    v_rcp_f32 v143, v143
    s_add_u32 m0, s25, 8192
    s_nop 0
    buffer_load_dwordx4 v3, s[12:15], s23 offen sc1 lds
    buffer_load_dwordx4 v3, s[12:15], s23 offen offset:1024 sc1 lds
    s_add_u32 s23, s23, 8192
    s_add_u32 s25, s25, 16384
    s_and_b32 s25, s25, 65535
    s_nop 0
    v_pk_mul_f32 v[136:137], v[136:137], v[212:213]
    v_pk_mul_f32 v[138:139], v[138:139], v[214:215]
    v_pk_mul_f32 v[140:141], v[140:141], v[244:245]
    v_pk_mul_f32 v[142:143], v[142:143], v[246:247]
    v_cvt_pk_bf16_f32 v212, v136, v137
    v_cvt_pk_bf16_f32 v213, v138, v139
    v_cvt_pk_bf16_f32 v214, v140, v141
    v_cvt_pk_bf16_f32 v215, v142, v143
    v_pk_mul_f32 v[128:129], v[216:217], v[216:217]
    v_pk_mul_f32 v[130:131], v[218:219], v[218:219]
    v_pk_mul_f32 v[132:133], v[248:249], v[248:249]
    v_pk_mul_f32 v[134:135], v[250:251], v[250:251]
    v_pk_fma_f32 v[128:129], v[128:129], s[50:51], v[154:155]
    v_pk_fma_f32 v[130:131], v[130:131], s[50:51], v[154:155]
    v_pk_fma_f32 v[132:133], v[132:133], s[50:51], v[154:155]
    v_pk_fma_f32 v[134:135], v[134:135], s[50:51], v[154:155]
    v_pk_mul_f32 v[128:129], v[128:129], v[216:217]
    v_pk_mul_f32 v[130:131], v[130:131], v[218:219]
    v_pk_mul_f32 v[132:133], v[132:133], v[248:249]
    v_pk_mul_f32 v[134:135], v[134:135], v[250:251]
    s_mov_b32 m0, s25
    s_nop 0
    buffer_load_dwordx4 v2, s[8:11], s23 offen sc1 lds
    buffer_load_dwordx4 v2, s[8:11], s23 offen offset:1024 sc1 lds
    v_exp_f32 v128, v128
    v_exp_f32 v129, v129
    v_exp_f32 v130, v130
    v_exp_f32 v131, v131
    v_exp_f32 v132, v132
    v_exp_f32 v133, v133
    v_exp_f32 v134, v134
    v_exp_f32 v135, v135
    v_pk_mul_f32 v[216:217], v[216:217], v[88:89]
    v_pk_mul_f32 v[218:219], v[218:219], v[90:91]
    v_pk_mul_f32 v[248:249], v[248:249], v[120:121]
    v_pk_mul_f32 v[250:251], v[250:251], v[122:123]
    v_pk_add_f32 v[128:129], v[128:129], 1.0 op_sel_hi:[1,0]
    v_pk_add_f32 v[130:131], v[130:131], 1.0 op_sel_hi:[1,0]
    v_pk_add_f32 v[132:133], v[132:133], 1.0 op_sel_hi:[1,0]
    v_pk_add_f32 v[134:135], v[134:135], 1.0 op_sel_hi:[1,0]
    s_add_u32 m0, s25, 8192
    s_nop 0
    buffer_load_dwordx4 v3, s[12:15], s23 offen sc1 lds
    buffer_load_dwordx4 v3, s[12:15], s23 offen offset:1024 sc1 lds
    v_rcp_f32 v128, v128
    v_rcp_f32 v129, v129
    v_rcp_f32 v130, v130
    v_rcp_f32 v131, v131
    v_rcp_f32 v132, v132
    v_rcp_f32 v133, v133
    v_rcp_f32 v134, v134
    v_rcp_f32 v135, v135
    s_nop 0
    v_pk_mul_f32 v[128:129], v[128:129], v[216:217]
    v_pk_mul_f32 v[130:131], v[130:131], v[218:219]
    v_pk_mul_f32 v[132:133], v[132:133], v[248:249]
    v_pk_mul_f32 v[134:135], v[134:135], v[250:251]
    v_cvt_pk_bf16_f32 v216, v128, v129
    v_cvt_pk_bf16_f32 v217, v130, v131
    v_cvt_pk_bf16_f32 v218, v132, v133
    v_cvt_pk_bf16_f32 v219, v134, v135
    v_pk_mul_f32 v[136:137], v[220:221], v[220:221]
    v_pk_mul_f32 v[138:139], v[222:223], v[222:223]
    v_pk_mul_f32 v[140:141], v[252:253], v[252:253]
    v_pk_mul_f32 v[142:143], v[254:255], v[254:255]
    v_pk_fma_f32 v[136:137], v[136:137], s[50:51], v[154:155]
    v_pk_fma_f32 v[138:139], v[138:139], s[50:51], v[154:155]
    v_pk_fma_f32 v[140:141], v[140:141], s[50:51], v[154:155]
    v_pk_fma_f32 v[142:143], v[142:143], s[50:51], v[154:155]
    v_pk_mul_f32 v[136:137], v[136:137], v[220:221]
    v_pk_mul_f32 v[138:139], v[138:139], v[222:223]
    v_pk_mul_f32 v[140:141], v[140:141], v[252:253]
    v_pk_mul_f32 v[142:143], v[142:143], v[254:255]
    v_exp_f32 v136, v136
    v_exp_f32 v137, v137
    v_exp_f32 v138, v138
    v_exp_f32 v139, v139
    v_exp_f32 v140, v140
    v_exp_f32 v141, v141
    v_exp_f32 v142, v142
    v_exp_f32 v143, v143
    v_pk_mul_f32 v[220:221], v[220:221], v[92:93]
    v_pk_mul_f32 v[222:223], v[222:223], v[94:95]
    v_pk_mul_f32 v[252:253], v[252:253], v[124:125]
    v_pk_mul_f32 v[254:255], v[254:255], v[126:127]
    v_pk_add_f32 v[136:137], v[136:137], 1.0 op_sel_hi:[1,0]
    v_pk_add_f32 v[138:139], v[138:139], 1.0 op_sel_hi:[1,0]
    v_pk_add_f32 v[140:141], v[140:141], 1.0 op_sel_hi:[1,0]
    v_pk_add_f32 v[142:143], v[142:143], 1.0 op_sel_hi:[1,0]
    v_rcp_f32 v136, v136
    v_rcp_f32 v137, v137
    v_rcp_f32 v138, v138
    v_rcp_f32 v139, v139
    v_rcp_f32 v140, v140
    v_rcp_f32 v141, v141
    v_rcp_f32 v142, v142
    v_rcp_f32 v143, v143
    s_nop 0
    v_pk_mul_f32 v[136:137], v[136:137], v[220:221]
    v_pk_mul_f32 v[138:139], v[138:139], v[222:223]
    v_pk_mul_f32 v[140:141], v[140:141], v[252:253]
    v_pk_mul_f32 v[142:143], v[142:143], v[254:255]
    v_cvt_pk_bf16_f32 v220, v136, v137
    v_cvt_pk_bf16_f32 v221, v138, v139
    v_cvt_pk_bf16_f32 v222, v140, v141
    v_cvt_pk_bf16_f32 v223, v142, v143
    v_mov_b32 v64, 0
    v_mov_b32 v65, 0
    v_mov_b32 v66, 0
    v_mov_b32 v67, 0
    v_mfma_f32_32x32x16_bf16 v[100:115], v[36:39], v[36:39], 0
    v_mfma_f32_32x32x16_bf16 v[116:131], v[36:39], v[36:39], 0
    v_mov_b32 v132, 0
    v_mov_b32 v133, 0
    v_mov_b32 v134, 0
    v_mov_b32 v135, 0
    s_waitcnt vmcnt(8)
    s_barrier
    ds_read_b128 v[28:31], v6 offset:0
    ds_read_b128 v[32:35], v6 offset:512
    s_waitcnt lgkmcnt(0)
    v_mfma_f32_32x32x16_bf16 v[68:83], v[28:31], v[12:15], 0
    v_mfma_f32_32x32x16_bf16 v[68:83], v[32:35], v[16:19], v[68:83]
    s_nop 11
    v_mfma_f32_32x32x16_bf16 v[84:99], v[28:31], v[20:23], 0
    ds_read_b128 v[28:31], v6 offset:2048
    v_exp_f32 v68, v68
    v_exp_f32 v69, v69
    v_cvt_pk_bf16_f32 v66, v172, v173
    v_cvt_pk_bf16_f32 v67, v174, v175
    v_mfma_f32_32x32x16_bf16 v[84:99], v[32:35], v[24:27], v[84:99]
    ds_read_b128 v[32:35], v6 offset:2560
    v_exp_f32 v70, v70
    v_exp_f32 v71, v71
    v_exp_f32 v72, v72
    v_mfma_f32_32x32x16_bf16 v[116:131], v[36:39], v[60:63], v[116:131]
    ds_read_b64_tr_b16 v[36:37], v7 offset:8192
    ds_read_b64_tr_b16 v[38:39], v164 offset:8192
    v_exp_f32 v73, v73
    v_cvt_pk_bf16_f32 v52, v68, v69
    v_exp_f32 v74, v74
    v_cvt_pk_bf16_f32 v53, v70, v71
    v_mfma_f32_32x32x16_bf16 v[116:131], v[40:43], v[64:67], v[116:131]
    s_waitcnt lgkmcnt(2)
    ds_read_b64_tr_b16 v[40:41], v7 offset:9216
    buffer_store_dwordx4 v[192:195], v184, s[32:35], s3 offen offset:0 sc1
    v_exp_f32 v75, v75
    v_exp_f32 v76, v76
    v_exp_f32 v77, v77
    v_smfmac_f32_16x16x64_bf16 v[48:51], v[8:11], v[60:67], v166
    ds_read_b64_tr_b16 v[42:43], v164 offset:9216
    v_cvt_pk_bf16_f32 v54, v72, v73
    v_exp_f32 v78, v78
    v_cvt_pk_bf16_f32 v55, v74, v75
    v_exp_f32 v79, v79
    v_exp_f32 v168, v80
    v_cvt_pk_bf16_f32 v56, v76, v77
    v_exp_f32 v169, v81
    v_exp_f32 v170, v82
    v_cvt_pk_bf16_f32 v57, v78, v79
    v_exp_f32 v171, v83
    v_mfma_f32_32x32x16_bf16 v[68:83], v[28:31], v[12:15], 0
    s_add_u32 m0, s98, 0
    v_exp_f32 v84, v84
    v_exp_f32 v85, v85
    v_cvt_pk_bf16_f32 v58, v168, v169
    v_cvt_pk_bf16_f32 v59, v170, v171
    v_mfma_f32_32x32x16_bf16 v[68:83], v[32:35], v[16:19], v[68:83]
    s_waitcnt lgkmcnt(0)
    s_mov_b32 s50, 0
    buffer_load_dwordx4 v167, s[92:95], s50 offen lds
    v_exp_f32 v86, v86
    v_exp_f32 v87, v87
    v_exp_f32 v88, v88
    v_mfma_f32_32x32x16_bf16 v[100:115], v[36:39], v[52:55], v[100:115]
    v_exp_f32 v89, v89
    v_cvt_pk_bf16_f32 v60, v84, v85
    v_exp_f32 v90, v90
    v_cvt_pk_bf16_f32 v61, v86, v87
    v_mfma_f32_32x32x16_bf16 v[100:115], v[40:43], v[56:59], v[100:115]
    buffer_store_dwordx4 v[196:199], v184, s[32:35], s3 offen offset:1024 sc1
    v_exp_f32 v91, v91
    v_exp_f32 v92, v92
    v_exp_f32 v93, v93
    v_smfmac_f32_16x16x64_bf16 v[44:47], v[8:11], v[52:59], v166
    s_add_u32 s26, s26, 16384
    s_and_b32 s26, s26, 65535
    v_cvt_pk_bf16_f32 v62, v88, v89
    v_exp_f32 v94, v94
    v_cvt_pk_bf16_f32 v63, v90, v91
    v_exp_f32 v95, v95
    v_exp_f32 v172, v96
    v_cvt_pk_bf16_f32 v64, v92, v93
    v_exp_f32 v173, v97
    v_exp_f32 v174, v98
    v_cvt_pk_bf16_f32 v65, v94, v95
    v_exp_f32 v175, v99
    v_mfma_f32_32x32x16_bf16 v[84:99], v[28:31], v[20:23], 0
    ds_read_b128 v[28:31], v6 offset:4096
    v_exp_f32 v68, v68
    v_exp_f32 v69, v69
    v_cvt_pk_bf16_f32 v66, v172, v173
    v_cvt_pk_bf16_f32 v67, v174, v175
    v_mfma_f32_32x32x16_bf16 v[84:99], v[32:35], v[24:27], v[84:99]
    ds_read_b128 v[32:35], v6 offset:4608
    v_exp_f32 v70, v70
    v_exp_f32 v71, v71
    v_exp_f32 v72, v72
    v_mfma_f32_32x32x16_bf16 v[116:131], v[36:39], v[60:63], v[116:131]
    ds_read_b64_tr_b16 v[36:37], v7 offset:10240
    ds_read_b64_tr_b16 v[38:39], v164 offset:10240
    v_exp_f32 v73, v73
    v_cvt_pk_bf16_f32 v52, v68, v69
    v_exp_f32 v74, v74
    v_cvt_pk_bf16_f32 v53, v70, v71
    v_mfma_f32_32x32x16_bf16 v[116:131], v[40:43], v[64:67], v[116:131]
    s_waitcnt lgkmcnt(2)
    ds_read_b64_tr_b16 v[40:41], v7 offset:11264
    buffer_store_dwordx4 v[200:203], v184, s[32:35], s3 offen offset:2048 sc1
    v_exp_f32 v75, v75
    v_exp_f32 v76, v76
    v_exp_f32 v77, v77
    v_smfmac_f32_16x16x64_bf16 v[48:51], v[8:11], v[60:67], v166
    ds_read_b64_tr_b16 v[42:43], v164 offset:11264
    v_cvt_pk_bf16_f32 v54, v72, v73
    v_exp_f32 v78, v78
    v_cvt_pk_bf16_f32 v55, v74, v75
    v_exp_f32 v79, v79
    v_exp_f32 v168, v80
    v_cvt_pk_bf16_f32 v56, v76, v77
    v_exp_f32 v169, v81
    v_exp_f32 v170, v82
    v_cvt_pk_bf16_f32 v57, v78, v79
    v_exp_f32 v171, v83
    v_mfma_f32_32x32x16_bf16 v[68:83], v[28:31], v[12:15], 0
    s_add_u32 m0, s98, 1024
    v_exp_f32 v84, v84
    v_exp_f32 v85, v85
    v_cvt_pk_bf16_f32 v58, v168, v169
    v_cvt_pk_bf16_f32 v59, v170, v171
    v_mfma_f32_32x32x16_bf16 v[68:83], v[32:35], v[16:19], v[68:83]
    s_waitcnt lgkmcnt(0)
    s_mov_b32 s50, 16384
    buffer_load_dwordx4 v167, s[92:95], s50 offen lds
    v_exp_f32 v86, v86
    v_exp_f32 v87, v87
    v_exp_f32 v88, v88
    v_mfma_f32_32x32x16_bf16 v[100:115], v[36:39], v[52:55], v[100:115]
    v_exp_f32 v89, v89
    v_cvt_pk_bf16_f32 v60, v84, v85
    v_exp_f32 v90, v90
    v_cvt_pk_bf16_f32 v61, v86, v87
    v_mfma_f32_32x32x16_bf16 v[100:115], v[40:43], v[56:59], v[100:115]
    buffer_store_dwordx4 v[204:207], v184, s[32:35], s3 offen offset:3072 sc1
    v_exp_f32 v91, v91
    v_exp_f32 v92, v92
    v_exp_f32 v93, v93
    v_smfmac_f32_16x16x64_bf16 v[44:47], v[8:11], v[52:59], v166
    v_cvt_pk_bf16_f32 v62, v88, v89
    v_exp_f32 v94, v94
    v_cvt_pk_bf16_f32 v63, v90, v91
    v_exp_f32 v95, v95
    v_exp_f32 v172, v96
    v_cvt_pk_bf16_f32 v64, v92, v93
    v_exp_f32 v173, v97
    v_exp_f32 v174, v98
    v_cvt_pk_bf16_f32 v65, v94, v95
    v_exp_f32 v175, v99
    v_mfma_f32_32x32x16_bf16 v[84:99], v[28:31], v[20:23], 0
    ds_read_b128 v[28:31], v6 offset:6144
    v_exp_f32 v68, v68
    v_exp_f32 v69, v69
    v_cvt_pk_bf16_f32 v66, v172, v173
    v_cvt_pk_bf16_f32 v67, v174, v175
    v_mfma_f32_32x32x16_bf16 v[84:99], v[32:35], v[24:27], v[84:99]
    ds_read_b128 v[32:35], v6 offset:6656
    v_exp_f32 v70, v70
    v_exp_f32 v71, v71
    v_exp_f32 v72, v72
    v_mfma_f32_32x32x16_bf16 v[116:131], v[36:39], v[60:63], v[116:131]
    ds_read_b64_tr_b16 v[36:37], v7 offset:12288
    ds_read_b64_tr_b16 v[38:39], v164 offset:12288
    v_exp_f32 v73, v73
    v_cvt_pk_bf16_f32 v52, v68, v69
    v_exp_f32 v74, v74
    v_cvt_pk_bf16_f32 v53, v70, v71
    v_mfma_f32_32x32x16_bf16 v[116:131], v[40:43], v[64:67], v[116:131]
    s_waitcnt lgkmcnt(2)
    ds_read_b64_tr_b16 v[40:41], v7 offset:13312
    buffer_store_dwordx4 v[208:211], v185, s[32:35], s3 offen offset:0 sc1
    v_exp_f32 v75, v75
    v_exp_f32 v76, v76
    v_exp_f32 v77, v77
    v_smfmac_f32_16x16x64_bf16 v[48:51], v[8:11], v[60:67], v166
    ds_read_b64_tr_b16 v[42:43], v164 offset:13312
    v_cvt_pk_bf16_f32 v54, v72, v73
    v_exp_f32 v78, v78
    v_cvt_pk_bf16_f32 v55, v74, v75
    v_exp_f32 v79, v79
    v_exp_f32 v168, v80
    v_cvt_pk_bf16_f32 v56, v76, v77
    v_exp_f32 v169, v81
    v_exp_f32 v170, v82
    v_cvt_pk_bf16_f32 v57, v78, v79
    v_exp_f32 v171, v83
    v_mfma_f32_32x32x16_bf16 v[68:83], v[28:31], v[12:15], 0
    s_add_u32 m0, s98, 2048
    v_exp_f32 v84, v84
    v_exp_f32 v85, v85
    v_cvt_pk_bf16_f32 v58, v168, v169
    v_cvt_pk_bf16_f32 v59, v170, v171
    v_mfma_f32_32x32x16_bf16 v[68:83], v[32:35], v[16:19], v[68:83]
    s_waitcnt lgkmcnt(0)
    s_mov_b32 s50, 32768
    buffer_load_dwordx4 v167, s[92:95], s50 offen lds
    v_exp_f32 v86, v86
    v_exp_f32 v87, v87
    v_exp_f32 v88, v88
    v_mfma_f32_32x32x16_bf16 v[100:115], v[36:39], v[52:55], v[100:115]
    v_exp_f32 v89, v89
    v_cvt_pk_bf16_f32 v60, v84, v85
    v_exp_f32 v90, v90
    v_cvt_pk_bf16_f32 v61, v86, v87
    v_mfma_f32_32x32x16_bf16 v[100:115], v[40:43], v[56:59], v[100:115]
    buffer_store_dwordx4 v[212:215], v185, s[32:35], s3 offen offset:1024 sc1
    v_exp_f32 v91, v91
    v_exp_f32 v92, v92
    v_exp_f32 v93, v93
    v_smfmac_f32_16x16x64_bf16 v[44:47], v[8:11], v[52:59], v166
    s_add_u32 s23, s23, 8192
    v_cvt_pk_bf16_f32 v62, v88, v89
    v_exp_f32 v94, v94
    v_cvt_pk_bf16_f32 v63, v90, v91
    v_exp_f32 v95, v95
    v_exp_f32 v172, v96
    v_cvt_pk_bf16_f32 v64, v92, v93
    v_exp_f32 v173, v97
    v_exp_f32 v174, v98
    v_cvt_pk_bf16_f32 v65, v94, v95
    v_exp_f32 v175, v99
    v_add_u32 v6, s26, v4
    v_mfma_f32_32x32x16_bf16 v[84:99], v[28:31], v[20:23], 0
    s_waitcnt vmcnt(13)
    s_barrier
    ds_read_b128 v[28:31], v6 offset:0
    v_exp_f32 v68, v68
    v_exp_f32 v69, v69
    v_cvt_pk_bf16_f32 v66, v172, v173
    v_cvt_pk_bf16_f32 v67, v174, v175
    v_mfma_f32_32x32x16_bf16 v[84:99], v[32:35], v[24:27], v[84:99]
    s_add_u32 s25, s25, 16384
    ds_read_b128 v[32:35], v6 offset:512
    v_exp_f32 v70, v70
    v_exp_f32 v71, v71
    v_exp_f32 v72, v72
    v_mfma_f32_32x32x16_bf16 v[116:131], v[36:39], v[60:63], v[116:131]
    s_and_b32 s25, s25, 65535
    ds_read_b64_tr_b16 v[36:37], v7 offset:14336
    ds_read_b64_tr_b16 v[38:39], v164 offset:14336
    v_exp_f32 v73, v73
    v_cvt_pk_bf16_f32 v52, v68, v69
    v_exp_f32 v74, v74
    v_cvt_pk_bf16_f32 v53, v70, v71
    v_mfma_f32_32x32x16_bf16 v[116:131], v[40:43], v[64:67], v[116:131]
    s_waitcnt lgkmcnt(2)
    ds_read_b64_tr_b16 v[40:41], v7 offset:15360
    buffer_store_dwordx4 v[216:219], v185, s[32:35], s3 offen offset:2048 sc1
    v_exp_f32 v75, v75
    v_exp_f32 v76, v76
    v_exp_f32 v77, v77
    v_smfmac_f32_16x16x64_bf16 v[48:51], v[8:11], v[60:67], v166
    ds_read_b64_tr_b16 v[42:43], v164 offset:15360
    v_cvt_pk_bf16_f32 v54, v72, v73
    v_exp_f32 v78, v78
    v_cvt_pk_bf16_f32 v55, v74, v75
    v_exp_f32 v79, v79
    v_exp_f32 v168, v80
    v_cvt_pk_bf16_f32 v56, v76, v77
    v_exp_f32 v169, v81
    v_exp_f32 v170, v82
    v_cvt_pk_bf16_f32 v57, v78, v79
    v_exp_f32 v171, v83
    v_mfma_f32_32x32x16_bf16 v[68:83], v[28:31], v[12:15], 0
    s_add_u32 m0, s98, 3072
    v_exp_f32 v84, v84
    v_exp_f32 v85, v85
    v_cvt_pk_bf16_f32 v58, v168, v169
    v_cvt_pk_bf16_f32 v59, v170, v171
    v_mfma_f32_32x32x16_bf16 v[68:83], v[32:35], v[16:19], v[68:83]
    s_waitcnt lgkmcnt(0)
    s_mov_b32 s50, 49152
    buffer_load_dwordx4 v167, s[92:95], s50 offen lds
    v_exp_f32 v86, v86
    v_exp_f32 v87, v87
    v_exp_f32 v88, v88
    v_mfma_f32_32x32x16_bf16 v[100:115], v[36:39], v[52:55], v[100:115]
    s_mov_b32 m0, s25
    v_exp_f32 v89, v89
    v_cvt_pk_bf16_f32 v60, v84, v85
    v_exp_f32 v90, v90
    v_cvt_pk_bf16_f32 v61, v86, v87
    v_mfma_f32_32x32x16_bf16 v[100:115], v[40:43], v[56:59], v[100:115]
    buffer_load_dwordx4 v2, s[8:11], s23 offen sc1 lds
    buffer_store_dwordx4 v[220:223], v185, s[32:35], s3 offen offset:3072 sc1
    v_exp_f32 v91, v91
    v_exp_f32 v92, v92
    v_exp_f32 v93, v93
    v_smfmac_f32_16x16x64_bf16 v[44:47], v[8:11], v[52:59], v166
    v_cvt_pk_bf16_f32 v62, v88, v89
    v_exp_f32 v94, v94
    v_cvt_pk_bf16_f32 v63, v90, v91
    v_exp_f32 v95, v95
    v_exp_f32 v172, v96
    v_cvt_pk_bf16_f32 v64, v92, v93
    v_exp_f32 v173, v97
    v_exp_f32 v174, v98
    v_cvt_pk_bf16_f32 v65, v94, v95
    v_exp_f32 v175, v99
    v_add_u32 v7, s26, v5
    v_add_u32 v164, s26, v165
    v_mfma_f32_32x32x16_bf16 v[84:99], v[28:31], v[20:23], 0
    ds_read_b128 v[28:31], v6 offset:2048
    v_exp_f32 v68, v68
    v_exp_f32 v69, v69
    v_cvt_pk_bf16_f32 v66, v172, v173
    v_cvt_pk_bf16_f32 v67, v174, v175
    v_mfma_f32_32x32x16_bf16 v[84:99], v[32:35], v[24:27], v[84:99]
    ds_read_b128 v[32:35], v6 offset:2560
    v_exp_f32 v70, v70
    v_exp_f32 v71, v71
    v_exp_f32 v72, v72
    v_mfma_f32_32x32x16_bf16 v[116:131], v[36:39], v[60:63], v[116:131]
    ds_read_b64_tr_b16 v[36:37], v7 offset:8192
    ds_read_b64_tr_b16 v[38:39], v164 offset:8192
    v_exp_f32 v73, v73
    v_cvt_pk_bf16_f32 v52, v68, v69
    v_exp_f32 v74, v74
    v_cvt_pk_bf16_f32 v53, v70, v71
    v_mfma_f32_32x32x16_bf16 v[116:131], v[40:43], v[64:67], v[116:131]
    s_waitcnt lgkmcnt(2)
    ds_read_b64_tr_b16 v[40:41], v7 offset:9216
    v_exp_f32 v75, v75
    v_exp_f32 v76, v76
    v_exp_f32 v77, v77
    v_smfmac_f32_16x16x64_bf16 v[48:51], v[8:11], v[60:67], v166
    ds_read_b64_tr_b16 v[42:43], v164 offset:9216
    v_cvt_pk_bf16_f32 v54, v72, v73
    v_exp_f32 v78, v78
    v_cvt_pk_bf16_f32 v55, v74, v75
    v_mfma_f32_32x32x16_bf16 a[0:15], v[132:135], v[132:135], 0
    v_exp_f32 v79, v79
    v_exp_f32 v168, v80
    v_cvt_pk_bf16_f32 v56, v76, v77
    v_exp_f32 v169, v81
    v_exp_f32 v170, v82
    v_cvt_pk_bf16_f32 v57, v78, v79
    v_exp_f32 v171, v83
    v_mfma_f32_32x32x16_bf16 v[68:83], v[28:31], v[12:15], 0
    v_exp_f32 v84, v84
    v_exp_f32 v85, v85
    v_cvt_pk_bf16_f32 v58, v168, v169
    v_cvt_pk_bf16_f32 v59, v170, v171
    v_mfma_f32_32x32x16_bf16 v[68:83], v[32:35], v[16:19], v[68:83]
    s_waitcnt lgkmcnt(0)
    v_exp_f32 v86, v86
    v_exp_f32 v87, v87
    v_exp_f32 v88, v88
    v_mfma_f32_32x32x16_bf16 v[100:115], v[36:39], v[52:55], v[100:115]
    s_mov_b32 m0, s25
    v_exp_f32 v89, v89
    v_cvt_pk_bf16_f32 v60, v84, v85
    v_exp_f32 v90, v90
    v_cvt_pk_bf16_f32 v61, v86, v87
    v_mfma_f32_32x32x16_bf16 v[100:115], v[40:43], v[56:59], v[100:115]
    buffer_load_dwordx4 v2, s[8:11], s23 offen offset:1024 sc1 lds
    v_exp_f32 v91, v91
    v_exp_f32 v92, v92
    v_exp_f32 v93, v93
    v_smfmac_f32_16x16x64_bf16 v[44:47], v[8:11], v[52:59], v166
    s_add_u32 s26, s26, 16384
    s_and_b32 s26, s26, 65535
    v_cvt_pk_bf16_f32 v62, v88, v89
    v_exp_f32 v94, v94
    v_cvt_pk_bf16_f32 v63, v90, v91
    v_mfma_f32_32x32x16_bf16 a[16:31], v[132:135], v[132:135], 0
    v_exp_f32 v95, v95
    v_exp_f32 v172, v96
    v_cvt_pk_bf16_f32 v64, v92, v93
    v_exp_f32 v173, v97
    v_exp_f32 v174, v98
    v_cvt_pk_bf16_f32 v65, v94, v95
    v_exp_f32 v175, v99
    v_mfma_f32_32x32x16_bf16 v[84:99], v[28:31], v[20:23], 0
    ds_read_b128 v[28:31], v6 offset:4096
    v_exp_f32 v68, v68
    v_exp_f32 v69, v69
    v_cvt_pk_bf16_f32 v66, v172, v173
    v_cvt_pk_bf16_f32 v67, v174, v175
    v_mfma_f32_32x32x16_bf16 v[84:99], v[32:35], v[24:27], v[84:99]
    ds_read_b128 v[32:35], v6 offset:4608
    v_exp_f32 v70, v70
    v_exp_f32 v71, v71
    v_exp_f32 v72, v72
    v_mfma_f32_32x32x16_bf16 v[116:131], v[36:39], v[60:63], v[116:131]
    ds_read_b64_tr_b16 v[36:37], v7 offset:10240
    ds_read_b64_tr_b16 v[38:39], v164 offset:10240
    v_exp_f32 v73, v73
    v_cvt_pk_bf16_f32 v52, v68, v69
    v_exp_f32 v74, v74
    v_cvt_pk_bf16_f32 v53, v70, v71
    v_mfma_f32_32x32x16_bf16 v[116:131], v[40:43], v[64:67], v[116:131]
    s_waitcnt lgkmcnt(2)
    ds_read_b64_tr_b16 v[40:41], v7 offset:11264
    v_exp_f32 v75, v75
    v_exp_f32 v76, v76
    v_exp_f32 v77, v77
    v_smfmac_f32_16x16x64_bf16 v[48:51], v[8:11], v[60:67], v166
    ds_read_b64_tr_b16 v[42:43], v164 offset:11264
    v_cvt_pk_bf16_f32 v54, v72, v73
    v_exp_f32 v78, v78
    v_cvt_pk_bf16_f32 v55, v74, v75
    v_mfma_f32_32x32x16_bf16 a[32:47], v[132:135], v[132:135], 0
    v_exp_f32 v79, v79
    v_exp_f32 v168, v80
    v_cvt_pk_bf16_f32 v56, v76, v77
    v_exp_f32 v169, v81
    v_exp_f32 v170, v82
    v_cvt_pk_bf16_f32 v57, v78, v79
    v_exp_f32 v171, v83
    v_mfma_f32_32x32x16_bf16 v[68:83], v[28:31], v[12:15], 0
    v_exp_f32 v84, v84
    v_exp_f32 v85, v85
    v_cvt_pk_bf16_f32 v58, v168, v169
    v_cvt_pk_bf16_f32 v59, v170, v171
    v_mfma_f32_32x32x16_bf16 v[68:83], v[32:35], v[16:19], v[68:83]
    s_waitcnt lgkmcnt(0)
    v_exp_f32 v86, v86
    v_exp_f32 v87, v87
    v_exp_f32 v88, v88
    v_mfma_f32_32x32x16_bf16 v[100:115], v[36:39], v[52:55], v[100:115]
    s_add_u32 m0, s25, 8192
    v_exp_f32 v89, v89
    v_cvt_pk_bf16_f32 v60, v84, v85
    v_exp_f32 v90, v90
    v_cvt_pk_bf16_f32 v61, v86, v87
    v_mfma_f32_32x32x16_bf16 v[100:115], v[40:43], v[56:59], v[100:115]
    buffer_load_dwordx4 v3, s[12:15], s23 offen sc1 lds
    v_exp_f32 v91, v91
    v_exp_f32 v92, v92
    v_exp_f32 v93, v93
    v_smfmac_f32_16x16x64_bf16 v[44:47], v[8:11], v[52:59], v166
    v_cvt_pk_bf16_f32 v62, v88, v89
    v_exp_f32 v94, v94
    v_cvt_pk_bf16_f32 v63, v90, v91
    v_mfma_f32_32x32x16_bf16 a[48:63], v[132:135], v[132:135], 0
    v_exp_f32 v95, v95
    v_exp_f32 v172, v96
    v_cvt_pk_bf16_f32 v64, v92, v93
    v_exp_f32 v173, v97
    v_exp_f32 v174, v98
    v_cvt_pk_bf16_f32 v65, v94, v95
    v_exp_f32 v175, v99
    v_mfma_f32_32x32x16_bf16 v[84:99], v[28:31], v[20:23], 0
    ds_read_b128 v[28:31], v6 offset:6144
    v_exp_f32 v68, v68
    v_exp_f32 v69, v69
    v_cvt_pk_bf16_f32 v66, v172, v173
    v_cvt_pk_bf16_f32 v67, v174, v175
    v_mfma_f32_32x32x16_bf16 v[84:99], v[32:35], v[24:27], v[84:99]
    ds_read_b128 v[32:35], v6 offset:6656
    v_exp_f32 v70, v70
    v_exp_f32 v71, v71
    v_exp_f32 v72, v72
    v_mfma_f32_32x32x16_bf16 v[116:131], v[36:39], v[60:63], v[116:131]
    ds_read_b64_tr_b16 v[36:37], v7 offset:12288
    ds_read_b64_tr_b16 v[38:39], v164 offset:12288
    s_waitcnt vmcnt(2)
    s_mov_b32 exec_hi, 0
    buffer_store_dword v160, v161, s[40:43], s78 offen sc1
    s_mov_b64 exec, -1
    v_exp_f32 v73, v73
    v_cvt_pk_bf16_f32 v52, v68, v69
    v_exp_f32 v74, v74
    v_cvt_pk_bf16_f32 v53, v70, v71
    v_mfma_f32_32x32x16_bf16 v[116:131], v[40:43], v[64:67], v[116:131]
    s_waitcnt lgkmcnt(2)
    ds_read_b64_tr_b16 v[40:41], v7 offset:13312
    v_exp_f32 v75, v75
    v_exp_f32 v76, v76
    v_exp_f32 v77, v77
    v_smfmac_f32_16x16x64_bf16 v[48:51], v[8:11], v[60:67], v166
    ds_read_b64_tr_b16 v[42:43], v164 offset:13312
    v_cvt_pk_bf16_f32 v54, v72, v73
    v_exp_f32 v78, v78
    v_cvt_pk_bf16_f32 v55, v74, v75
    v_mfma_f32_32x32x16_bf16 a[64:79], v[132:135], v[132:135], 0
    v_exp_f32 v79, v79
    v_exp_f32 v168, v80
    v_cvt_pk_bf16_f32 v56, v76, v77
    v_exp_f32 v169, v81
    v_exp_f32 v170, v82
    v_cvt_pk_bf16_f32 v57, v78, v79
    v_exp_f32 v171, v83
    v_mfma_f32_32x32x16_bf16 v[68:83], v[28:31], v[12:15], 0
    ds_read_b128 v[192:195], v148
    ds_read_b128 v[196:199], v149
    v_exp_f32 v84, v84
    v_exp_f32 v85, v85
    v_cvt_pk_bf16_f32 v58, v168, v169
    v_cvt_pk_bf16_f32 v59, v170, v171
    v_mfma_f32_32x32x16_bf16 v[68:83], v[32:35], v[16:19], v[68:83]
    s_waitcnt lgkmcnt(2)
    v_exp_f32 v86, v86
    v_exp_f32 v87, v87
    v_exp_f32 v88, v88
    v_mfma_f32_32x32x16_bf16 v[100:115], v[36:39], v[52:55], v[100:115]
    s_add_u32 m0, s25, 8192
    v_exp_f32 v89, v89
    v_cvt_pk_bf16_f32 v60, v84, v85
    v_exp_f32 v90, v90
    v_cvt_pk_bf16_f32 v61, v86, v87
    v_mfma_f32_32x32x16_bf16 v[100:115], v[40:43], v[56:59], v[100:115]
    buffer_load_dwordx4 v3, s[12:15], s23 offen offset:1024 sc1 lds
    v_exp_f32 v91, v91
    v_exp_f32 v92, v92
    v_exp_f32 v93, v93
    v_smfmac_f32_16x16x64_bf16 v[44:47], v[8:11], v[52:59], v166
    s_add_u32 s23, s23, 8192
    v_cvt_pk_bf16_f32 v62, v88, v89
    v_exp_f32 v94, v94
    v_cvt_pk_bf16_f32 v63, v90, v91
    v_mfma_f32_32x32x16_bf16 a[80:95], v[132:135], v[132:135], 0
    v_exp_f32 v95, v95
    v_exp_f32 v172, v96
    v_cvt_pk_bf16_f32 v64, v92, v93
    v_exp_f32 v173, v97
    v_exp_f32 v174, v98
    v_cvt_pk_bf16_f32 v65, v94, v95
    v_exp_f32 v175, v99
    v_add_u32 v6, s26, v4
    v_mfma_f32_32x32x16_bf16 v[84:99], v[28:31], v[20:23], 0
    s_barrier
    ds_read_b128 v[28:31], v6 offset:0
    v_exp_f32 v68, v68
    v_exp_f32 v69, v69
    v_cvt_pk_bf16_f32 v66, v172, v173
    v_cvt_pk_bf16_f32 v67, v174, v175
    v_mfma_f32_32x32x16_bf16 v[84:99], v[32:35], v[24:27], v[84:99]
    s_add_u32 s25, s25, 16384
    ds_read_b128 v[32:35], v6 offset:512
    v_exp_f32 v70, v70
    v_exp_f32 v71, v71
    v_exp_f32 v72, v72
    v_mfma_f32_32x32x16_bf16 v[116:131], v[36:39], v[60:63], v[116:131]
    s_and_b32 s25, s25, 65535
    ds_read_b64_tr_b16 v[36:37], v7 offset:14336
    ds_read_b64_tr_b16 v[38:39], v164 offset:14336
    v_exp_f32 v73, v73
    v_cvt_pk_bf16_f32 v52, v68, v69
    v_exp_f32 v74, v74
    v_cvt_pk_bf16_f32 v53, v70, v71
    v_mfma_f32_32x32x16_bf16 v[116:131], v[40:43], v[64:67], v[116:131]
    s_waitcnt lgkmcnt(2)
    ds_read_b64_tr_b16 v[40:41], v7 offset:15360
    v_exp_f32 v75, v75
    v_exp_f32 v76, v76
    v_exp_f32 v77, v77
    v_smfmac_f32_16x16x64_bf16 v[48:51], v[8:11], v[60:67], v166
    ds_read_b64_tr_b16 v[42:43], v164 offset:15360
    v_cvt_pk_bf16_f32 v54, v72, v73
    v_exp_f32 v78, v78
    v_cvt_pk_bf16_f32 v55, v74, v75
    v_mfma_f32_32x32x16_bf16 a[96:111], v[132:135], v[132:135], 0
    v_exp_f32 v79, v79
    v_exp_f32 v168, v80
    v_cvt_pk_bf16_f32 v56, v76, v77
    v_exp_f32 v169, v81
    v_exp_f32 v170, v82
    v_cvt_pk_bf16_f32 v57, v78, v79
    v_exp_f32 v171, v83
    v_mfma_f32_32x32x16_bf16 v[68:83], v[28:31], v[12:15], 0
    ds_read_b128 v[200:203], v150
    ds_read_b128 v[204:207], v151
    v_exp_f32 v84, v84
    v_exp_f32 v85, v85
    v_cvt_pk_bf16_f32 v58, v168, v169
    v_cvt_pk_bf16_f32 v59, v170, v171
    v_mfma_f32_32x32x16_bf16 v[68:83], v[32:35], v[16:19], v[68:83]
    s_waitcnt lgkmcnt(2)
    v_exp_f32 v86, v86
    v_exp_f32 v87, v87
    v_exp_f32 v88, v88
    v_mfma_f32_32x32x16_bf16 v[100:115], v[36:39], v[52:55], v[100:115]
    s_mov_b32 m0, s25
    v_exp_f32 v89, v89
    v_cvt_pk_bf16_f32 v60, v84, v85
    v_exp_f32 v90, v90
    v_cvt_pk_bf16_f32 v61, v86, v87
    v_mfma_f32_32x32x16_bf16 v[100:115], v[40:43], v[56:59], v[100:115]
    buffer_load_dwordx4 v2, s[8:11], s23 offen sc1 lds
    v_exp_f32 v91, v91
    v_exp_f32 v92, v92
    v_exp_f32 v93, v93
    v_smfmac_f32_16x16x64_bf16 v[44:47], v[8:11], v[52:59], v166
    v_cvt_pk_bf16_f32 v62, v88, v89
    v_exp_f32 v94, v94
    v_cvt_pk_bf16_f32 v63, v90, v91
    v_mfma_f32_32x32x16_bf16 a[112:127], v[132:135], v[132:135], 0
    v_exp_f32 v95, v95
    v_exp_f32 v172, v96
    v_cvt_pk_bf16_f32 v64, v92, v93
    v_exp_f32 v173, v97
    v_exp_f32 v174, v98
    v_cvt_pk_bf16_f32 v65, v94, v95
    v_exp_f32 v175, v99
    v_add_u32 v7, s26, v5
    v_add_u32 v164, s26, v165
    v_mfma_f32_32x32x16_bf16 v[84:99], v[28:31], v[20:23], 0
    ds_read_b128 v[28:31], v6 offset:2048
    s_add_u32 s4, s74, 33554432
    s_addc_u32 s5, s75, 0
    s_mov_b32 s6, 4194304
    s_mov_b32 s7, 0x20000
    v_exp_f32 v68, v68
    v_exp_f32 v69, v69
    v_cvt_pk_bf16_f32 v66, v172, v173
    v_cvt_pk_bf16_f32 v67, v174, v175
    v_mfma_f32_32x32x16_bf16 v[84:99], v[32:35], v[24:27], v[84:99]
    s_add_u32 m0, s48, 0
    ds_read_b128 v[32:35], v6 offset:2560
    v_exp_f32 v70, v70
    v_exp_f32 v71, v71
    v_exp_f32 v72, v72
    v_mfma_f32_32x32x16_bf16 v[116:131], v[36:39], v[60:63], v[116:131]
    ds_read_b64_tr_b16 v[36:37], v7 offset:8192
    ds_read_b64_tr_b16 v[38:39], v164 offset:8192
    s_mov_b32 s30, 0
    s_mov_b32 s49, 0
    v_exp_f32 v73, v73
    v_cvt_pk_bf16_f32 v52, v68, v69
    v_exp_f32 v74, v74
    v_cvt_pk_bf16_f32 v53, v70, v71
    v_mfma_f32_32x32x16_bf16 v[116:131], v[40:43], v[64:67], v[116:131]
    s_waitcnt lgkmcnt(2)
    ds_read_b64_tr_b16 v[40:41], v7 offset:9216
    buffer_load_dwordx4 v180, s[36:39], s47 offen lds
    v_exp_f32 v75, v75
    v_exp_f32 v76, v76
    v_exp_f32 v77, v77
    v_smfmac_f32_16x16x64_bf16 v[48:51], v[8:11], v[60:67], v166
    s_add_u32 s47, s47, 16384
    ds_read_b64_tr_b16 v[42:43], v164 offset:9216
    v_cvt_pk_bf16_f32 v54, v72, v73
    v_exp_f32 v78, v78
    v_cvt_pk_bf16_f32 v55, v74, v75
    v_exp_f32 v79, v79
    v_exp_f32 v168, v80
    v_cvt_pk_bf16_f32 v56, v76, v77
    v_exp_f32 v169, v81
    v_exp_f32 v170, v82
    v_cvt_pk_bf16_f32 v57, v78, v79
    v_exp_f32 v171, v83
    v_mfma_f32_32x32x16_bf16 v[68:83], v[28:31], v[12:15], 0
    s_add_u32 m0, s48, 1024
    v_exp_f32 v84, v84
    v_exp_f32 v85, v85
    v_cvt_pk_bf16_f32 v58, v168, v169
    v_cvt_pk_bf16_f32 v59, v170, v171
    v_mfma_f32_32x32x16_bf16 v[68:83], v[32:35], v[16:19], v[68:83]
    s_waitcnt lgkmcnt(0)
    buffer_load_dwordx4 v180, s[36:39], s47 offen lds
    v_exp_f32 v86, v86
    v_exp_f32 v87, v87
    v_exp_f32 v88, v88
    v_mfma_f32_32x32x16_bf16 v[100:115], v[36:39], v[52:55], v[100:115]
    s_mov_b32 m0, s25
    v_exp_f32 v89, v89
    v_cvt_pk_bf16_f32 v60, v84, v85
    v_exp_f32 v90, v90
    v_cvt_pk_bf16_f32 v61, v86, v87
    v_mfma_f32_32x32x16_bf16 v[100:115], v[40:43], v[56:59], v[100:115]
    s_add_u32 s47, s47, 16384
    buffer_load_dwordx4 v2, s[8:11], s23 offen offset:1024 sc1 lds
    v_exp_f32 v91, v91
    v_exp_f32 v92, v92
    v_exp_f32 v93, v93
    v_smfmac_f32_16x16x64_bf16 v[44:47], v[8:11], v[52:59], v166
    s_add_u32 s26, s26, 16384
    s_and_b32 s26, s26, 65535
    v_cvt_pk_bf16_f32 v62, v88, v89
    v_exp_f32 v94, v94
    v_cvt_pk_bf16_f32 v63, v90, v91
    v_exp_f32 v95, v95
    v_exp_f32 v172, v96
    v_cvt_pk_bf16_f32 v64, v92, v93
    v_exp_f32 v173, v97
    v_exp_f32 v174, v98
    v_cvt_pk_bf16_f32 v65, v94, v95
    v_exp_f32 v175, v99
    v_mfma_f32_32x32x16_bf16 v[84:99], v[28:31], v[20:23], 0
    ds_read_b128 v[28:31], v6 offset:4096
    v_exp_f32 v68, v68
    v_exp_f32 v69, v69
    v_cvt_pk_bf16_f32 v66, v172, v173
    v_cvt_pk_bf16_f32 v67, v174, v175
    v_mfma_f32_32x32x16_bf16 v[84:99], v[32:35], v[24:27], v[84:99]
    s_add_u32 m0, s48, 2048
    ds_read_b128 v[32:35], v6 offset:4608
    v_exp_f32 v70, v70
    v_exp_f32 v71, v71
    v_exp_f32 v72, v72
    v_mfma_f32_32x32x16_bf16 v[116:131], v[36:39], v[60:63], v[116:131]
    ds_read_b64_tr_b16 v[36:37], v7 offset:10240
    ds_read_b64_tr_b16 v[38:39], v164 offset:10240
    v_exp_f32 v73, v73
    v_cvt_pk_bf16_f32 v52, v68, v69
    v_exp_f32 v74, v74
    v_cvt_pk_bf16_f32 v53, v70, v71
    v_mfma_f32_32x32x16_bf16 v[116:131], v[40:43], v[64:67], v[116:131]
    s_waitcnt lgkmcnt(2)
    ds_read_b64_tr_b16 v[40:41], v7 offset:11264
    buffer_load_dwordx4 v180, s[36:39], s47 offen lds
    v_exp_f32 v75, v75
    v_exp_f32 v76, v76
    v_exp_f32 v77, v77
    v_smfmac_f32_16x16x64_bf16 v[48:51], v[8:11], v[60:67], v166
    s_add_u32 s47, s47, 16384
    ds_read_b64_tr_b16 v[42:43], v164 offset:11264
    v_cvt_pk_bf16_f32 v54, v72, v73
    v_exp_f32 v78, v78
    v_cvt_pk_bf16_f32 v55, v74, v75
    v_exp_f32 v79, v79
    v_exp_f32 v168, v80
    v_cvt_pk_bf16_f32 v56, v76, v77
    v_exp_f32 v169, v81
    v_exp_f32 v170, v82
    v_cvt_pk_bf16_f32 v57, v78, v79
    v_exp_f32 v171, v83
    v_mfma_f32_32x32x16_bf16 v[68:83], v[28:31], v[12:15], 0
    s_add_u32 m0, s48, 3072
    v_exp_f32 v84, v84
    v_exp_f32 v85, v85
    v_cvt_pk_bf16_f32 v58, v168, v169
    v_cvt_pk_bf16_f32 v59, v170, v171
    v_mfma_f32_32x32x16_bf16 v[68:83], v[32:35], v[16:19], v[68:83]
    s_waitcnt lgkmcnt(0)
    buffer_load_dwordx4 v180, s[36:39], s47 offen lds
    v_exp_f32 v86, v86
    v_exp_f32 v87, v87
    v_exp_f32 v88, v88
    v_mfma_f32_32x32x16_bf16 v[100:115], v[36:39], v[52:55], v[100:115]
    s_add_u32 m0, s25, 8192
    v_exp_f32 v89, v89
    v_cvt_pk_bf16_f32 v60, v84, v85
    v_exp_f32 v90, v90
    v_cvt_pk_bf16_f32 v61, v86, v87
    v_mfma_f32_32x32x16_bf16 v[100:115], v[40:43], v[56:59], v[100:115]
    s_add_u32 s47, s47, 212992
    buffer_load_dwordx4 v3, s[12:15], s23 offen sc1 lds
    v_exp_f32 v91, v91
    v_exp_f32 v92, v92
    v_exp_f32 v93, v93
    v_smfmac_f32_16x16x64_bf16 v[44:47], v[8:11], v[52:59], v166
    v_cvt_pk_bf16_f32 v62, v88, v89
    v_exp_f32 v94, v94
    v_cvt_pk_bf16_f32 v63, v90, v91
    v_exp_f32 v95, v95
    v_exp_f32 v172, v96
    v_cvt_pk_bf16_f32 v64, v92, v93
    v_exp_f32 v173, v97
    v_exp_f32 v174, v98
    v_cvt_pk_bf16_f32 v65, v94, v95
    v_exp_f32 v175, v99
    v_mfma_f32_32x32x16_bf16 v[84:99], v[28:31], v[20:23], 0
    ds_read_b128 v[28:31], v6 offset:6144
    v_exp_f32 v68, v68
    v_exp_f32 v69, v69
    v_cvt_pk_bf16_f32 v66, v172, v173
    v_cvt_pk_bf16_f32 v67, v174, v175
    v_mfma_f32_32x32x16_bf16 v[84:99], v[32:35], v[24:27], v[84:99]
    s_add_u32 m0, s48, 4096
    ds_read_b128 v[32:35], v6 offset:6656
    v_exp_f32 v70, v70
    v_exp_f32 v71, v71
    v_exp_f32 v72, v72
    v_mfma_f32_32x32x16_bf16 v[116:131], v[36:39], v[60:63], v[116:131]
    ds_read_b64_tr_b16 v[36:37], v7 offset:12288
    ds_read_b64_tr_b16 v[38:39], v164 offset:12288
    v_exp_f32 v73, v73
    v_cvt_pk_bf16_f32 v52, v68, v69
    v_exp_f32 v74, v74
    v_cvt_pk_bf16_f32 v53, v70, v71
    v_mfma_f32_32x32x16_bf16 v[116:131], v[40:43], v[64:67], v[116:131]
    s_waitcnt lgkmcnt(2)
    ds_read_b64_tr_b16 v[40:41], v7 offset:13312
    buffer_load_dwordx4 v180, s[36:39], s47 offen lds
    v_exp_f32 v75, v75
    v_exp_f32 v76, v76
    v_exp_f32 v77, v77
    v_smfmac_f32_16x16x64_bf16 v[48:51], v[8:11], v[60:67], v166
    s_add_u32 s47, s47, 16384
    ds_read_b64_tr_b16 v[42:43], v164 offset:13312
    v_cvt_pk_bf16_f32 v54, v72, v73
    v_exp_f32 v78, v78
    v_cvt_pk_bf16_f32 v55, v74, v75
    v_exp_f32 v79, v79
    v_exp_f32 v168, v80
    v_cvt_pk_bf16_f32 v56, v76, v77
    v_exp_f32 v169, v81
    v_exp_f32 v170, v82
    v_cvt_pk_bf16_f32 v57, v78, v79
    v_exp_f32 v171, v83
    v_mfma_f32_32x32x16_bf16 v[68:83], v[28:31], v[12:15], 0
    s_add_u32 m0, s48, 5120
    v_exp_f32 v84, v84
    v_exp_f32 v85, v85
    v_cvt_pk_bf16_f32 v58, v168, v169
    v_cvt_pk_bf16_f32 v59, v170, v171
    v_mfma_f32_32x32x16_bf16 v[68:83], v[32:35], v[16:19], v[68:83]
    s_waitcnt lgkmcnt(0)
    buffer_load_dwordx4 v180, s[36:39], s47 offen lds
    v_exp_f32 v86, v86
    v_exp_f32 v87, v87
    v_exp_f32 v88, v88
    v_mfma_f32_32x32x16_bf16 v[100:115], v[36:39], v[52:55], v[100:115]
    s_add_u32 m0, s25, 8192
    v_exp_f32 v89, v89
    v_cvt_pk_bf16_f32 v60, v84, v85
    v_exp_f32 v90, v90
    v_cvt_pk_bf16_f32 v61, v86, v87
    v_mfma_f32_32x32x16_bf16 v[100:115], v[40:43], v[56:59], v[100:115]
    s_add_u32 s47, s47, 16384
    buffer_load_dwordx4 v3, s[12:15], s23 offen offset:1024 sc1 lds
    v_exp_f32 v91, v91
    v_exp_f32 v92, v92
    v_exp_f32 v93, v93
    v_smfmac_f32_16x16x64_bf16 v[44:47], v[8:11], v[52:59], v166
    s_add_u32 s23, s23, 8192
    buffer_load_dword v185, v159, s[40:43], 0 offen sc1
    v_cvt_pk_bf16_f32 v62, v88, v89
    v_exp_f32 v94, v94
    v_cvt_pk_bf16_f32 v63, v90, v91
    v_exp_f32 v95, v95
    v_exp_f32 v172, v96
    v_cvt_pk_bf16_f32 v64, v92, v93
    v_exp_f32 v173, v97
    v_exp_f32 v174, v98
    v_cvt_pk_bf16_f32 v65, v94, v95
    v_exp_f32 v175, v99
    v_add_u32 v6, s26, v4
    v_mfma_f32_32x32x16_bf16 v[84:99], v[28:31], v[20:23], 0
    s_waitcnt vmcnt(11)
    s_barrier
    ds_read_b128 v[28:31], v6 offset:0
    v_exp_f32 v68, v68
    v_exp_f32 v69, v69
    v_cvt_pk_bf16_f32 v66, v172, v173
    v_cvt_pk_bf16_f32 v67, v174, v175
    v_mfma_f32_32x32x16_bf16 v[84:99], v[32:35], v[24:27], v[84:99]
    s_add_u32 m0, s48, 6144
    s_add_u32 s25, s25, 16384
    ds_read_b128 v[32:35], v6 offset:512
    v_exp_f32 v70, v70
    v_exp_f32 v71, v71
    v_exp_f32 v72, v72
    v_mfma_f32_32x32x16_bf16 v[116:131], v[36:39], v[60:63], v[116:131]
    s_and_b32 s25, s25, 65535
    ds_read_b64_tr_b16 v[36:37], v7 offset:14336
    ds_read_b64_tr_b16 v[38:39], v164 offset:14336
    v_exp_f32 v73, v73
    v_cvt_pk_bf16_f32 v52, v68, v69
    v_exp_f32 v74, v74
    v_cvt_pk_bf16_f32 v53, v70, v71
    v_mfma_f32_32x32x16_bf16 v[116:131], v[40:43], v[64:67], v[116:131]
    s_waitcnt lgkmcnt(2)
    ds_read_b64_tr_b16 v[40:41], v7 offset:15360
    buffer_load_dwordx4 v180, s[36:39], s47 offen lds
    v_exp_f32 v75, v75
    v_exp_f32 v76, v76
    v_exp_f32 v77, v77
    v_smfmac_f32_16x16x64_bf16 v[48:51], v[8:11], v[60:67], v166
    s_add_u32 s47, s47, 16384
    ds_read_b64_tr_b16 v[42:43], v164 offset:15360
    v_cvt_pk_bf16_f32 v54, v72, v73
    v_exp_f32 v78, v78
    v_cvt_pk_bf16_f32 v55, v74, v75
    v_exp_f32 v79, v79
    v_exp_f32 v168, v80
    v_cvt_pk_bf16_f32 v56, v76, v77
    v_exp_f32 v169, v81
    v_exp_f32 v170, v82
    v_cvt_pk_bf16_f32 v57, v78, v79
    v_exp_f32 v171, v83
    v_mfma_f32_32x32x16_bf16 v[68:83], v[28:31], v[12:15], 0
    s_add_u32 m0, s48, 7168
    v_exp_f32 v84, v84
    v_exp_f32 v85, v85
    v_cvt_pk_bf16_f32 v58, v168, v169
    v_cvt_pk_bf16_f32 v59, v170, v171
    v_mfma_f32_32x32x16_bf16 v[68:83], v[32:35], v[16:19], v[68:83]
    s_waitcnt lgkmcnt(0)
    buffer_load_dwordx4 v180, s[36:39], s47 offen lds
    v_exp_f32 v86, v86
    v_exp_f32 v87, v87
    v_exp_f32 v88, v88
    v_mfma_f32_32x32x16_bf16 v[100:115], v[36:39], v[52:55], v[100:115]
    s_mov_b32 m0, s25
    v_exp_f32 v89, v89
    v_cvt_pk_bf16_f32 v60, v84, v85
    v_exp_f32 v90, v90
    v_cvt_pk_bf16_f32 v61, v86, v87
    v_mfma_f32_32x32x16_bf16 v[100:115], v[40:43], v[56:59], v[100:115]
    s_add_u32 s47, s47, 212992
    buffer_load_dwordx4 v2, s[8:11], s23 offen sc1 lds
    v_exp_f32 v91, v91
    v_exp_f32 v92, v92
    v_exp_f32 v93, v93
    v_smfmac_f32_16x16x64_bf16 v[44:47], v[8:11], v[52:59], v166
    s_cmp_lg_u32 s77, 0
    s_cbranch_scc1 L_f2_go
    s_waitcnt vmcnt(3)
    v_cmp_ne_u32 vcc, s76, v185
    s_cmp_eq_u64 vcc, 0
    s_cbranch_scc1 L_f2_go
    s_mov_b32 s50, 0x40000
L_f2_poll:
    buffer_load_dword v185, v159, s[40:43], 0 offen sc1
    s_waitcnt vmcnt(0)
    v_cmp_ne_u32 vcc, s76, v185
    s_cmp_eq_u64 vcc, 0
    s_cbranch_scc1 L_f2_go
    s_sleep 4
    s_sub_u32 s50, s50, 1
    s_cmp_lg_u32 s50, 0
    s_cbranch_scc1 L_f2_poll
L_f2_go:
    s_barrier
    v_cvt_pk_bf16_f32 v62, v88, v89
    v_exp_f32 v94, v94
    v_cvt_pk_bf16_f32 v63, v90, v91
    v_exp_f32 v95, v95
    v_exp_f32 v172, v96
    v_cvt_pk_bf16_f32 v64, v92, v93
    v_exp_f32 v173, v97
    v_exp_f32 v174, v98
    v_cvt_pk_bf16_f32 v65, v94, v95
    v_exp_f32 v175, v99
    v_add_u32 v7, s26, v5
    v_add_u32 v164, s26, v165
    v_mfma_f32_32x32x16_bf16 v[84:99], v[28:31], v[20:23], 0
    ds_read_b128 v[28:31], v6 offset:2048
    v_exp_f32 v68, v68
    v_exp_f32 v69, v69
    v_cvt_pk_bf16_f32 v66, v172, v173
    v_cvt_pk_bf16_f32 v67, v174, v175
    v_mfma_f32_32x32x16_bf16 v[84:99], v[32:35], v[24:27], v[84:99]
    s_add_u32 m0, s48, 8192
    ds_read_b128 v[32:35], v6 offset:2560
    buffer_load_dwordx4 a[128:131], v176, s[32:35], s46 offen sc1
    v_exp_f32 v70, v70
    v_exp_f32 v71, v71
    v_exp_f32 v72, v72
    v_mfma_f32_32x32x16_bf16 v[116:131], v[36:39], v[60:63], v[116:131]
    ds_read_b64_tr_b16 v[36:37], v7 offset:8192
    ds_read_b64_tr_b16 v[38:39], v164 offset:8192
    v_exp_f32 v73, v73
    v_cvt_pk_bf16_f32 v52, v68, v69
    v_exp_f32 v74, v74
    v_cvt_pk_bf16_f32 v53, v70, v71
    v_mfma_f32_32x32x16_bf16 v[116:131], v[40:43], v[64:67], v[116:131]
    s_waitcnt lgkmcnt(2)
    ds_read_b64_tr_b16 v[40:41], v7 offset:9216
    buffer_load_dwordx4 v180, s[36:39], s47 offen lds
    v_exp_f32 v75, v75
    v_exp_f32 v76, v76
    v_exp_f32 v77, v77
    v_smfmac_f32_16x16x64_bf16 v[48:51], v[8:11], v[60:67], v166
    s_add_u32 s47, s47, 16384
    ds_read_b64_tr_b16 v[42:43], v164 offset:9216
    buffer_load_dwordx4 a[132:135], v176, s[32:35], s46 offen offset:512 sc1
    v_cvt_pk_bf16_f32 v54, v72, v73
    v_exp_f32 v78, v78
    v_cvt_pk_bf16_f32 v55, v74, v75
    v_exp_f32 v79, v79
    v_exp_f32 v168, v80
    v_cvt_pk_bf16_f32 v56, v76, v77
    v_exp_f32 v169, v81
    v_exp_f32 v170, v82
    v_cvt_pk_bf16_f32 v57, v78, v79
    v_exp_f32 v171, v83
    v_mfma_f32_32x32x16_bf16 v[68:83], v[28:31], v[12:15], 0
    s_add_u32 m0, s48, 9216
    v_exp_f32 v84, v84
    v_exp_f32 v85, v85
    v_cvt_pk_bf16_f32 v58, v168, v169
    v_cvt_pk_bf16_f32 v59, v170, v171
    v_mfma_f32_32x32x16_bf16 v[68:83], v[32:35], v[16:19], v[68:83]
    s_waitcnt lgkmcnt(0)
    buffer_load_dwordx4 v180, s[36:39], s47 offen lds
    v_exp_f32 v86, v86
    v_exp_f32 v87, v87
    v_exp_f32 v88, v88
    v_mfma_f32_32x32x16_bf16 v[100:115], v[36:39], v[52:55], v[100:115]
    s_mov_b32 m0, s25
    buffer_load_dwordx4 a[136:139], v177, s[32:35], s46 offen sc1
    v_exp_f32 v89, v89
    v_cvt_pk_bf16_f32 v60, v84, v85
    v_exp_f32 v90, v90
    v_cvt_pk_bf16_f32 v61, v86, v87
    v_mfma_f32_32x32x16_bf16 v[100:115], v[40:43], v[56:59], v[100:115]
    s_add_u32 s47, s47, 16384
    buffer_load_dwordx4 v2, s[8:11], s23 offen offset:1024 sc1 lds
    v_exp_f32 v91, v91
    v_exp_f32 v92, v92
    v_exp_f32 v93, v93
    v_smfmac_f32_16x16x64_bf16 v[44:47], v[8:11], v[52:59], v166
    s_add_u32 s26, s26, 16384
    s_and_b32 s26, s26, 65535
    buffer_load_dwordx4 a[140:143], v177, s[32:35], s46 offen offset:512 sc1
    v_cvt_pk_bf16_f32 v62, v88, v89
    v_exp_f32 v94, v94
    v_cvt_pk_bf16_f32 v63, v90, v91
    v_exp_f32 v95, v95
    v_exp_f32 v172, v96
    v_cvt_pk_bf16_f32 v64, v92, v93
    v_exp_f32 v173, v97
    v_exp_f32 v174, v98
    v_cvt_pk_bf16_f32 v65, v94, v95
    v_exp_f32 v175, v99
    v_mfma_f32_32x32x16_bf16 v[84:99], v[28:31], v[20:23], 0
    ds_read_b128 v[28:31], v6 offset:4096
    v_exp_f32 v68, v68
    v_exp_f32 v69, v69
    v_cvt_pk_bf16_f32 v66, v172, v173
    v_cvt_pk_bf16_f32 v67, v174, v175
    v_mfma_f32_32x32x16_bf16 v[84:99], v[32:35], v[24:27], v[84:99]
    s_add_u32 m0, s48, 10240
    ds_read_b128 v[32:35], v6 offset:4608
    buffer_load_dwordx4 a[144:147], v178, s[32:35], s46 offen sc1
    v_exp_f32 v70, v70
    v_exp_f32 v71, v71
    v_exp_f32 v72, v72
    v_mfma_f32_32x32x16_bf16 v[116:131], v[36:39], v[60:63], v[116:131]
    ds_read_b64_tr_b16 v[36:37], v7 offset:10240
    ds_read_b64_tr_b16 v[38:39], v164 offset:10240
    v_exp_f32 v73, v73
    v_cvt_pk_bf16_f32 v52, v68, v69
    v_exp_f32 v74, v74
    v_cvt_pk_bf16_f32 v53, v70, v71
    v_mfma_f32_32x32x16_bf16 v[116:131], v[40:43], v[64:67], v[116:131]
    s_waitcnt lgkmcnt(2)
    ds_read_b64_tr_b16 v[40:41], v7 offset:11264
    buffer_load_dwordx4 v180, s[36:39], s47 offen lds
    v_exp_f32 v75, v75
    v_exp_f32 v76, v76
    v_exp_f32 v77, v77
    v_smfmac_f32_16x16x64_bf16 v[48:51], v[8:11], v[60:67], v166
    s_add_u32 s47, s47, 16384
    ds_read_b64_tr_b16 v[42:43], v164 offset:11264
    buffer_load_dwordx4 a[148:151], v178, s[32:35], s46 offen offset:512 sc1
    v_cvt_pk_bf16_f32 v54, v72, v73
    v_exp_f32 v78, v78
    v_cvt_pk_bf16_f32 v55, v74, v75
    v_exp_f32 v79, v79
    v_exp_f32 v168, v80
    v_cvt_pk_bf16_f32 v56, v76, v77
    v_exp_f32 v169, v81
    v_exp_f32 v170, v82
    v_cvt_pk_bf16_f32 v57, v78, v79
    v_exp_f32 v171, v83
    v_mfma_f32_32x32x16_bf16 v[68:83], v[28:31], v[12:15], 0
    s_add_u32 m0, s48, 11264
    v_exp_f32 v84, v84
    v_exp_f32 v85, v85
    v_cvt_pk_bf16_f32 v58, v168, v169
    v_cvt_pk_bf16_f32 v59, v170, v171
    v_mfma_f32_32x32x16_bf16 v[68:83], v[32:35], v[16:19], v[68:83]
    s_waitcnt lgkmcnt(0)
    buffer_load_dwordx4 v180, s[36:39], s47 offen lds
    v_exp_f32 v86, v86
    v_exp_f32 v87, v87
    v_exp_f32 v88, v88
    v_mfma_f32_32x32x16_bf16 v[100:115], v[36:39], v[52:55], v[100:115]
    s_add_u32 m0, s25, 8192
    buffer_load_dwordx4 a[152:155], v179, s[32:35], s46 offen sc1
    v_exp_f32 v89, v89
    v_cvt_pk_bf16_f32 v60, v84, v85
    v_exp_f32 v90, v90
    v_cvt_pk_bf16_f32 v61, v86, v87
    v_mfma_f32_32x32x16_bf16 v[100:115], v[40:43], v[56:59], v[100:115]
    s_add_u32 s47, s47, 212992
    buffer_load_dwordx4 v3, s[12:15], s23 offen sc1 lds
    v_exp_f32 v91, v91
    v_exp_f32 v92, v92
    v_exp_f32 v93, v93
    v_smfmac_f32_16x16x64_bf16 v[44:47], v[8:11], v[52:59], v166
    buffer_load_dwordx4 a[156:159], v179, s[32:35], s46 offen offset:512 sc1
    v_cvt_pk_bf16_f32 v62, v88, v89
    v_exp_f32 v94, v94
    v_cvt_pk_bf16_f32 v63, v90, v91
    v_exp_f32 v95, v95
    v_exp_f32 v172, v96
    v_cvt_pk_bf16_f32 v64, v92, v93
    v_exp_f32 v173, v97
    v_exp_f32 v174, v98
    v_cvt_pk_bf16_f32 v65, v94, v95
    v_exp_f32 v175, v99
    v_mfma_f32_32x32x16_bf16 v[84:99], v[28:31], v[20:23], 0
    s_add_u32 s46, s46, 0x80000
    ds_read_b128 v[28:31], v6 offset:6144
    v_exp_f32 v68, v68
    v_exp_f32 v69, v69
    v_cvt_pk_bf16_f32 v66, v172, v173
    v_cvt_pk_bf16_f32 v67, v174, v175
    v_mfma_f32_32x32x16_bf16 v[84:99], v[32:35], v[24:27], v[84:99]
    s_add_u32 m0, s48, 12288
    ds_read_b128 v[32:35], v6 offset:6656
    buffer_load_dwordx4 a[160:163], v176, s[32:35], s46 offen sc1
    v_exp_f32 v70, v70
    v_exp_f32 v71, v71
    v_exp_f32 v72, v72
    v_mfma_f32_32x32x16_bf16 v[116:131], v[36:39], v[60:63], v[116:131]
    ds_read_b64_tr_b16 v[36:37], v7 offset:12288
    ds_read_b64_tr_b16 v[38:39], v164 offset:12288
    v_exp_f32 v73, v73
    v_cvt_pk_bf16_f32 v52, v68, v69
    v_exp_f32 v74, v74
    v_cvt_pk_bf16_f32 v53, v70, v71
    v_mfma_f32_32x32x16_bf16 v[116:131], v[40:43], v[64:67], v[116:131]
    s_waitcnt lgkmcnt(2)
    ds_read_b64_tr_b16 v[40:41], v7 offset:13312
    buffer_load_dwordx4 v180, s[36:39], s47 offen lds
    v_exp_f32 v75, v75
    v_exp_f32 v76, v76
    v_exp_f32 v77, v77
    v_smfmac_f32_16x16x64_bf16 v[48:51], v[8:11], v[60:67], v166
    s_add_u32 s47, s47, 16384
    ds_read_b64_tr_b16 v[42:43], v164 offset:13312
    buffer_load_dwordx4 a[164:167], v176, s[32:35], s46 offen offset:512 sc1
    v_cvt_pk_bf16_f32 v54, v72, v73
    v_exp_f32 v78, v78
    v_cvt_pk_bf16_f32 v55, v74, v75
    v_exp_f32 v79, v79
    v_exp_f32 v168, v80
    v_cvt_pk_bf16_f32 v56, v76, v77
    v_exp_f32 v169, v81
    v_exp_f32 v170, v82
    v_cvt_pk_bf16_f32 v57, v78, v79
    v_exp_f32 v171, v83
    v_mfma_f32_32x32x16_bf16 v[68:83], v[28:31], v[12:15], 0
    s_add_u32 m0, s48, 13312
    v_exp_f32 v84, v84
    v_exp_f32 v85, v85
    v_cvt_pk_bf16_f32 v58, v168, v169
    v_cvt_pk_bf16_f32 v59, v170, v171
    v_mfma_f32_32x32x16_bf16 v[68:83], v[32:35], v[16:19], v[68:83]
    s_waitcnt vmcnt(25) lgkmcnt(0)
    buffer_load_dwordx4 v180, s[36:39], s47 offen lds
    v_exp_f32 v86, v86
    v_exp_f32 v87, v87
    v_exp_f32 v88, v88
    v_mfma_f32_32x32x16_bf16 v[100:115], v[36:39], v[52:55], v[100:115]
    s_add_u32 m0, s25, 8192
    ds_read_b64_tr_b16 a[192:193], v181 offset:0
    ds_read_b64_tr_b16 a[194:195], v181 offset:2048
    buffer_load_dwordx4 a[168:171], v177, s[32:35], s46 offen sc1
    v_exp_f32 v89, v89
    v_cvt_pk_bf16_f32 v60, v84, v85
    v_exp_f32 v90, v90
    v_cvt_pk_bf16_f32 v61, v86, v87
    v_mfma_f32_32x32x16_bf16 v[100:115], v[40:43], v[56:59], v[100:115]
    s_add_u32 s47, s47, 16384
    ds_read_b64_tr_b16 a[200:201], v182 offset:0
    buffer_load_dwordx4 v3, s[12:15], s23 offen offset:1024 sc1 lds
    v_exp_f32 v91, v91
    v_exp_f32 v92, v92
    v_exp_f32 v93, v93
    v_smfmac_f32_16x16x64_bf16 v[44:47], v[8:11], v[52:59], v166
    s_add_u32 s23, s23, 8192
    ds_read_b64_tr_b16 a[202:203], v182 offset:2048
    buffer_load_dwordx4 a[172:175], v177, s[32:35], s46 offen offset:512 sc1
    v_cvt_pk_bf16_f32 v62, v88, v89
    v_exp_f32 v94, v94
    v_cvt_pk_bf16_f32 v63, v90, v91
    v_exp_f32 v95, v95
    v_exp_f32 v172, v96
    v_cvt_pk_bf16_f32 v64, v92, v93
    v_exp_f32 v173, v97
    v_exp_f32 v174, v98
    v_cvt_pk_bf16_f32 v65, v94, v95
    v_exp_f32 v175, v99
    v_add_u32 v6, s26, v4
    v_mfma_f32_32x32x16_bf16 v[84:99], v[28:31], v[20:23], 0
    s_waitcnt vmcnt(25)
    s_barrier
    ds_read_b128 v[28:31], v6 offset:0
    v_exp_f32 v68, v68
    v_exp_f32 v69, v69
    v_cvt_pk_bf16_f32 v66, v172, v173
    v_cvt_pk_bf16_f32 v67, v174, v175
    v_mfma_f32_32x32x16_bf16 v[84:99], v[32:35], v[24:27], v[84:99]
    s_add_u32 m0, s48, 14336
    s_add_u32 s25, s25, 16384
    ds_read_b128 v[32:35], v6 offset:512
    buffer_load_dwordx4 a[176:179], v178, s[32:35], s46 offen sc1
    v_exp_f32 v70, v70
    v_exp_f32 v71, v71
    v_exp_f32 v72, v72
    v_mfma_f32_32x32x16_bf16 v[116:131], v[36:39], v[60:63], v[116:131]
    s_and_b32 s25, s25, 65535
    ds_read_b64_tr_b16 v[36:37], v7 offset:14336
    ds_read_b64_tr_b16 v[38:39], v164 offset:14336
    v_exp_f32 v73, v73
    v_cvt_pk_bf16_f32 v52, v68, v69
    v_exp_f32 v74, v74
    v_cvt_pk_bf16_f32 v53, v70, v71
    v_mfma_f32_32x32x16_bf16 v[116:131], v[40:43], v[64:67], v[116:131]
    s_waitcnt lgkmcnt(2)
    ds_read_b64_tr_b16 v[40:41], v7 offset:15360
    buffer_load_dwordx4 v180, s[36:39], s47 offen lds
    v_exp_f32 v75, v75
    v_exp_f32 v76, v76
    v_exp_f32 v77, v77
    v_smfmac_f32_16x16x64_bf16 v[48:51], v[8:11], v[60:67], v166
    s_add_u32 s47, s47, 16384
    ds_read_b64_tr_b16 v[42:43], v164 offset:15360
    buffer_load_dwordx4 a[180:183], v178, s[32:35], s46 offen offset:512 sc1
    v_cvt_pk_bf16_f32 v54, v72, v73
    v_exp_f32 v78, v78
    v_cvt_pk_bf16_f32 v55, v74, v75
    v_exp_f32 v79, v79
    v_exp_f32 v168, v80
    v_cvt_pk_bf16_f32 v56, v76, v77
    v_exp_f32 v169, v81
    v_exp_f32 v170, v82
    v_cvt_pk_bf16_f32 v57, v78, v79
    v_exp_f32 v171, v83
    v_mfma_f32_32x32x16_bf16 v[68:83], v[28:31], v[12:15], 0
    s_add_u32 m0, s48, 15360
    v_exp_f32 v84, v84
    v_exp_f32 v85, v85
    v_cvt_pk_bf16_f32 v58, v168, v169
    v_cvt_pk_bf16_f32 v59, v170, v171
    v_mfma_f32_32x32x16_bf16 v[68:83], v[32:35], v[16:19], v[68:83]
    s_waitcnt lgkmcnt(0)
    buffer_load_dwordx4 v180, s[36:39], s47 offen lds
    v_exp_f32 v86, v86
    v_exp_f32 v87, v87
    v_exp_f32 v88, v88
    v_mfma_f32_32x32x16_bf16 v[100:115], v[36:39], v[52:55], v[100:115]
    s_mov_b32 m0, s25
    ds_read_b64_tr_b16 a[196:197], v181 offset:1024
    ds_read_b64_tr_b16 a[198:199], v181 offset:3072
    buffer_load_dwordx4 a[184:187], v179, s[32:35], s46 offen sc1
    v_exp_f32 v89, v89
    v_cvt_pk_bf16_f32 v60, v84, v85
    v_exp_f32 v90, v90
    v_cvt_pk_bf16_f32 v61, v86, v87
    v_mfma_f32_32x32x16_bf16 v[100:115], v[40:43], v[56:59], v[100:115]
    s_add_u32 s47, s47, 212992
    ds_read_b64_tr_b16 a[204:205], v182 offset:1024
    buffer_load_dwordx4 v2, s[8:11], s23 offen sc1 lds
    v_exp_f32 v91, v91
    v_exp_f32 v92, v92
    v_exp_f32 v93, v93
    v_smfmac_f32_16x16x64_bf16 v[44:47], v[8:11], v[52:59], v166
    ds_read_b64_tr_b16 a[206:207], v182 offset:3072
    buffer_load_dwordx4 a[188:191], v179, s[32:35], s46 offen offset:512 sc1
    v_cvt_pk_bf16_f32 v62, v88, v89
    v_exp_f32 v94, v94
    v_cvt_pk_bf16_f32 v63, v90, v91
    v_exp_f32 v95, v95
    v_exp_f32 v172, v96
    v_cvt_pk_bf16_f32 v64, v92, v93
    v_exp_f32 v173, v97
    v_exp_f32 v174, v98
    v_cvt_pk_bf16_f32 v65, v94, v95
    v_exp_f32 v175, v99
    v_add_u32 v7, s26, v5
    v_add_u32 v164, s26, v165
    s_waitcnt vmcnt(28)
    s_mov_b32 s28, 5
.p2align 6
L_p2_loop:
    v_mfma_f32_32x32x16_bf16 v[84:99], v[28:31], v[20:23], 0
    s_add_u32 s46, s46, 0x80000
    ds_read_b128 v[28:31], v6 offset:2048
    v_exp_f32 v68, v68
    v_exp_f32 v69, v69
    v_cvt_pk_bf16_f32 v66, v172, v173
    v_mfma_f32_32x32x16_bf16 v[84:99], v[32:35], v[24:27], v[84:99]
    s_waitcnt vmcnt(25) lgkmcnt(1)
    ds_read_b128 v[32:35], v6 offset:2560
    v_cvt_pk_bf16_f32 v67, v174, v175
    v_exp_f32 v70, v70
    v_exp_f32 v71, v71
    v_mfma_f32_32x32x16_bf16 a[0:15], a[192:195], a[128:131], a[0:15]
    s_add_u32 m0, s48, 0
    buffer_load_dword v157, v162, s[88:91], s99 offen
    v_exp_f32 v72, v72
    v_cvt_pk_bf16_f32 v52, v68, v69
    v_mfma_f32_32x32x16_bf16 v[116:131], v[36:39], v[60:63], v[116:131]
    ds_read_b64_tr_b16 v[36:37], v7 offset:8192
    ds_read_b64_tr_b16 v[38:39], v164 offset:8192
    v_exp_f32 v73, v73
    v_exp_f32 v74, v74
    v_mfma_f32_32x32x16_bf16 a[16:31], a[200:203], a[128:131], a[16:31]
    buffer_load_dwordx4 a[128:131], v176, s[32:35], s46 offen sc1
    v_cvt_pk_bf16_f32 v53, v70, v71
    v_exp_f32 v75, v75
    v_exp_f32 v76, v76
    v_mfma_f32_32x32x16_bf16 v[116:131], v[40:43], v[64:67], v[116:131]
    s_waitcnt lgkmcnt(2)
    ds_read_b64_tr_b16 v[40:41], v7 offset:9216
    v_cvt_pk_bf16_f32 v54, v72, v73
    v_exp_f32 v77, v77
    v_exp_f32 v78, v78
    v_cvt_pk_bf16_f32 v55, v74, v75
    v_mfma_f32_32x32x16_bf16 a[0:15], a[196:199], a[132:135], a[0:15]
    buffer_load_dwordx4 v180, s[36:39], s47 offen lds
    v_exp_f32 v79, v79
    v_exp_f32 v168, v80
    v_cvt_pk_bf16_f32 v56, v76, v77
    v_smfmac_f32_16x16x64_bf16 v[48:51], v[8:11], v[60:67], v166
    s_add_u32 s47, s47, 16384
    ds_read_b64_tr_b16 v[42:43], v164 offset:9216
    v_exp_f32 v169, v81
    v_mfma_f32_32x32x16_bf16 a[16:31], a[204:207], a[132:135], a[16:31]
    buffer_load_dwordx4 a[132:135], v176, s[32:35], s46 offen offset:512 sc1
    v_exp_f32 v170, v82
    v_cvt_pk_bf16_f32 v57, v78, v79
    v_exp_f32 v171, v83
    v_mfma_f32_32x32x16_bf16 v[68:83], v[28:31], v[12:15], 0
    s_add_u32 m0, s48, 1024
    v_exp_f32 v84, v84
    v_exp_f32 v85, v85
    v_cvt_pk_bf16_f32 v58, v168, v169
    v_cvt_pk_bf16_f32 v59, v170, v171
    v_mfma_f32_32x32x16_bf16 v[68:83], v[32:35], v[16:19], v[68:83]
    s_waitcnt vmcnt(25) lgkmcnt(0)
    buffer_load_dwordx4 v180, s[36:39], s47 offen lds
    v_exp_f32 v86, v86
    v_exp_f32 v87, v87
    v_mfma_f32_32x32x16_bf16 a[32:47], a[192:195], a[136:139], a[32:47]
    s_mov_b32 m0, s25
    ds_read_b64_tr_b16 a[208:209], v181 offset:4096
    v_exp_f32 v88, v88
    v_cvt_pk_bf16_f32 v60, v84, v85
    v_exp_f32 v89, v89
    v_mfma_f32_32x32x16_bf16 v[100:115], v[36:39], v[52:55], v[100:115]
    s_add_u32 s47, s47, 16384
    ds_read_b64_tr_b16 a[210:211], v181 offset:6144
    v_exp_f32 v90, v90
    v_cvt_pk_bf16_f32 v61, v86, v87
    v_exp_f32 v91, v91
    v_mfma_f32_32x32x16_bf16 a[48:63], a[200:203], a[136:139], a[48:63]
    buffer_load_dwordx4 a[136:139], v177, s[32:35], s46 offen sc1
    v_exp_f32 v92, v92
    v_cvt_pk_bf16_f32 v62, v88, v89
    v_mfma_f32_32x32x16_bf16 v[100:115], v[40:43], v[56:59], v[100:115]
    s_add_u32 s26, s26, 16384
    ds_read_b64_tr_b16 a[216:217], v182 offset:4096
    v_exp_f32 v93, v93
    v_exp_f32 v94, v94
    v_cvt_pk_bf16_f32 v63, v90, v91
    v_mfma_f32_32x32x16_bf16 a[32:47], a[196:199], a[140:143], a[32:47]
    buffer_load_dwordx4 v2, s[8:11], s23 offen offset:1024 sc1 lds
    v_exp_f32 v95, v95
    v_exp_f32 v172, v96
    v_cvt_pk_bf16_f32 v64, v92, v93
    v_smfmac_f32_16x16x64_bf16 v[44:47], v[8:11], v[52:59], v166
    s_and_b32 s26, s26, 65535
    ds_read_b64_tr_b16 a[218:219], v182 offset:6144
    v_exp_f32 v173, v97
    v_mfma_f32_32x32x16_bf16 a[48:63], a[204:207], a[140:143], a[48:63]
    buffer_load_dwordx4 a[140:143], v177, s[32:35], s46 offen offset:512 sc1
    v_exp_f32 v174, v98
    v_cvt_pk_bf16_f32 v65, v94, v95
    v_exp_f32 v175, v99
    v_mfma_f32_32x32x16_bf16 v[84:99], v[28:31], v[20:23], 0
    ds_read_b128 v[28:31], v6 offset:4096
    v_exp_f32 v68, v68
    v_exp_f32 v69, v69
    v_cvt_pk_bf16_f32 v66, v172, v173
    v_mfma_f32_32x32x16_bf16 v[84:99], v[32:35], v[24:27], v[84:99]
    s_waitcnt vmcnt(26)
    ds_read_b128 v[32:35], v6 offset:4608
    v_cvt_pk_bf16_f32 v67, v174, v175
    v_exp_f32 v70, v70
    v_exp_f32 v71, v71
    v_mfma_f32_32x32x16_bf16 a[64:79], a[192:195], a[144:147], a[64:79]
    s_add_u32 m0, s48, 2048
    s_add_u32 s99, s99, 0x10000
    v_exp_f32 v72, v72
    v_cvt_pk_bf16_f32 v52, v68, v69
    v_exp_f32 v73, v73
    v_mfma_f32_32x32x16_bf16 v[116:131], v[36:39], v[60:63], v[116:131]
    ds_read_b64_tr_b16 v[36:37], v7 offset:10240
    ds_read_b64_tr_b16 v[38:39], v164 offset:10240
    v_exp_f32 v74, v74
    v_cvt_pk_bf16_f32 v53, v70, v71
    v_mfma_f32_32x32x16_bf16 a[80:95], a[200:203], a[144:147], a[80:95]
    buffer_load_dwordx4 a[144:147], v178, s[32:35], s46 offen sc1
    v_exp_f32 v75, v75
    v_exp_f32 v76, v76
    v_mfma_f32_32x32x16_bf16 v[116:131], v[40:43], v[64:67], v[116:131]
    s_waitcnt lgkmcnt(2)
    ds_read_b64_tr_b16 v[40:41], v7 offset:11264
    v_cvt_pk_bf16_f32 v54, v72, v73
    v_exp_f32 v77, v77
    v_exp_f32 v78, v78
    v_cvt_pk_bf16_f32 v55, v74, v75
    v_mfma_f32_32x32x16_bf16 a[64:79], a[196:199], a[148:151], a[64:79]
    buffer_load_dwordx4 v180, s[36:39], s47 offen lds
    v_exp_f32 v79, v79
    v_exp_f32 v168, v80
    v_cvt_pk_bf16_f32 v56, v76, v77
    v_smfmac_f32_16x16x64_bf16 v[48:51], v[8:11], v[60:67], v166
    s_add_u32 s47, s47, 16384
    ds_read_b64_tr_b16 v[42:43], v164 offset:11264
    v_exp_f32 v169, v81
    v_mfma_f32_32x32x16_bf16 a[80:95], a[204:207], a[148:151], a[80:95]
    buffer_load_dwordx4 a[148:151], v178, s[32:35], s46 offen offset:512 sc1
    v_exp_f32 v170, v82
    v_cvt_pk_bf16_f32 v57, v78, v79
    v_exp_f32 v171, v83
    v_mfma_f32_32x32x16_bf16 v[68:83], v[28:31], v[12:15], 0
    s_add_u32 m0, s48, 3072
    v_exp_f32 v84, v84
    v_exp_f32 v85, v85
    v_cvt_pk_bf16_f32 v58, v168, v169
    v_cvt_pk_bf16_f32 v59, v170, v171
    v_mfma_f32_32x32x16_bf16 v[68:83], v[32:35], v[16:19], v[68:83]
    s_waitcnt vmcnt(25) lgkmcnt(0)
    buffer_load_dwordx4 v180, s[36:39], s47 offen lds
    v_exp_f32 v86, v86
    v_exp_f32 v87, v87
    v_mfma_f32_32x32x16_bf16 a[96:111], a[192:195], a[152:155], a[96:111]
    s_add_u32 m0, s25, 8192
    ds_read_b64_tr_b16 a[212:213], v181 offset:5120
    v_exp_f32 v88, v88
    v_cvt_pk_bf16_f32 v60, v84, v85
    v_exp_f32 v89, v89
    v_mfma_f32_32x32x16_bf16 v[100:115], v[36:39], v[52:55], v[100:115]
    s_add_u32 s47, s47, 212992
    ds_read_b64_tr_b16 a[214:215], v181 offset:7168
    v_exp_f32 v90, v90
    v_cvt_pk_bf16_f32 v61, v86, v87
    v_exp_f32 v91, v91
    v_mfma_f32_32x32x16_bf16 a[112:127], a[200:203], a[152:155], a[112:127]
    buffer_load_dwordx4 a[152:155], v179, s[32:35], s46 offen sc1
    v_exp_f32 v92, v92
    v_cvt_pk_bf16_f32 v62, v88, v89
    v_mfma_f32_32x32x16_bf16 v[100:115], v[40:43], v[56:59], v[100:115]
    ds_read_b64_tr_b16 a[220:221], v182 offset:5120
    v_exp_f32 v93, v93
    v_exp_f32 v94, v94
    v_cvt_pk_bf16_f32 v63, v90, v91
    v_mfma_f32_32x32x16_bf16 a[96:111], a[196:199], a[156:159], a[96:111]
    buffer_load_dwordx4 v3, s[12:15], s23 offen sc1 lds
    v_exp_f32 v95, v95
    v_exp_f32 v172, v96
    v_cvt_pk_bf16_f32 v64, v92, v93
    v_smfmac_f32_16x16x64_bf16 v[44:47], v[8:11], v[52:59], v166
    ds_read_b64_tr_b16 a[222:223], v182 offset:7168
    v_exp_f32 v173, v97
    v_mfma_f32_32x32x16_bf16 a[112:127], a[204:207], a[156:159], a[112:127]
    buffer_load_dwordx4 a[156:159], v179, s[32:35], s46 offen offset:512 sc1
    v_exp_f32 v174, v98
    v_cvt_pk_bf16_f32 v65, v94, v95
    v_exp_f32 v175, v99
    v_mfma_f32_32x32x16_bf16 v[84:99], v[28:31], v[20:23], 0
    s_add_u32 s46, s46, 0x80000
    ds_read_b128 v[28:31], v6 offset:6144
    v_exp_f32 v68, v68
    v_exp_f32 v69, v69
    v_cvt_pk_bf16_f32 v66, v172, v173
    v_mfma_f32_32x32x16_bf16 v[84:99], v[32:35], v[24:27], v[84:99]
    s_waitcnt vmcnt(26) lgkmcnt(1)
    ds_read_b128 v[32:35], v6 offset:6656
    v_cvt_pk_bf16_f32 v67, v174, v175
    v_exp_f32 v70, v70
    v_exp_f32 v71, v71
    v_mfma_f32_32x32x16_bf16 a[0:15], a[208:211], a[160:163], a[0:15]
    s_add_u32 m0, s48, 4096
    v_exp_f32 v72, v72
    v_cvt_pk_bf16_f32 v52, v68, v69
    v_exp_f32 v73, v73
    v_mfma_f32_32x32x16_bf16 v[116:131], v[36:39], v[60:63], v[116:131]
    ds_read_b64_tr_b16 v[36:37], v7 offset:12288
    ds_read_b64_tr_b16 v[38:39], v164 offset:12288
    v_exp_f32 v74, v74
    v_cvt_pk_bf16_f32 v53, v70, v71
    v_mfma_f32_32x32x16_bf16 a[16:31], a[216:219], a[160:163], a[16:31]
    buffer_load_dwordx4 a[160:163], v176, s[32:35], s46 offen sc1
    v_exp_f32 v75, v75
    v_exp_f32 v76, v76
    v_mfma_f32_32x32x16_bf16 v[116:131], v[40:43], v[64:67], v[116:131]
    s_waitcnt lgkmcnt(2)
    ds_read_b64_tr_b16 v[40:41], v7 offset:13312
    v_cvt_pk_bf16_f32 v54, v72, v73
    v_exp_f32 v77, v77
    v_exp_f32 v78, v78
    v_cvt_pk_bf16_f32 v55, v74, v75
    v_mfma_f32_32x32x16_bf16 a[0:15], a[212:215], a[164:167], a[0:15]
    buffer_load_dwordx4 v180, s[36:39], s47 offen lds
    v_exp_f32 v79, v79
    v_exp_f32 v168, v80
    v_cvt_pk_bf16_f32 v56, v76, v77
    v_smfmac_f32_16x16x64_bf16 v[48:51], v[8:11], v[60:67], v166
    s_add_u32 s47, s47, 16384
    ds_read_b64_tr_b16 v[42:43], v164 offset:13312
    v_exp_f32 v169, v81
    v_mfma_f32_32x32x16_bf16 a[16:31], a[220:223], a[164:167], a[16:31]
    buffer_load_dwordx4 a[164:167], v176, s[32:35], s46 offen offset:512 sc1
    v_exp_f32 v170, v82
    v_cvt_pk_bf16_f32 v57, v78, v79
    v_exp_f32 v171, v83
    v_mfma_f32_32x32x16_bf16 v[68:83], v[28:31], v[12:15], 0
    s_add_u32 m0, s48, 5120
    v_exp_f32 v84, v84
    v_exp_f32 v85, v85
    v_cvt_pk_bf16_f32 v58, v168, v169
    v_cvt_pk_bf16_f32 v59, v170, v171
    v_mfma_f32_32x32x16_bf16 v[68:83], v[32:35], v[16:19], v[68:83]
    s_waitcnt vmcnt(25) lgkmcnt(0)
    buffer_load_dwordx4 v180, s[36:39], s47 offen lds
    v_exp_f32 v86, v86
    v_exp_f32 v87, v87
    v_mfma_f32_32x32x16_bf16 a[32:47], a[208:211], a[168:171], a[32:47]
    s_add_u32 m0, s25, 8192
    ds_read_b64_tr_b16 a[192:193], v181 offset:8192
    v_exp_f32 v88, v88
    v_cvt_pk_bf16_f32 v60, v84, v85
    v_exp_f32 v89, v89
    v_mfma_f32_32x32x16_bf16 v[100:115], v[36:39], v[52:55], v[100:115]
    s_add_u32 s47, s47, 16384
    ds_read_b64_tr_b16 a[194:195], v181 offset:10240
    v_exp_f32 v90, v90
    v_cvt_pk_bf16_f32 v61, v86, v87
    v_exp_f32 v91, v91
    v_mfma_f32_32x32x16_bf16 a[48:63], a[216:219], a[168:171], a[48:63]
    buffer_load_dwordx4 a[168:171], v177, s[32:35], s46 offen sc1
    v_exp_f32 v92, v92
    v_cvt_pk_bf16_f32 v62, v88, v89
    v_exp_f32 v93, v93
    v_mfma_f32_32x32x16_bf16 v[100:115], v[40:43], v[56:59], v[100:115]
    ds_read_b64_tr_b16 a[200:201], v182 offset:8192
    v_exp_f32 v94, v94
    v_cvt_pk_bf16_f32 v63, v90, v91
    v_exp_f32 v95, v95
    v_mfma_f32_32x32x16_bf16 a[32:47], a[212:215], a[172:175], a[32:47]
    buffer_load_dwordx4 v3, s[12:15], s23 offen offset:1024 sc1 lds
    v_exp_f32 v172, v96
    v_cvt_pk_bf16_f32 v64, v92, v93
    v_exp_f32 v173, v97
    v_smfmac_f32_16x16x64_bf16 v[44:47], v[8:11], v[52:59], v166
    s_add_u32 s23, s23, 8192
    ds_read_b64_tr_b16 a[202:203], v182 offset:10240
    v_exp_f32 v174, v98
    v_mfma_f32_32x32x16_bf16 a[48:63], a[220:223], a[172:175], a[48:63]
    buffer_load_dwordx4 a[172:175], v177, s[32:35], s46 offen offset:512 sc1
    v_cvt_pk_bf16_f32 v65, v94, v95
    v_exp_f32 v175, v99
    v_add_u32 v6, s26, v4
    v_mfma_f32_32x32x16_bf16 v[84:99], v[28:31], v[20:23], 0
    s_barrier
    ds_read_b128 v[28:31], v6 offset:0
    v_exp_f32 v68, v68
    v_exp_f32 v69, v69
    v_mfma_f32_32x32x16_bf16 v[84:99], v[32:35], v[24:27], v[84:99]
    s_waitcnt vmcnt(26)
    ds_read_b128 v[32:35], v6 offset:512
    v_cvt_pk_bf16_f32 v66, v172, v173
    v_cvt_pk_bf16_f32 v67, v174, v175
    v_exp_f32 v70, v70
    v_mfma_f32_32x32x16_bf16 a[64:79], a[208:211], a[176:179], a[64:79]
    s_add_u32 m0, s48, 6144
    v_exp_f32 v71, v71
    v_exp_f32 v72, v72
    v_cvt_pk_bf16_f32 v52, v68, v69
    v_mfma_f32_32x32x16_bf16 v[116:131], v[36:39], v[60:63], v[116:131]
    s_add_u32 s25, s25, 16384
    ds_read_b64_tr_b16 v[36:37], v7 offset:14336
    ds_read_b64_tr_b16 v[38:39], v164 offset:14336
    v_exp_f32 v73, v73
    v_exp_f32 v74, v74
    v_mfma_f32_32x32x16_bf16 a[80:95], a[216:219], a[176:179], a[80:95]
    s_and_b32 s25, s25, 65535
    buffer_load_dwordx4 a[176:179], v178, s[32:35], s46 offen sc1
    v_cvt_pk_bf16_f32 v53, v70, v71
    v_exp_f32 v75, v75
    v_exp_f32 v76, v76
    v_mfma_f32_32x32x16_bf16 v[116:131], v[40:43], v[64:67], v[116:131]
    s_waitcnt lgkmcnt(2)
    ds_read_b64_tr_b16 v[40:41], v7 offset:15360
    v_cvt_pk_bf16_f32 v54, v72, v73
    v_exp_f32 v77, v77
    v_exp_f32 v78, v78
    v_cvt_pk_bf16_f32 v55, v74, v75
    v_mfma_f32_32x32x16_bf16 a[64:79], a[212:215], a[180:183], a[64:79]
    buffer_load_dwordx4 v180, s[36:39], s47 offen lds
    v_exp_f32 v79, v79
    v_exp_f32 v168, v80
    v_cvt_pk_bf16_f32 v56, v76, v77
    v_smfmac_f32_16x16x64_bf16 v[48:51], v[8:11], v[60:67], v166
    s_add_u32 s47, s47, 16384
    ds_read_b64_tr_b16 v[42:43], v164 offset:15360
    v_exp_f32 v169, v81
    v_mfma_f32_32x32x16_bf16 a[80:95], a[220:223], a[180:183], a[80:95]
    buffer_load_dwordx4 a[180:183], v178, s[32:35], s46 offen offset:512 sc1
    v_exp_f32 v170, v82
    v_cvt_pk_bf16_f32 v57, v78, v79
    v_exp_f32 v171, v83
    v_mfma_f32_32x32x16_bf16 v[68:83], v[28:31], v[12:15], 0
    s_add_u32 m0, s48, 7168
    v_exp_f32 v84, v84
    v_exp_f32 v85, v85
    v_cvt_pk_bf16_f32 v58, v168, v169
    v_cvt_pk_bf16_f32 v59, v170, v171
    v_mfma_f32_32x32x16_bf16 v[68:83], v[32:35], v[16:19], v[68:83]
    s_waitcnt vmcnt(25) lgkmcnt(0)
    buffer_load_dwordx4 v180, s[36:39], s47 offen lds
    v_exp_f32 v86, v86
    v_exp_f32 v87, v87
    v_mfma_f32_32x32x16_bf16 a[96:111], a[208:211], a[184:187], a[96:111]
    s_mov_b32 m0, s25
    ds_read_b64_tr_b16 a[196:197], v181 offset:9216
    v_exp_f32 v88, v88
    v_cvt_pk_bf16_f32 v60, v84, v85
    v_exp_f32 v89, v89
    v_mfma_f32_32x32x16_bf16 v[100:115], v[36:39], v[52:55], v[100:115]
    s_add_u32 s47, s47, 212992
    ds_read_b64_tr_b16 a[198:199], v181 offset:11264
    v_exp_f32 v90, v90
    v_cvt_pk_bf16_f32 v61, v86, v87
    v_exp_f32 v91, v91
    v_mfma_f32_32x32x16_bf16 a[112:127], a[216:219], a[184:187], a[112:127]
    buffer_load_dwordx4 a[184:187], v179, s[32:35], s46 offen sc1
    v_exp_f32 v92, v92
    v_cvt_pk_bf16_f32 v62, v88, v89
    v_exp_f32 v93, v93
    v_mfma_f32_32x32x16_bf16 v[100:115], v[40:43], v[56:59], v[100:115]
    ds_read_b64_tr_b16 a[204:205], v182 offset:9216
    v_exp_f32 v94, v94
    v_cvt_pk_bf16_f32 v63, v90, v91
    v_exp_f32 v95, v95
    v_mfma_f32_32x32x16_bf16 a[96:111], a[212:215], a[188:191], a[96:111]
    buffer_load_dwordx4 v2, s[8:11], s23 offen sc1 lds
    v_exp_f32 v172, v96
    v_cvt_pk_bf16_f32 v64, v92, v93
    v_exp_f32 v173, v97
    v_smfmac_f32_16x16x64_bf16 v[44:47], v[8:11], v[52:59], v166
    ds_read_b64_tr_b16 a[206:207], v182 offset:11264
    v_exp_f32 v174, v98
    v_mfma_f32_32x32x16_bf16 a[112:127], a[220:223], a[188:191], a[112:127]
    buffer_load_dwordx4 a[188:191], v179, s[32:35], s46 offen offset:512 sc1
    v_cvt_pk_bf16_f32 v65, v94, v95
    v_exp_f32 v175, v99
    v_add_u32 v7, s26, v5
    v_add_u32 v164, s26, v165
    v_mfma_f32_32x32x16_bf16 v[84:99], v[28:31], v[20:23], 0
    s_add_u32 s46, s46, 0x80000
    ds_read_b128 v[28:31], v6 offset:2048
    v_exp_f32 v68, v68
    v_exp_f32 v69, v69
    v_cvt_pk_bf16_f32 v66, v172, v173
    v_mfma_f32_32x32x16_bf16 v[84:99], v[32:35], v[24:27], v[84:99]
    s_waitcnt vmcnt(25) lgkmcnt(1)
    ds_read_b128 v[32:35], v6 offset:2560
    v_cvt_pk_bf16_f32 v67, v174, v175
    v_exp_f32 v70, v70
    v_exp_f32 v71, v71
    v_mfma_f32_32x32x16_bf16 a[0:15], a[192:195], a[128:131], a[0:15]
    s_add_u32 m0, s48, 8192
    v_exp_f32 v72, v72
    v_cvt_pk_bf16_f32 v52, v68, v69
    v_exp_f32 v73, v73
    v_mfma_f32_32x32x16_bf16 v[116:131], v[36:39], v[60:63], v[116:131]
    ds_read_b64_tr_b16 v[36:37], v7 offset:8192
    ds_read_b64_tr_b16 v[38:39], v164 offset:8192
    v_exp_f32 v74, v74
    v_cvt_pk_bf16_f32 v53, v70, v71
    v_mfma_f32_32x32x16_bf16 a[16:31], a[200:203], a[128:131], a[16:31]
    buffer_load_dwordx4 a[128:131], v176, s[32:35], s46 offen sc1
    v_exp_f32 v75, v75
    v_exp_f32 v76, v76
    v_mfma_f32_32x32x16_bf16 v[116:131], v[40:43], v[64:67], v[116:131]
    s_waitcnt lgkmcnt(2)
    ds_read_b64_tr_b16 v[40:41], v7 offset:9216
    v_cvt_pk_bf16_f32 v54, v72, v73
    v_exp_f32 v77, v77
    v_exp_f32 v78, v78
    v_cvt_pk_bf16_f32 v55, v74, v75
    v_mfma_f32_32x32x16_bf16 a[0:15], a[196:199], a[132:135], a[0:15]
    buffer_load_dwordx4 v180, s[36:39], s47 offen lds
    v_exp_f32 v79, v79
    v_exp_f32 v168, v80
    v_cvt_pk_bf16_f32 v56, v76, v77
    v_smfmac_f32_16x16x64_bf16 v[48:51], v[8:11], v[60:67], v166
    s_add_u32 s47, s47, 16384
    ds_read_b64_tr_b16 v[42:43], v164 offset:9216
    v_exp_f32 v169, v81
    v_mfma_f32_32x32x16_bf16 a[16:31], a[204:207], a[132:135], a[16:31]
    buffer_load_dwordx4 a[132:135], v176, s[32:35], s46 offen offset:512 sc1
    v_exp_f32 v170, v82
    v_cvt_pk_bf16_f32 v57, v78, v79
    v_exp_f32 v171, v83
    v_mfma_f32_32x32x16_bf16 v[68:83], v[28:31], v[12:15], 0
    s_add_u32 m0, s48, 9216
    v_exp_f32 v84, v84
    v_exp_f32 v85, v85
    v_cvt_pk_bf16_f32 v58, v168, v169
    v_cvt_pk_bf16_f32 v59, v170, v171
    v_mfma_f32_32x32x16_bf16 v[68:83], v[32:35], v[16:19], v[68:83]
    s_waitcnt vmcnt(24) lgkmcnt(0)
    buffer_load_dwordx4 v180, s[36:39], s47 offen lds
    v_exp_f32 v86, v86
    v_exp_f32 v87, v87
    v_mfma_f32_32x32x16_bf16 a[32:47], a[192:195], a[136:139], a[32:47]
    s_mov_b32 m0, s25
    ds_read_b64_tr_b16 a[208:209], v181 offset:12288
    v_exp_f32 v88, v88
    v_cvt_pk_bf16_f32 v60, v84, v85
    v_exp_f32 v89, v89
    v_mfma_f32_32x32x16_bf16 v[100:115], v[36:39], v[52:55], v[100:115]
    s_add_u32 s47, s47, 16384
    ds_read_b64_tr_b16 a[210:211], v181 offset:14336
    v_exp_f32 v90, v90
    v_cvt_pk_bf16_f32 v61, v86, v87
    v_exp_f32 v91, v91
    v_mfma_f32_32x32x16_bf16 a[48:63], a[200:203], a[136:139], a[48:63]
    buffer_load_dwordx4 a[136:139], v177, s[32:35], s46 offen sc1
    v_exp_f32 v92, v92
    v_cvt_pk_bf16_f32 v62, v88, v89
    v_mfma_f32_32x32x16_bf16 v[100:115], v[40:43], v[56:59], v[100:115]
    s_add_u32 s26, s26, 16384
    ds_read_b64_tr_b16 a[216:217], v182 offset:12288
    v_exp_f32 v93, v93
    v_exp_f32 v94, v94
    v_cvt_pk_bf16_f32 v63, v90, v91
    v_mfma_f32_32x32x16_bf16 a[32:47], a[196:199], a[140:143], a[32:47]
    buffer_load_dwordx4 v2, s[8:11], s23 offen offset:1024 sc1 lds
    v_exp_f32 v95, v95
    v_exp_f32 v172, v96
    v_cvt_pk_bf16_f32 v64, v92, v93
    v_smfmac_f32_16x16x64_bf16 v[44:47], v[8:11], v[52:59], v166
    s_and_b32 s26, s26, 65535
    ds_read_b64_tr_b16 a[218:219], v182 offset:14336
    v_exp_f32 v173, v97
    v_mfma_f32_32x32x16_bf16 a[48:63], a[204:207], a[140:143], a[48:63]
    buffer_load_dwordx4 a[140:143], v177, s[32:35], s46 offen offset:512 sc1
    v_exp_f32 v174, v98
    v_cvt_pk_bf16_f32 v65, v94, v95
    v_exp_f32 v175, v99
    v_mfma_f32_32x32x16_bf16 v[84:99], v[28:31], v[20:23], 0
    ds_read_b128 v[28:31], v6 offset:4096
    v_exp_f32 v68, v68
    v_exp_f32 v69, v69
    v_cvt_pk_bf16_f32 v66, v172, v173
    v_mfma_f32_32x32x16_bf16 v[84:99], v[32:35], v[24:27], v[84:99]
    s_waitcnt vmcnt(25)
    ds_read_b128 v[32:35], v6 offset:4608
    v_cvt_pk_bf16_f32 v67, v174, v175
    v_exp_f32 v70, v70
    v_exp_f32 v71, v71
    v_mfma_f32_32x32x16_bf16 a[64:79], a[192:195], a[144:147], a[64:79]
    s_add_u32 m0, s48, 10240
    v_exp_f32 v72, v72
    v_cvt_pk_bf16_f32 v52, v68, v69
    v_exp_f32 v73, v73
    v_mfma_f32_32x32x16_bf16 v[116:131], v[36:39], v[60:63], v[116:131]
    ds_read_b64_tr_b16 v[36:37], v7 offset:10240
    ds_read_b64_tr_b16 v[38:39], v164 offset:10240
    v_exp_f32 v74, v74
    v_cvt_pk_bf16_f32 v53, v70, v71
    v_mfma_f32_32x32x16_bf16 a[80:95], a[200:203], a[144:147], a[80:95]
    buffer_load_dwordx4 a[144:147], v178, s[32:35], s46 offen sc1
    v_exp_f32 v75, v75
    v_exp_f32 v76, v76
    v_mfma_f32_32x32x16_bf16 v[116:131], v[40:43], v[64:67], v[116:131]
    s_waitcnt lgkmcnt(2)
    ds_read_b64_tr_b16 v[40:41], v7 offset:11264
    v_cvt_pk_bf16_f32 v54, v72, v73
    v_exp_f32 v77, v77
    v_exp_f32 v78, v78
    v_cvt_pk_bf16_f32 v55, v74, v75
    v_mfma_f32_32x32x16_bf16 a[64:79], a[196:199], a[148:151], a[64:79]
    buffer_load_dwordx4 v180, s[36:39], s47 offen lds
    v_exp_f32 v79, v79
    v_exp_f32 v168, v80
    v_cvt_pk_bf16_f32 v56, v76, v77
    v_smfmac_f32_16x16x64_bf16 v[48:51], v[8:11], v[60:67], v166
    s_add_u32 s47, s47, 16384
    ds_read_b64_tr_b16 v[42:43], v164 offset:11264
    v_exp_f32 v169, v81
    v_mfma_f32_32x32x16_bf16 a[80:95], a[204:207], a[148:151], a[80:95]
    buffer_load_dwordx4 a[148:151], v178, s[32:35], s46 offen offset:512 sc1
    v_exp_f32 v170, v82
    v_cvt_pk_bf16_f32 v57, v78, v79
    v_exp_f32 v171, v83
    v_mfma_f32_32x32x16_bf16 v[68:83], v[28:31], v[12:15], 0
    s_add_u32 m0, s48, 11264
    v_exp_f32 v84, v84
    v_exp_f32 v85, v85
    v_cvt_pk_bf16_f32 v58, v168, v169
    v_cvt_pk_bf16_f32 v59, v170, v171
    v_mfma_f32_32x32x16_bf16 v[68:83], v[32:35], v[16:19], v[68:83]
    s_waitcnt vmcnt(24) lgkmcnt(0)
    buffer_load_dwordx4 v180, s[36:39], s47 offen lds
    v_exp_f32 v86, v86
    v_exp_f32 v87, v87
    v_mfma_f32_32x32x16_bf16 a[96:111], a[192:195], a[152:155], a[96:111]
    s_add_u32 m0, s25, 8192
    ds_read_b64_tr_b16 a[212:213], v181 offset:13312
    v_exp_f32 v88, v88
    v_cvt_pk_bf16_f32 v60, v84, v85
    v_exp_f32 v89, v89
    v_mfma_f32_32x32x16_bf16 v[100:115], v[36:39], v[52:55], v[100:115]
    s_add_u32 s47, s47, 212992
    ds_read_b64_tr_b16 a[214:215], v181 offset:15360
    v_exp_f32 v90, v90
    v_cvt_pk_bf16_f32 v61, v86, v87
    v_exp_f32 v91, v91
    v_mfma_f32_32x32x16_bf16 a[112:127], a[200:203], a[152:155], a[112:127]
    buffer_load_dwordx4 a[152:155], v179, s[32:35], s46 offen sc1
    v_exp_f32 v92, v92
    v_cvt_pk_bf16_f32 v62, v88, v89
    v_mfma_f32_32x32x16_bf16 v[100:115], v[40:43], v[56:59], v[100:115]
    ds_read_b64_tr_b16 a[220:221], v182 offset:13312
    v_exp_f32 v93, v93
    v_exp_f32 v94, v94
    v_cvt_pk_bf16_f32 v63, v90, v91
    v_mfma_f32_32x32x16_bf16 a[96:111], a[196:199], a[156:159], a[96:111]
    buffer_load_dwordx4 v3, s[12:15], s23 offen sc1 lds
    v_exp_f32 v95, v95
    v_exp_f32 v172, v96
    v_cvt_pk_bf16_f32 v64, v92, v93
    v_smfmac_f32_16x16x64_bf16 v[44:47], v[8:11], v[52:59], v166
    ds_read_b64_tr_b16 a[222:223], v182 offset:15360
    v_exp_f32 v173, v97
    v_mfma_f32_32x32x16_bf16 a[112:127], a[204:207], a[156:159], a[112:127]
    buffer_load_dwordx4 a[156:159], v179, s[32:35], s46 offen offset:512 sc1
    v_exp_f32 v174, v98
    v_cvt_pk_bf16_f32 v65, v94, v95
    v_exp_f32 v175, v99
    v_mfma_f32_32x32x16_bf16 v[84:99], v[28:31], v[20:23], 0
    s_add_u32 s46, s46, 0x80000
    ds_read_b128 v[28:31], v6 offset:6144
    v_exp_f32 v68, v68
    v_exp_f32 v69, v69
    v_cvt_pk_bf16_f32 v66, v172, v173
    v_mfma_f32_32x32x16_bf16 v[84:99], v[32:35], v[24:27], v[84:99]
    s_waitcnt vmcnt(25) lgkmcnt(1)
    ds_read_b128 v[32:35], v6 offset:6656
    v_cvt_pk_bf16_f32 v67, v174, v175
    v_exp_f32 v70, v70
    v_exp_f32 v71, v71
    v_mfma_f32_32x32x16_bf16 a[0:15], a[208:211], a[160:163], a[0:15]
    s_add_u32 m0, s48, 12288
    v_exp_f32 v72, v72
    v_cvt_pk_bf16_f32 v52, v68, v69
    v_exp_f32 v73, v73
    v_mfma_f32_32x32x16_bf16 v[116:131], v[36:39], v[60:63], v[116:131]
    ds_read_b64_tr_b16 v[36:37], v7 offset:12288
    ds_read_b64_tr_b16 v[38:39], v164 offset:12288
    v_exp_f32 v74, v74
    v_cvt_pk_bf16_f32 v53, v70, v71
    v_mfma_f32_32x32x16_bf16 a[16:31], a[216:219], a[160:163], a[16:31]
    buffer_load_dwordx4 a[160:163], v176, s[32:35], s46 offen sc1
    v_exp_f32 v75, v75
    v_exp_f32 v76, v76
    v_mfma_f32_32x32x16_bf16 v[116:131], v[40:43], v[64:67], v[116:131]
    s_waitcnt lgkmcnt(2)
    ds_read_b64_tr_b16 v[40:41], v7 offset:13312
    v_cvt_pk_bf16_f32 v54, v72, v73
    v_exp_f32 v77, v77
    v_exp_f32 v78, v78
    v_cvt_pk_bf16_f32 v55, v74, v75
    v_mfma_f32_32x32x16_bf16 a[0:15], a[212:215], a[164:167], a[0:15]
    buffer_load_dwordx4 v180, s[36:39], s47 offen lds
    v_exp_f32 v79, v79
    v_exp_f32 v168, v80
    v_cvt_pk_bf16_f32 v56, v76, v77
    v_smfmac_f32_16x16x64_bf16 v[48:51], v[8:11], v[60:67], v166
    s_add_u32 s47, s47, 16384
    ds_read_b64_tr_b16 v[42:43], v164 offset:13312
    v_exp_f32 v169, v81
    v_mfma_f32_32x32x16_bf16 a[16:31], a[220:223], a[164:167], a[16:31]
    buffer_load_dwordx4 a[164:167], v176, s[32:35], s46 offen offset:512 sc1
    v_exp_f32 v170, v82
    v_cvt_pk_bf16_f32 v57, v78, v79
    v_exp_f32 v171, v83
    v_mfma_f32_32x32x16_bf16 v[68:83], v[28:31], v[12:15], 0
    s_add_u32 m0, s48, 13312
    v_exp_f32 v84, v84
    v_exp_f32 v85, v85
    v_cvt_pk_bf16_f32 v58, v168, v169
    v_cvt_pk_bf16_f32 v59, v170, v171
    v_mfma_f32_32x32x16_bf16 v[68:83], v[32:35], v[16:19], v[68:83]
    s_waitcnt vmcnt(24) lgkmcnt(0)
    buffer_load_dwordx4 v180, s[36:39], s47 offen lds
    v_exp_f32 v86, v86
    v_exp_f32 v87, v87
    v_mfma_f32_32x32x16_bf16 a[32:47], a[208:211], a[168:171], a[32:47]
    s_add_u32 m0, s25, 8192
    ds_read_b64_tr_b16 a[192:193], v181 offset:0
    v_exp_f32 v88, v88
    v_cvt_pk_bf16_f32 v60, v84, v85
    v_exp_f32 v89, v89
    v_mfma_f32_32x32x16_bf16 v[100:115], v[36:39], v[52:55], v[100:115]
    s_add_u32 s47, s47, 16384
    ds_read_b64_tr_b16 a[194:195], v181 offset:2048
    v_exp_f32 v90, v90
    v_cvt_pk_bf16_f32 v61, v86, v87
    v_exp_f32 v91, v91
    v_mfma_f32_32x32x16_bf16 a[48:63], a[216:219], a[168:171], a[48:63]
    buffer_load_dwordx4 a[168:171], v177, s[32:35], s46 offen sc1
    v_exp_f32 v92, v92
    v_cvt_pk_bf16_f32 v62, v88, v89
    v_exp_f32 v93, v93
    v_mfma_f32_32x32x16_bf16 v[100:115], v[40:43], v[56:59], v[100:115]
    ds_read_b64_tr_b16 a[200:201], v182 offset:0
    v_exp_f32 v94, v94
    v_cvt_pk_bf16_f32 v63, v90, v91
    v_exp_f32 v95, v95
    v_mfma_f32_32x32x16_bf16 a[32:47], a[212:215], a[172:175], a[32:47]
    buffer_load_dwordx4 v3, s[12:15], s23 offen offset:1024 sc1 lds
    v_exp_f32 v172, v96
    v_cvt_pk_bf16_f32 v64, v92, v93
    v_exp_f32 v173, v97
    v_smfmac_f32_16x16x64_bf16 v[44:47], v[8:11], v[52:59], v166
    s_add_u32 s23, s23, 8192
    ds_read_b64_tr_b16 a[202:203], v182 offset:2048
    v_exp_f32 v174, v98
    v_mfma_f32_32x32x16_bf16 a[48:63], a[220:223], a[172:175], a[48:63]
    buffer_load_dwordx4 a[172:175], v177, s[32:35], s46 offen offset:512 sc1
    v_cvt_pk_bf16_f32 v65, v94, v95
    v_exp_f32 v175, v99
    v_add_u32 v6, s26, v4
    v_mfma_f32_32x32x16_bf16 v[84:99], v[28:31], v[20:23], 0
    s_barrier
    ds_read_b128 v[28:31], v6 offset:0
    v_exp_f32 v68, v68
    v_exp_f32 v69, v69
    v_mfma_f32_32x32x16_bf16 v[84:99], v[32:35], v[24:27], v[84:99]
    s_waitcnt vmcnt(25)
    ds_read_b128 v[32:35], v6 offset:512
    v_cvt_pk_bf16_f32 v66, v172, v173
    v_cvt_pk_bf16_f32 v67, v174, v175
    v_exp_f32 v70, v70
    v_mfma_f32_32x32x16_bf16 a[64:79], a[208:211], a[176:179], a[64:79]
    s_add_u32 m0, s48, 14336
    v_exp_f32 v71, v71
    v_exp_f32 v72, v72
    v_cvt_pk_bf16_f32 v52, v68, v69
    v_mfma_f32_32x32x16_bf16 v[116:131], v[36:39], v[60:63], v[116:131]
    s_add_u32 s25, s25, 16384
    ds_read_b64_tr_b16 v[36:37], v7 offset:14336
    ds_read_b64_tr_b16 v[38:39], v164 offset:14336
    v_exp_f32 v73, v73
    v_exp_f32 v74, v74
    v_mfma_f32_32x32x16_bf16 a[80:95], a[216:219], a[176:179], a[80:95]
    s_and_b32 s25, s25, 65535
    buffer_load_dwordx4 a[176:179], v178, s[32:35], s46 offen sc1
    v_cvt_pk_bf16_f32 v53, v70, v71
    v_exp_f32 v75, v75
    v_exp_f32 v76, v76
    v_mfma_f32_32x32x16_bf16 v[116:131], v[40:43], v[64:67], v[116:131]
    s_waitcnt lgkmcnt(2)
    ds_read_b64_tr_b16 v[40:41], v7 offset:15360
    v_cvt_pk_bf16_f32 v54, v72, v73
    v_exp_f32 v77, v77
    v_exp_f32 v78, v78
    v_cvt_pk_bf16_f32 v55, v74, v75
    v_mfma_f32_32x32x16_bf16 a[64:79], a[212:215], a[180:183], a[64:79]
    buffer_load_dwordx4 v180, s[36:39], s47 offen lds
    v_exp_f32 v79, v79
    v_exp_f32 v168, v80
    v_cvt_pk_bf16_f32 v56, v76, v77
    v_smfmac_f32_16x16x64_bf16 v[48:51], v[8:11], v[60:67], v166
    s_add_u32 s47, s47, 16384
    ds_read_b64_tr_b16 v[42:43], v164 offset:15360
    v_exp_f32 v169, v81
    v_mfma_f32_32x32x16_bf16 a[80:95], a[220:223], a[180:183], a[80:95]
    buffer_load_dwordx4 a[180:183], v178, s[32:35], s46 offen offset:512 sc1
    v_exp_f32 v170, v82
    v_cvt_pk_bf16_f32 v57, v78, v79
    v_exp_f32 v171, v83
    v_mfma_f32_32x32x16_bf16 v[68:83], v[28:31], v[12:15], 0
    s_add_u32 m0, s48, 15360
    v_exp_f32 v84, v84
    v_exp_f32 v85, v85
    v_cvt_pk_bf16_f32 v58, v168, v169
    v_cvt_pk_bf16_f32 v59, v170, v171
    v_mfma_f32_32x32x16_bf16 v[68:83], v[32:35], v[16:19], v[68:83]
    s_waitcnt vmcnt(24) lgkmcnt(0)
    buffer_load_dwordx4 v180, s[36:39], s47 offen lds
    v_exp_f32 v86, v86
    v_exp_f32 v87, v87
    v_mfma_f32_32x32x16_bf16 a[96:111], a[208:211], a[184:187], a[96:111]
    s_mov_b32 m0, s25
    ds_read_b64_tr_b16 a[196:197], v181 offset:1024
    v_exp_f32 v88, v88
    v_cvt_pk_bf16_f32 v60, v84, v85
    v_exp_f32 v89, v89
    v_mfma_f32_32x32x16_bf16 v[100:115], v[36:39], v[52:55], v[100:115]
    s_add_u32 s47, s47, 212992
    ds_read_b64_tr_b16 a[198:199], v181 offset:3072
    v_exp_f32 v90, v90
    v_cvt_pk_bf16_f32 v61, v86, v87
    v_exp_f32 v91, v91
    v_mfma_f32_32x32x16_bf16 a[112:127], a[216:219], a[184:187], a[112:127]
    buffer_load_dwordx4 a[184:187], v179, s[32:35], s46 offen sc1
    v_exp_f32 v92, v92
    v_cvt_pk_bf16_f32 v62, v88, v89
    v_exp_f32 v93, v93
    v_mfma_f32_32x32x16_bf16 v[100:115], v[40:43], v[56:59], v[100:115]
    ds_read_b64_tr_b16 a[204:205], v182 offset:1024
    v_exp_f32 v94, v94
    v_cvt_pk_bf16_f32 v63, v90, v91
    v_exp_f32 v95, v95
    v_mfma_f32_32x32x16_bf16 a[96:111], a[212:215], a[188:191], a[96:111]
    buffer_load_dwordx4 v2, s[8:11], s23 offen sc1 lds
    v_exp_f32 v172, v96
    v_cvt_pk_bf16_f32 v64, v92, v93
    v_exp_f32 v173, v97
    v_smfmac_f32_16x16x64_bf16 v[44:47], v[8:11], v[52:59], v166
    s_sub_u32 s28, s28, 1
    ds_read_b64_tr_b16 a[206:207], v182 offset:3072
    v_exp_f32 v174, v98
    v_mfma_f32_32x32x16_bf16 a[112:127], a[220:223], a[188:191], a[112:127]
    buffer_load_dwordx4 a[188:191], v179, s[32:35], s46 offen offset:512 sc1
    v_cvt_pk_bf16_f32 v65, v94, v95
    v_exp_f32 v175, v99
    v_add_u32 v7, s26, v5
    v_add_u32 v164, s26, v165
    s_cbranch_scc0 L_p2_loop
L_p2_tail:
    v_cvt_pk_bf16_f32 v66, v172, v173
    v_cvt_pk_bf16_f32 v67, v174, v175
    v_mfma_f32_32x32x16_bf16 v[116:131], v[36:39], v[60:63], v[116:131]
    s_nop 0
    v_mfma_f32_32x32x16_bf16 v[116:131], v[40:43], v[64:67], v[116:131]
    v_smfmac_f32_16x16x64_bf16 v[48:51], v[8:11], v[60:67], v166
    s_add_u32 s46, s46, 0x80000
    s_waitcnt vmcnt(25) lgkmcnt(0)
    v_mfma_f32_32x32x16_bf16 a[0:15], a[192:195], a[128:131], a[0:15]
    s_add_u32 m0, s48, 0
    ds_read_b64_tr_b16 a[208:209], v181 offset:4096
    s_mov_b32 s50, 0x17800000
    s_mov_b32 s51, 0x76800000
    s_mov_b32 s52, 0x7f800000
    s_mov_b32 s53, 0x12800000
    v_add_f32 v44, v44, v45
    v_add_f32 v46, abs(v100), abs(v101)
    v_rcp_f32 v45, v44
    v_add_f32 v47, abs(v102), abs(v103)
    v_add_f32 v46, v46, abs(v104)
    v_mfma_f32_32x32x16_bf16 a[16:31], a[200:203], a[128:131], a[16:31]
    buffer_load_dwordx4 a[128:131], v176, s[32:35], s46 offen sc1
    v_add_f32 v47, v47, abs(v105)
    v_add_f32 v46, v46, abs(v106)
    v_add_f32 v47, v47, abs(v107)
    v_add_f32 v46, v46, abs(v108)
    v_add_f32 v47, v47, abs(v109)
    v_add_f32 v46, v46, abs(v110)
    v_add_f32 v47, v47, abs(v111)
    v_add_f32 v46, v46, abs(v112)
    v_add_f32 v47, v47, abs(v113)
    v_mfma_f32_32x32x16_bf16 a[0:15], a[196:199], a[132:135], a[0:15]
    buffer_load_dwordx4 v190, s[84:87], s49 offen lds
    s_add_u32 s49, s49, 0x10000
    ds_read_b64_tr_b16 a[210:211], v181 offset:6144
    v_add_f32 v46, v46, abs(v114)
    v_add_f32 v47, v47, abs(v115)
    v_mul_f32 v100, v100, v45
    v_mul_f32 v101, v101, v45
    v_mul_f32 v102, v102, v45
    v_mul_f32 v103, v103, v45
    v_mul_f32 v104, v104, v45
    v_mul_f32 v105, v105, v45
    v_mul_f32 v106, v106, v45
    v_mfma_f32_32x32x16_bf16 a[16:31], a[204:207], a[132:135], a[16:31]
    buffer_load_dwordx4 a[132:135], v176, s[32:35], s46 offen offset:512 sc1
    v_mul_f32 v107, v107, v45
    v_mul_f32 v108, v108, v45
    v_mul_f32 v109, v109, v45
    v_mul_f32 v110, v110, v45
    v_mul_f32 v111, v111, v45
    v_mul_f32 v112, v112, v45
    v_mul_f32 v113, v113, v45
    v_mul_f32 v114, v114, v45
    v_mul_f32 v115, v115, v45
    s_waitcnt vmcnt(24)
    v_mfma_f32_32x32x16_bf16 a[32:47], a[192:195], a[136:139], a[32:47]
    s_add_u32 m0, s48, 1024
    ds_read_b64_tr_b16 a[216:217], v182 offset:4096
    v_cvt_pk_bf16_f32 v68, v100, v101
    v_cvt_pk_bf16_f32 v69, v102, v103
    v_cvt_pk_bf16_f32 v70, v108, v109
    v_cvt_pk_bf16_f32 v71, v110, v111
    buffer_store_dwordx4 v[68:71], v4, s[16:19], s27 offen offset:0 sc1
    v_cvt_pk_bf16_f32 v72, v104, v105
    v_cvt_pk_bf16_f32 v73, v106, v107
    v_cvt_pk_bf16_f32 v74, v112, v113
    v_cvt_pk_bf16_f32 v75, v114, v115
    v_mfma_f32_32x32x16_bf16 a[48:63], a[200:203], a[136:139], a[48:63]
    buffer_load_dwordx4 a[136:139], v177, s[32:35], s46 offen sc1
    buffer_store_dwordx4 v[72:75], v4, s[16:19], s27 offen offset:512 sc1
    v_add_f32 v48, v48, v49
    v_add_f32 v50, abs(v116), abs(v117)
    v_rcp_f32 v49, v48
    v_add_f32 v51, abs(v118), abs(v119)
    v_add_f32 v50, v50, abs(v120)
    v_add_f32 v51, v51, abs(v121)
    v_add_f32 v50, v50, abs(v122)
    v_add_f32 v51, v51, abs(v123)
    v_mfma_f32_32x32x16_bf16 a[32:47], a[196:199], a[140:143], a[32:47]
    buffer_load_dwordx4 v190, s[84:87], s49 offen lds
    s_add_u32 s49, s49, 0x10000
    ds_read_b64_tr_b16 a[218:219], v182 offset:6144
    v_add_f32 v50, v50, abs(v124)
    v_add_f32 v51, v51, abs(v125)
    v_add_f32 v50, v50, abs(v126)
    v_add_f32 v51, v51, abs(v127)
    v_add_f32 v50, v50, abs(v128)
    v_add_f32 v51, v51, abs(v129)
    v_add_f32 v50, v50, abs(v130)
    v_add_f32 v51, v51, abs(v131)
    v_mul_f32 v116, v116, v49
    v_mfma_f32_32x32x16_bf16 a[48:63], a[204:207], a[140:143], a[48:63]
    buffer_load_dwordx4 a[140:143], v177, s[32:35], s46 offen offset:512 sc1
    v_mul_f32 v117, v117, v49
    v_mul_f32 v118, v118, v49
    v_mul_f32 v119, v119, v49
    v_mul_f32 v120, v120, v49
    v_mul_f32 v121, v121, v49
    v_mul_f32 v122, v122, v49
    v_mul_f32 v123, v123, v49
    v_mul_f32 v124, v124, v49
    v_mul_f32 v125, v125, v49
    s_waitcnt vmcnt(26)
    v_mfma_f32_32x32x16_bf16 a[64:79], a[192:195], a[144:147], a[64:79]
    s_add_u32 m0, s48, 2048
    ds_read_b64_tr_b16 a[212:213], v181 offset:5120
    v_mul_f32 v126, v126, v49
    v_mul_f32 v127, v127, v49
    v_mul_f32 v128, v128, v49
    v_mul_f32 v129, v129, v49
    v_mul_f32 v130, v130, v49
    v_mul_f32 v131, v131, v49
    v_cvt_pk_bf16_f32 v84, v116, v117
    v_cvt_pk_bf16_f32 v85, v118, v119
    v_cvt_pk_bf16_f32 v86, v124, v125
    v_mfma_f32_32x32x16_bf16 a[80:95], a[200:203], a[144:147], a[80:95]
    buffer_load_dwordx4 a[144:147], v178, s[32:35], s46 offen sc1
    v_cvt_pk_bf16_f32 v87, v126, v127
    buffer_store_dwordx4 v[84:87], v4, s[16:19], s27 offen offset:2048 sc1
    v_cvt_pk_bf16_f32 v88, v120, v121
    v_cvt_pk_bf16_f32 v89, v122, v123
    v_cvt_pk_bf16_f32 v90, v128, v129
    v_cvt_pk_bf16_f32 v91, v130, v131
    buffer_store_dwordx4 v[88:91], v4, s[16:19], s27 offen offset:2560 sc1
    v_add_f32 v46, v46, v47
    v_cmp_nle_f32 vcc, s50, v44
    v_mfma_f32_32x32x16_bf16 a[64:79], a[196:199], a[148:151], a[64:79]
    buffer_load_dwordx4 v190, s[84:87], s49 offen lds
    s_add_u32 s49, s49, 0x10000
    ds_read_b64_tr_b16 a[214:215], v181 offset:7168
    s_mov_b64 s[54:55], vcc
    v_cmp_nge_f32 vcc, s51, v44
    s_or_b64 s[54:55], s[54:55], vcc
    v_cmp_ngt_f32 vcc, s52, v46
    s_or_b64 s[54:55], s[54:55], vcc
    v_fma_f32 v47, v44, s53, v46
    v_cmp_nle_f32 vcc, s53, v47
    s_or_b64 s[54:55], s[54:55], vcc
    v_add_f32 v50, v50, v51
    v_mfma_f32_32x32x16_bf16 a[80:95], a[204:207], a[148:151], a[80:95]
    buffer_load_dwordx4 a[148:151], v178, s[32:35], s46 offen offset:512 sc1
    v_cmp_nle_f32 vcc, s50, v48
    s_or_b64 s[54:55], s[54:55], vcc
    v_cmp_nge_f32 vcc, s51, v48
    s_or_b64 s[54:55], s[54:55], vcc
    v_cmp_ngt_f32 vcc, s52, v50
    s_or_b64 s[54:55], s[54:55], vcc
    v_fma_f32 v51, v48, s53, v50
    v_cmp_nle_f32 vcc, s53, v51
    s_or_b64 s[54:55], s[54:55], vcc
    s_waitcnt vmcnt(27)
    v_mfma_f32_32x32x16_bf16 a[96:111], a[192:195], a[152:155], a[96:111]
    s_add_u32 m0, s48, 3072
    ds_read_b64_tr_b16 a[220:221], v182 offset:5120
    s_or_b32 s50, s54, s55
    s_min_u32 s50, s50, 1
    s_lshl_b32 s51, s77, 2
    v_mov_b32 v169, s50
    v_mov_b32 v170, 163824
    v_add_u32 v168, s51, v170
    ds_write_b32 v168, v169
    v_mfma_f32_32x32x16_bf16 a[112:127], a[200:203], a[152:155], a[112:127]
    buffer_load_dwordx4 a[152:155], v179, s[32:35], s46 offen sc1
    v_mfma_f32_32x32x16_bf16 a[96:111], a[196:199], a[156:159], a[96:111]
    buffer_load_dwordx4 v190, s[84:87], s49 offen lds
    s_add_u32 s49, s49, 0x10000
    ds_read_b64_tr_b16 a[222:223], v182 offset:7168
    v_mfma_f32_32x32x16_bf16 a[112:127], a[204:207], a[156:159], a[112:127]
    buffer_load_dwordx4 a[156:159], v179, s[32:35], s46 offen offset:512 sc1
    s_add_u32 s46, s46, 0x80000
    s_waitcnt vmcnt(17) lgkmcnt(1)
    s_barrier
    ds_read_b128 v[28:31], v170
    s_waitcnt lgkmcnt(1)
    v_mfma_f32_32x32x16_bf16 a[0:15], a[208:211], a[160:163], a[0:15]
    s_add_u32 m0, s48, 4096
    ds_read_b64_tr_b16 a[192:193], v181 offset:8192
    v_mfma_f32_32x32x16_bf16 a[16:31], a[216:219], a[160:163], a[16:31]
    buffer_load_dwordx4 a[160:163], v176, s[32:35], s46 offen sc1
    v_mfma_f32_32x32x16_bf16 a[0:15], a[212:215], a[164:167], a[0:15]
    buffer_load_dwordx4 v190, s[84:87], s49 offen lds
    s_add_u32 s49, s49, 0x10000
    ds_read_b64_tr_b16 a[194:195], v181 offset:10240
    v_mfma_f32_32x32x16_bf16 a[16:31], a[220:223], a[164:167], a[16:31]
    buffer_load_dwordx4 a[164:167], v176, s[32:35], s46 offen offset:512 sc1
    s_waitcnt lgkmcnt(2)
    v_or_b32 v28, v28, v29
    v_or3_b32 v28, v28, v30, v31
    s_nop 0
    v_readfirstlane_b32 s50, v28
    s_cmp_lg_u32 s50, 0
    s_cbranch_scc1 L_p2_slow
L_p2_voted:
    v_mfma_f32_32x32x16_bf16 a[32:47], a[208:211], a[168:171], a[32:47]
    s_add_u32 m0, s48, 5120
    ds_read_b64_tr_b16 a[200:201], v182 offset:8192
    v_mfma_f32_32x32x16_bf16 a[48:63], a[216:219], a[168:171], a[48:63]
    buffer_load_dwordx4 a[168:171], v177, s[32:35], s46 offen sc1
    v_mfma_f32_32x32x16_bf16 a[32:47], a[212:215], a[172:175], a[32:47]
    buffer_load_dwordx4 v190, s[84:87], s49 offen lds
    s_add_u32 s49, s49, 0x10000
    ds_read_b64_tr_b16 a[202:203], v182 offset:10240
    v_mfma_f32_32x32x16_bf16 a[48:63], a[220:223], a[172:175], a[48:63]
    buffer_load_dwordx4 a[172:175], v177, s[32:35], s46 offen offset:512 sc1
    v_mfma_f32_32x32x16_bf16 a[64:79], a[208:211], a[176:179], a[64:79]
    s_add_u32 m0, s48, 6144
    ds_read_b64_tr_b16 a[196:197], v181 offset:9216
    v_mfma_f32_32x32x16_bf16 a[80:95], a[216:219], a[176:179], a[80:95]
    buffer_load_dwordx4 a[176:179], v178, s[32:35], s46 offen sc1
    v_mfma_f32_32x32x16_bf16 a[64:79], a[212:215], a[180:183], a[64:79]
    buffer_load_dwordx4 v190, s[84:87], s49 offen lds
    s_add_u32 s49, s49, 0x10000
    ds_read_b64_tr_b16 a[198:199], v181 offset:11264
    v_mfma_f32_32x32x16_bf16 a[80:95], a[220:223], a[180:183], a[80:95]
    buffer_load_dwordx4 a[180:183], v178, s[32:35], s46 offen offset:512 sc1
    s_waitcnt vmcnt(25)
    v_mfma_f32_32x32x16_bf16 a[96:111], a[208:211], a[184:187], a[96:111]
    s_add_u32 m0, s48, 7168
    ds_read_b64_tr_b16 a[204:205], v182 offset:9216
    v_mfma_f32_32x32x16_bf16 a[112:127], a[216:219], a[184:187], a[112:127]
    buffer_load_dwordx4 a[184:187], v179, s[32:35], s46 offen sc1
    v_mfma_f32_32x32x16_bf16 a[96:111], a[212:215], a[188:191], a[96:111]
    buffer_load_dwordx4 v190, s[84:87], s49 offen lds
    s_add_u32 s49, s49, 0x10000
    ds_read_b64_tr_b16 a[206:207], v182 offset:11264
    v_mfma_f32_32x32x16_bf16 a[112:127], a[220:223], a[188:191], a[112:127]
    buffer_load_dwordx4 a[188:191], v179, s[32:35], s46 offen offset:512 sc1
    s_add_u32 s46, s46, 0x80000
    s_barrier
    s_waitcnt vmcnt(20) lgkmcnt(0)
    v_mfma_f32_32x32x16_bf16 a[32:47], a[192:195], a[136:139], a[32:47]
    s_add_u32 m0, s48, 8192
    ds_read_b64_tr_b16 a[208:209], v181 offset:12288
    ds_read_b64_tr_b16 a[210:211], v181 offset:14336
    v_mfma_f32_32x32x16_bf16 a[48:63], a[200:203], a[136:139], a[48:63]
    ds_read_b64_tr_b16 a[216:217], v182 offset:12288
    ds_read_b64_tr_b16 a[218:219], v182 offset:14336
    v_mfma_f32_32x32x16_bf16 a[32:47], a[196:199], a[140:143], a[32:47]
    ds_read_b64_tr_b16 a[212:213], v181 offset:13312
    ds_read_b64_tr_b16 a[214:215], v181 offset:15360
    buffer_load_dwordx4 v190, s[84:87], s49 offen lds
    s_add_u32 s49, s49, 0x10000
    v_mfma_f32_32x32x16_bf16 a[48:63], a[204:207], a[140:143], a[48:63]
    ds_read_b64_tr_b16 a[220:221], v182 offset:13312
    ds_read_b64_tr_b16 a[222:223], v182 offset:15360
    s_waitcnt vmcnt(18)
    s_mov_b32 exec_hi, 0
    buffer_store_dword v160, v161, s[40:43], s96 offen sc1
    s_mov_b64 exec, -1
    s_waitcnt vmcnt(8) lgkmcnt(0)
    v_mfma_f32_32x32x16_bf16 a[32:47], a[208:211], a[168:171], a[32:47]
    s_add_u32 m0, s48, 9216
    s_lshl_b32 s52, s77, 14
    v_mfma_f32_32x32x16_bf16 a[48:63], a[216:219], a[168:171], a[48:63]
    v_add_u32 v8, s52, v189
    v_mfma_f32_32x32x16_bf16 a[32:47], a[212:215], a[172:175], a[32:47]
    buffer_load_dwordx4 v190, s[84:87], s49 offen lds
    s_add_u32 s49, s49, 0x10000
    s_lshl_b32 s52, s77, 13
    v_mfma_f32_32x32x16_bf16 a[48:63], a[220:223], a[172:175], a[48:63]
    s_add_u32 s52, s52, 131072
    v_mfma_f32_32x32x16_bf16 a[64:79], a[192:195], a[144:147], a[64:79]
    s_add_u32 m0, s48, 10240
    v_add_u32 v9, s52, v189
    v_mfma_f32_32x32x16_bf16 a[80:95], a[200:203], a[144:147], a[80:95]
    s_mov_b32 s32, s72
    v_mfma_f32_32x32x16_bf16 a[64:79], a[196:199], a[148:151], a[64:79]
    buffer_load_dwordx4 v190, s[84:87], s49 offen lds
    s_add_u32 s49, s49, 0x10000
    ds_write_b128 v186, a[32:35] offset:0
    s_mov_b32 s33, s73
    v_mfma_f32_32x32x16_bf16 a[80:95], a[204:207], a[148:151], a[80:95]
    ds_write_b128 v186, a[36:39] offset:1024
    s_mov_b32 s34, 4194304
    s_waitcnt vmcnt(7)
    v_mfma_f32_32x32x16_bf16 a[64:79], a[208:211], a[176:179], a[64:79]
    s_add_u32 m0, s48, 11264
    ds_write_b128 v186, a[40:43] offset:2048
    s_mov_b32 s35, 0x20000
    v_mfma_f32_32x32x16_bf16 a[80:95], a[216:219], a[176:179], a[80:95]
    ds_write_b128 v186, a[44:47] offset:3072
    v_mfma_f32_32x32x16_bf16 a[64:79], a[212:215], a[180:183], a[64:79]
    buffer_load_dwordx4 v190, s[84:87], s49 offen lds
    s_add_u32 s49, s49, 0x10000
    ds_write_b128 v186, a[48:51] offset:4096
    ds_write_b128 v186, a[52:55] offset:5120
    v_mfma_f32_32x32x16_bf16 a[80:95], a[220:223], a[180:183], a[80:95]
    ds_write_b128 v186, a[56:59] offset:6144
    ds_write_b128 v186, a[60:63] offset:7168
    v_mfma_f32_32x32x16_bf16 a[96:111], a[192:195], a[152:155], a[96:111]
    s_add_u32 m0, s48, 12288
    v_mfma_f32_32x32x16_bf16 a[112:127], a[200:203], a[152:155], a[112:127]
    v_mfma_f32_32x32x16_bf16 a[96:111], a[196:199], a[156:159], a[96:111]
    buffer_load_dwordx4 v190, s[84:87], s49 offen lds
    s_add_u32 s49, s49, 0x10000
    ds_write_b128 v187, a[64:67] offset:0
    v_mfma_f32_32x32x16_bf16 a[112:127], a[204:207], a[156:159], a[112:127]
    ds_write_b128 v187, a[68:71] offset:1024
    s_waitcnt vmcnt(6)
    v_mfma_f32_32x32x16_bf16 a[96:111], a[208:211], a[184:187], a[96:111]
    s_add_u32 m0, s48, 13312
    ds_write_b128 v187, a[72:75] offset:2048
    v_mfma_f32_32x32x16_bf16 a[112:127], a[216:219], a[184:187], a[112:127]
    ds_write_b128 v187, a[76:79] offset:3072
    v_mfma_f32_32x32x16_bf16 a[96:111], a[212:215], a[188:191], a[96:111]
    buffer_load_dwordx4 v190, s[84:87], s49 offen lds
    s_add_u32 s49, s49, 0x10000
    ds_write_b128 v187, a[80:83] offset:4096
    ds_write_b128 v187, a[84:87] offset:5120
    v_mfma_f32_32x32x16_bf16 a[112:127], a[220:223], a[188:191], a[112:127]
    ds_write_b128 v187, a[88:91] offset:6144
    ds_write_b128 v187, a[92:95] offset:7168
    v_add_u32 v159, 262144, v159
    buffer_load_dword v185, v159, s[40:43], 0 offen sc1
    v_mfma_f32_32x32x16_bf16 a[0:15], a[192:195], a[128:131], a[0:15]
    s_add_u32 m0, s48, 14336
    v_mfma_f32_32x32x16_bf16 a[16:31], a[200:203], a[128:131], a[16:31]
    v_mfma_f32_32x32x16_bf16 a[0:15], a[196:199], a[132:135], a[0:15]
    buffer_load_dwordx4 v190, s[84:87], s49 offen lds
    s_add_u32 s49, s49, 0x10000
    ds_write_b128 v188, a[96:99] offset:0
    v_mfma_f32_32x32x16_bf16 a[16:31], a[204:207], a[132:135], a[16:31]
    ds_write_b128 v188, a[100:103] offset:1024
    v_mfma_f32_32x32x16_bf16 a[0:15], a[208:211], a[160:163], a[0:15]
    s_add_u32 m0, s48, 15360
    ds_write_b128 v188, a[104:107] offset:2048
    v_mfma_f32_32x32x16_bf16 a[16:31], a[216:219], a[160:163], a[16:31]
    ds_write_b128 v188, a[108:111] offset:3072
    v_mfma_f32_32x32x16_bf16 a[0:15], a[212:215], a[164:167], a[0:15]
    buffer_load_dwordx4 v190, s[84:87], s49 offen lds
    s_add_u32 s49, s49, 0x10000
    ds_write_b128 v188, a[112:115] offset:4096
    ds_write_b128 v188, a[116:119] offset:5120
    v_mfma_f32_32x32x16_bf16 a[16:31], a[220:223], a[164:167], a[16:31]
    ds_write_b128 v188, a[120:123] offset:6144
    ds_write_b128 v188, a[124:127] offset:7168
    s_lshl_b32 s50, s77, 14
    v_subrev_u32 v181, s50, v181
    v_subrev_u32 v182, s50, v182
    v_subrev_u32 v10, 65536, v181
    v_subrev_u32 v11, 65536, v182
    v_accvgpr_read_b32 v80, a0
    v_accvgpr_read_b32 v81, a1
    v_accvgpr_read_b32 v82, a2
    v_accvgpr_read_b32 v83, a3
    v_accvgpr_read_b32 v84, a4
    v_accvgpr_read_b32 v85, a5
    v_accvgpr_read_b32 v86, a6
    v_accvgpr_read_b32 v87, a7
    v_accvgpr_read_b32 v88, a8
    v_accvgpr_read_b32 v89, a9
    v_accvgpr_read_b32 v90, a10
    v_accvgpr_read_b32 v91, a11
    v_accvgpr_read_b32 v92, a12
    v_accvgpr_read_b32 v93, a13
    v_accvgpr_read_b32 v94, a14
    v_accvgpr_read_b32 v95, a15
    v_accvgpr_read_b32 v96, a16
    v_accvgpr_read_b32 v97, a17
    v_accvgpr_read_b32 v98, a18
    v_accvgpr_read_b32 v99, a19
    v_accvgpr_read_b32 v100, a20
    v_accvgpr_read_b32 v101, a21
    v_accvgpr_read_b32 v102, a22
    v_accvgpr_read_b32 v103, a23
    v_accvgpr_read_b32 v104, a24
    v_accvgpr_read_b32 v105, a25
    v_accvgpr_read_b32 v106, a26
    v_accvgpr_read_b32 v107, a27
    v_accvgpr_read_b32 v108, a28
    v_accvgpr_read_b32 v109, a29
    v_accvgpr_read_b32 v110, a30
    v_accvgpr_read_b32 v111, a31
    s_waitcnt lgkmcnt(0)
    s_cmp_lg_u32 s77, 0
    s_cbranch_scc1 L_f3_go
    s_waitcnt vmcnt(2)
    v_cmp_ne_u32 vcc, s76, v185
    s_cmp_eq_u64 vcc, 0
    s_cbranch_scc1 L_f3_go
    s_mov_b32 s50, 0x40000
L_f3_poll:
    buffer_load_dword v185, v159, s[40:43], 0 offen sc1
    s_waitcnt vmcnt(0)
    v_cmp_ne_u32 vcc, s76, v185
    s_cmp_eq_u64 vcc, 0
    s_cbranch_scc1 L_f3_go
    s_sleep 4
    s_sub_u32 s50, s50, 1
    s_cmp_lg_u32 s50, 0
    s_cbranch_scc1 L_f3_poll
L_f3_go:
    s_barrier
    buffer_load_dwordx4 a[128:131], v191, s[4:7], s30 offen sc1
    buffer_load_dwordx4 a[132:135], v191, s[4:7], s30 offen offset:512 sc1
    s_add_u32 s30, s30, 0x20000
    ds_read_b128 v[112:115], v8 offset:0
    ds_read_b128 v[116:119], v8 offset:1024
    ds_read_b128 v[120:123], v8 offset:2048
    ds_read_b128 v[124:127], v8 offset:3072
    buffer_load_dwordx4 a[136:139], v191, s[4:7], s30 offen sc1
    buffer_load_dwordx4 a[140:143], v191, s[4:7], s30 offen offset:512 sc1
    s_add_u32 s30, s30, 0x20000
    ds_read_b128 v[128:131], v8 offset:4096
    ds_read_b128 v[132:135], v8 offset:5120
    ds_read_b128 v[136:139], v8 offset:6144
    ds_read_b128 v[140:143], v8 offset:7168
    buffer_load_dwordx4 a[144:147], v191, s[4:7], s30 offen sc1
    buffer_load_dwordx4 a[148:151], v191, s[4:7], s30 offen offset:512 sc1
    s_add_u32 s30, s30, 0x20000
    ds_read_b128 v[208:211], v8 offset:8192
    ds_read_b128 v[212:215], v8 offset:9216
    ds_read_b128 v[216:219], v8 offset:10240
    ds_read_b128 v[220:223], v8 offset:11264
    buffer_load_dwordx4 a[152:155], v191, s[4:7], s30 offen sc1
    buffer_load_dwordx4 a[156:159], v191, s[4:7], s30 offen offset:512 sc1
    s_add_u32 s30, s30, 0x20000
    s_waitcnt lgkmcnt(4)
    ds_read_b128 v[224:227], v8 offset:12288
    ds_read_b128 v[228:231], v8 offset:13312
    ds_read_b128 v[232:235], v8 offset:14336
    ds_read_b128 v[236:239], v8 offset:15360
    buffer_load_dwordx4 a[160:163], v191, s[4:7], s30 offen sc1
    buffer_load_dwordx4 a[164:167], v191, s[4:7], s30 offen offset:512 sc1
    s_add_u32 s30, s30, 0x20000
    ds_read_b128 v[12:15], v9 offset:0
    ds_read_b128 v[16:19], v9 offset:1024
    ds_read_b128 v[20:23], v9 offset:2048
    ds_read_b128 v[24:27], v9 offset:3072
    v_pk_add_f32 v[80:81], v[80:81], v[112:113]
    v_pk_add_f32 v[82:83], v[82:83], v[114:115]
    v_pk_add_f32 v[84:85], v[84:85], v[116:117]
    v_pk_add_f32 v[86:87], v[86:87], v[118:119]
    v_pk_add_f32 v[88:89], v[88:89], v[120:121]
    v_pk_add_f32 v[90:91], v[90:91], v[122:123]
    v_pk_add_f32 v[92:93], v[92:93], v[124:125]
    v_pk_add_f32 v[94:95], v[94:95], v[126:127]
    buffer_load_dwordx4 a[168:171], v191, s[4:7], s30 offen sc1
    buffer_load_dwordx4 a[172:175], v191, s[4:7], s30 offen offset:512 sc1
    s_add_u32 s30, s30, 0x20000
    v_pk_add_f32 v[96:97], v[96:97], v[128:129]
    v_pk_add_f32 v[98:99], v[98:99], v[130:131]
    v_pk_add_f32 v[100:101], v[100:101], v[132:133]
    v_pk_add_f32 v[102:103], v[102:103], v[134:135]
    v_pk_add_f32 v[104:105], v[104:105], v[136:137]
    v_pk_add_f32 v[106:107], v[106:107], v[138:139]
    v_pk_add_f32 v[108:109], v[108:109], v[140:141]
    v_pk_add_f32 v[110:111], v[110:111], v[142:143]
    s_waitcnt lgkmcnt(4)
    ds_read_b128 v[28:31], v9 offset:4096
    ds_read_b128 v[32:35], v9 offset:5120
    ds_read_b128 v[36:39], v9 offset:6144
    ds_read_b128 v[40:43], v9 offset:7168
    buffer_load_dwordx4 a[176:179], v191, s[4:7], s30 offen sc1
    buffer_load_dwordx4 a[180:183], v191, s[4:7], s30 offen offset:512 sc1
    s_add_u32 s30, s30, 0x20000
    v_pk_add_f32 v[80:81], v[80:81], v[208:209]
    v_pk_add_f32 v[82:83], v[82:83], v[210:211]
    v_pk_add_f32 v[84:85], v[84:85], v[212:213]
    v_pk_add_f32 v[86:87], v[86:87], v[214:215]
    v_pk_add_f32 v[88:89], v[88:89], v[216:217]
    v_pk_add_f32 v[90:91], v[90:91], v[218:219]
    v_pk_add_f32 v[92:93], v[92:93], v[220:221]
    v_pk_add_f32 v[94:95], v[94:95], v[222:223]
    buffer_load_dwordx4 a[184:187], v191, s[4:7], s30 offen sc1
    buffer_load_dwordx4 a[188:191], v191, s[4:7], s30 offen offset:512 sc1
    s_add_u32 s30, s30, 0x20000
    v_pk_add_f32 v[96:97], v[96:97], v[224:225]
    v_pk_add_f32 v[98:99], v[98:99], v[226:227]
    v_pk_add_f32 v[100:101], v[100:101], v[228:229]
    v_pk_add_f32 v[102:103], v[102:103], v[230:231]
    v_pk_add_f32 v[104:105], v[104:105], v[232:233]
    v_pk_add_f32 v[106:107], v[106:107], v[234:235]
    v_pk_add_f32 v[108:109], v[108:109], v[236:237]
    v_pk_add_f32 v[110:111], v[110:111], v[238:239]
    s_waitcnt lgkmcnt(0)
    ds_read_b64_tr_b16 v[48:49], v181 offset:0
    ds_read_b64_tr_b16 v[50:51], v181 offset:32768
    ds_read_b64_tr_b16 v[56:57], v182 offset:0
    ds_read_b64_tr_b16 v[58:59], v182 offset:32768
    ds_read_b64_tr_b16 v[52:53], v181 offset:16384
    ds_read_b64_tr_b16 v[54:55], v181 offset:49152
    ds_read_b64_tr_b16 v[60:61], v182 offset:16384
    ds_read_b64_tr_b16 v[62:63], v182 offset:49152
    v_pk_add_f32 v[80:81], v[80:81], v[12:13]
    v_pk_add_f32 v[82:83], v[82:83], v[14:15]
    v_pk_add_f32 v[84:85], v[84:85], v[16:17]
    v_pk_add_f32 v[86:87], v[86:87], v[18:19]
    v_pk_add_f32 v[88:89], v[88:89], v[20:21]
    v_pk_add_f32 v[90:91], v[90:91], v[22:23]
    v_pk_add_f32 v[92:93], v[92:93], v[24:25]
    v_pk_add_f32 v[94:95], v[94:95], v[26:27]
    v_pk_add_f32 v[96:97], v[96:97], v[28:29]
    v_pk_add_f32 v[98:99], v[98:99], v[30:31]
    v_pk_add_f32 v[100:101], v[100:101], v[32:33]
    v_pk_add_f32 v[102:103], v[102:103], v[34:35]
    v_pk_add_f32 v[104:105], v[104:105], v[36:37]
    v_pk_add_f32 v[106:107], v[106:107], v[38:39]
    v_pk_add_f32 v[108:109], v[108:109], v[40:41]
    v_pk_add_f32 v[110:111], v[110:111], v[42:43]
    s_mov_b32 s50, 0xbfb8aa3b
    s_mov_b32 s51, s50
    v_pk_mul_f32 v[208:209], v[80:81], s[50:51]
    v_pk_mul_f32 v[210:211], v[82:83], s[50:51]
    v_pk_mul_f32 v[212:213], v[84:85], s[50:51]
    v_pk_mul_f32 v[214:215], v[86:87], s[50:51]
    v_pk_mul_f32 v[216:217], v[88:89], s[50:51]
    v_pk_mul_f32 v[218:219], v[90:91], s[50:51]
    v_pk_mul_f32 v[220:221], v[92:93], s[50:51]
    v_pk_mul_f32 v[222:223], v[94:95], s[50:51]
    v_pk_mul_f32 v[224:225], v[96:97], s[50:51]
    v_pk_mul_f32 v[226:227], v[98:99], s[50:51]
    v_pk_mul_f32 v[228:229], v[100:101], s[50:51]
    v_pk_mul_f32 v[230:231], v[102:103], s[50:51]
    v_pk_mul_f32 v[232:233], v[104:105], s[50:51]
    v_pk_mul_f32 v[234:235], v[106:107], s[50:51]
    v_pk_mul_f32 v[236:237], v[108:109], s[50:51]
    v_pk_mul_f32 v[238:239], v[110:111], s[50:51]
    s_waitcnt vmcnt(14) lgkmcnt(4)
    v_mfma_f32_32x32x16_bf16 v[16:31], v[48:51], a[128:131], 0
    s_sub_u32 m0, s48, 65536
    ds_read_b64_tr_b16 v[64:65], v181 offset:1024
    ds_read_b64_tr_b16 v[66:67], v181 offset:33792
    buffer_load_dwordx4 v190, s[84:87], s49 offen lds
    s_add_u32 s49, s49, 0x10000
    v_exp_f32 v208, v208
    v_mfma_f32_32x32x16_bf16 v[32:47], v[56:59], a[128:131], 0
    s_waitcnt lgkmcnt(2)
    ds_read_b64_tr_b16 v[72:73], v182 offset:1024
    ds_read_b64_tr_b16 v[74:75], v182 offset:33792
    buffer_load_dwordx4 a[128:131], v191, s[4:7], s30 offen sc1
    v_exp_f32 v209, v209
    v_mfma_f32_32x32x16_bf16 v[16:31], v[52:55], a[132:135], v[16:31]
    ds_read_b64_tr_b16 v[68:69], v181 offset:17408
    ds_read_b64_tr_b16 v[70:71], v181 offset:50176
    v_exp_f32 v210, v210
    v_exp_f32 v211, v211
    v_mfma_f32_32x32x16_bf16 v[32:47], v[60:63], a[132:135], v[32:47]
    s_waitcnt vmcnt(14) lgkmcnt(2)
    ds_read_b64_tr_b16 v[76:77], v182 offset:17408
    ds_read_b64_tr_b16 v[78:79], v182 offset:50176
    buffer_load_dwordx4 a[132:135], v191, s[4:7], s30 offen offset:512 sc1
    s_add_u32 s30, s30, 0x20000
    v_exp_f32 v212, v212
    v_mfma_f32_32x32x16_bf16 v[16:31], v[64:67], a[136:139], v[16:31]
    s_sub_u32 m0, s48, 64512
    ds_read_b64_tr_b16 v[48:49], v181 offset:2048
    ds_read_b64_tr_b16 v[50:51], v181 offset:34816
    buffer_load_dwordx4 v190, s[84:87], s49 offen lds
    s_add_u32 s49, s49, 0x10000
    v_exp_f32 v213, v213
    v_mfma_f32_32x32x16_bf16 v[32:47], v[72:75], a[136:139], v[32:47]
    s_waitcnt lgkmcnt(2)
    ds_read_b64_tr_b16 v[56:57], v182 offset:2048
    ds_read_b64_tr_b16 v[58:59], v182 offset:34816
    buffer_load_dwordx4 a[136:139], v191, s[4:7], s30 offen sc1
    v_exp_f32 v214, v214
    v_mfma_f32_32x32x16_bf16 v[16:31], v[68:71], a[140:143], v[16:31]
    ds_read_b64_tr_b16 v[52:53], v181 offset:18432
    ds_read_b64_tr_b16 v[54:55], v181 offset:51200
    v_exp_f32 v215, v215
    v_exp_f32 v216, v216
    v_mfma_f32_32x32x16_bf16 v[32:47], v[76:79], a[140:143], v[32:47]
    s_waitcnt vmcnt(15) lgkmcnt(2)
    ds_read_b64_tr_b16 v[60:61], v182 offset:18432
    ds_read_b64_tr_b16 v[62:63], v182 offset:51200
    buffer_load_dwordx4 a[140:143], v191, s[4:7], s30 offen offset:512 sc1
    s_add_u32 s30, s30, 0x20000
    v_exp_f32 v217, v217
    v_mfma_f32_32x32x16_bf16 v[16:31], v[48:51], a[144:147], v[16:31]
    s_sub_u32 m0, s48, 63488
    ds_read_b64_tr_b16 v[64:65], v181 offset:3072
    ds_read_b64_tr_b16 v[66:67], v181 offset:35840
    buffer_load_dwordx4 v190, s[84:87], s49 offen lds
    s_add_u32 s49, s49, 0x10000
    v_exp_f32 v218, v218
    v_mfma_f32_32x32x16_bf16 v[32:47], v[56:59], a[144:147], v[32:47]
    s_waitcnt lgkmcnt(2)
    ds_read_b64_tr_b16 v[72:73], v182 offset:3072
    ds_read_b64_tr_b16 v[74:75], v182 offset:35840
    buffer_load_dwordx4 a[144:147], v191, s[4:7], s30 offen sc1
    v_exp_f32 v219, v219
    v_mfma_f32_32x32x16_bf16 v[16:31], v[52:55], a[148:151], v[16:31]
    ds_read_b64_tr_b16 v[68:69], v181 offset:19456
    ds_read_b64_tr_b16 v[70:71], v181 offset:52224
    v_exp_f32 v220, v220
    v_exp_f32 v221, v221
    v_mfma_f32_32x32x16_bf16 v[32:47], v[60:63], a[148:151], v[32:47]
    s_waitcnt vmcnt(16) lgkmcnt(2)
    ds_read_b64_tr_b16 v[76:77], v182 offset:19456
    ds_read_b64_tr_b16 v[78:79], v182 offset:52224
    buffer_load_dwordx4 a[148:151], v191, s[4:7], s30 offen offset:512 sc1
    s_add_u32 s30, s30, 0x20000
    v_exp_f32 v222, v222
    v_mfma_f32_32x32x16_bf16 v[16:31], v[64:67], a[152:155], v[16:31]
    s_sub_u32 m0, s48, 62464
    ds_read_b64_tr_b16 v[48:49], v181 offset:4096
    ds_read_b64_tr_b16 v[50:51], v181 offset:36864
    buffer_load_dwordx4 v190, s[84:87], s49 offen lds
    s_add_u32 s49, s49, 0x10000
    v_exp_f32 v223, v223
    v_mfma_f32_32x32x16_bf16 v[32:47], v[72:75], a[152:155], v[32:47]
    s_waitcnt lgkmcnt(2)
    ds_read_b64_tr_b16 v[56:57], v182 offset:4096
    ds_read_b64_tr_b16 v[58:59], v182 offset:36864
    buffer_load_dwordx4 a[152:155], v191, s[4:7], s30 offen sc1
    v_exp_f32 v224, v224
    v_mfma_f32_32x32x16_bf16 v[16:31], v[68:71], a[156:159], v[16:31]
    ds_read_b64_tr_b16 v[52:53], v181 offset:20480
    ds_read_b64_tr_b16 v[54:55], v181 offset:53248
    v_exp_f32 v225, v225
    v_exp_f32 v226, v226
    v_mfma_f32_32x32x16_bf16 v[32:47], v[76:79], a[156:159], v[32:47]
    s_waitcnt vmcnt(17) lgkmcnt(2)
    ds_read_b64_tr_b16 v[60:61], v182 offset:20480
    ds_read_b64_tr_b16 v[62:63], v182 offset:53248
    buffer_load_dwordx4 a[156:159], v191, s[4:7], s30 offen offset:512 sc1
    s_add_u32 s30, s30, 0x20000
    v_exp_f32 v227, v227
    v_mfma_f32_32x32x16_bf16 v[16:31], v[48:51], a[160:163], v[16:31]
    s_sub_u32 m0, s48, 61440
    ds_read_b64_tr_b16 v[64:65], v181 offset:5120
    ds_read_b64_tr_b16 v[66:67], v181 offset:37888
    buffer_load_dwordx4 v190, s[84:87], s49 offen lds
    s_add_u32 s49, s49, 0x10000
    v_exp_f32 v228, v228
    v_mfma_f32_32x32x16_bf16 v[32:47], v[56:59], a[160:163], v[32:47]
    s_waitcnt lgkmcnt(2)
    ds_read_b64_tr_b16 v[72:73], v182 offset:5120
    ds_read_b64_tr_b16 v[74:75], v182 offset:37888
    buffer_load_dwordx4 a[160:163], v191, s[4:7], s30 offen sc1
    v_exp_f32 v229, v229
    v_mfma_f32_32x32x16_bf16 v[16:31], v[52:55], a[164:167], v[16:31]
    ds_read_b64_tr_b16 v[68:69], v181 offset:21504
    ds_read_b64_tr_b16 v[70:71], v181 offset:54272
    v_exp_f32 v230, v230
    v_exp_f32 v231, v231
    v_mfma_f32_32x32x16_bf16 v[32:47], v[60:63], a[164:167], v[32:47]
    s_waitcnt vmcnt(18) lgkmcnt(2)
    ds_read_b64_tr_b16 v[76:77], v182 offset:21504
    ds_read_b64_tr_b16 v[78:79], v182 offset:54272
    buffer_load_dwordx4 a[164:167], v191, s[4:7], s30 offen offset:512 sc1
    s_add_u32 s30, s30, 0x20000
    v_exp_f32 v232, v232
    v_mfma_f32_32x32x16_bf16 v[16:31], v[64:67], a[168:171], v[16:31]
    s_sub_u32 m0, s48, 60416
    ds_read_b64_tr_b16 v[48:49], v181 offset:6144
    ds_read_b64_tr_b16 v[50:51], v181 offset:38912
    buffer_load_dwordx4 v190, s[84:87], s49 offen lds
    s_add_u32 s49, s49, 0x10000
    v_exp_f32 v233, v233
    v_mfma_f32_32x32x16_bf16 v[32:47], v[72:75], a[168:171], v[32:47]
    s_waitcnt lgkmcnt(2)
    ds_read_b64_tr_b16 v[56:57], v182 offset:6144
    ds_read_b64_tr_b16 v[58:59], v182 offset:38912
    buffer_load_dwordx4 a[168:171], v191, s[4:7], s30 offen sc1
    v_exp_f32 v234, v234
    v_mfma_f32_32x32x16_bf16 v[16:31], v[68:71], a[172:175], v[16:31]
    ds_read_b64_tr_b16 v[52:53], v181 offset:22528
    ds_read_b64_tr_b16 v[54:55], v181 offset:55296
    v_exp_f32 v235, v235
    v_exp_f32 v236, v236
    v_mfma_f32_32x32x16_bf16 v[32:47], v[76:79], a[172:175], v[32:47]
    s_waitcnt vmcnt(19) lgkmcnt(2)
    ds_read_b64_tr_b16 v[60:61], v182 offset:22528
    ds_read_b64_tr_b16 v[62:63], v182 offset:55296
    buffer_load_dwordx4 a[172:175], v191, s[4:7], s30 offen offset:512 sc1
    s_add_u32 s30, s30, 0x20000
    v_exp_f32 v237, v237
    v_mfma_f32_32x32x16_bf16 v[16:31], v[48:51], a[176:179], v[16:31]
    s_sub_u32 m0, s48, 59392
    ds_read_b64_tr_b16 v[64:65], v181 offset:7168
    ds_read_b64_tr_b16 v[66:67], v181 offset:39936
    buffer_load_dwordx4 v190, s[84:87], s49 offen lds
    s_add_u32 s49, s49, 0x10000
    v_exp_f32 v238, v238
    v_mfma_f32_32x32x16_bf16 v[32:47], v[56:59], a[176:179], v[32:47]
    s_waitcnt lgkmcnt(2)
    ds_read_b64_tr_b16 v[72:73], v182 offset:7168
    ds_read_b64_tr_b16 v[74:75], v182 offset:39936
    buffer_load_dwordx4 a[176:179], v191, s[4:7], s30 offen sc1
    v_exp_f32 v239, v239
    v_mfma_f32_32x32x16_bf16 v[16:31], v[52:55], a[180:183], v[16:31]
    ds_read_b64_tr_b16 v[68:69], v181 offset:23552
    ds_read_b64_tr_b16 v[70:71], v181 offset:56320
    v_add_f32 v208, 1.0, v208
    v_add_f32 v209, 1.0, v209
    v_mfma_f32_32x32x16_bf16 v[32:47], v[60:63], a[180:183], v[32:47]
    s_waitcnt vmcnt(20) lgkmcnt(2)
    ds_read_b64_tr_b16 v[76:77], v182 offset:23552
    ds_read_b64_tr_b16 v[78:79], v182 offset:56320
    buffer_load_dwordx4 a[180:183], v191, s[4:7], s30 offen offset:512 sc1
    s_add_u32 s30, s30, 0x20000
    v_add_f32 v210, 1.0, v210
    s_barrier
    v_mfma_f32_32x32x16_bf16 v[16:31], v[64:67], a[184:187], v[16:31]
    s_sub_u32 m0, s48, 58368
    ds_read_b64_tr_b16 v[48:49], v181 offset:8192
    ds_read_b64_tr_b16 v[50:51], v181 offset:40960
    buffer_load_dwordx4 v190, s[84:87], s49 offen lds
    s_add_u32 s49, s49, 0x10000
    v_add_f32 v211, 1.0, v211
    v_mfma_f32_32x32x16_bf16 v[32:47], v[72:75], a[184:187], v[32:47]
    s_waitcnt lgkmcnt(2)
    ds_read_b64_tr_b16 v[56:57], v182 offset:8192
    ds_read_b64_tr_b16 v[58:59], v182 offset:40960
    buffer_load_dwordx4 a[184:187], v191, s[4:7], s30 offen sc1
    v_add_f32 v212, 1.0, v212
    v_mfma_f32_32x32x16_bf16 v[16:31], v[68:71], a[188:191], v[16:31]
    ds_read_b64_tr_b16 v[52:53], v181 offset:24576
    ds_read_b64_tr_b16 v[54:55], v181 offset:57344
    v_add_f32 v213, 1.0, v213
    v_add_f32 v214, 1.0, v214
    v_mfma_f32_32x32x16_bf16 v[32:47], v[76:79], a[188:191], v[32:47]
    s_waitcnt vmcnt(20) lgkmcnt(2)
    ds_read_b64_tr_b16 v[60:61], v182 offset:24576
    ds_read_b64_tr_b16 v[62:63], v182 offset:57344
    buffer_load_dwordx4 a[188:191], v191, s[4:7], s30 offen offset:512 sc1
    s_add_u32 s30, s30, 0x20000
    v_add_f32 v215, 1.0, v215
    v_mfma_f32_32x32x16_bf16 v[16:31], v[48:51], a[128:131], v[16:31]
    s_sub_u32 m0, s48, 57344
    ds_read_b64_tr_b16 v[64:65], v181 offset:9216
    ds_read_b64_tr_b16 v[66:67], v181 offset:41984
    buffer_load_dwordx4 v190, s[84:87], s49 offen lds
    s_add_u32 s49, s49, 0x10000
    v_add_f32 v216, 1.0, v216
    v_mfma_f32_32x32x16_bf16 v[32:47], v[56:59], a[128:131], v[32:47]
    s_waitcnt lgkmcnt(2)
    ds_read_b64_tr_b16 v[72:73], v182 offset:9216
    ds_read_b64_tr_b16 v[74:75], v182 offset:41984
    buffer_load_dwordx4 a[128:131], v191, s[4:7], s30 offen sc1
    v_add_f32 v217, 1.0, v217
    v_mfma_f32_32x32x16_bf16 v[16:31], v[52:55], a[132:135], v[16:31]
    ds_read_b64_tr_b16 v[68:69], v181 offset:25600
    ds_read_b64_tr_b16 v[70:71], v181 offset:58368
    v_add_f32 v218, 1.0, v218
    v_add_f32 v219, 1.0, v219
    v_mfma_f32_32x32x16_bf16 v[32:47], v[60:63], a[132:135], v[32:47]
    s_waitcnt vmcnt(20) lgkmcnt(2)
    ds_read_b64_tr_b16 v[76:77], v182 offset:25600
    ds_read_b64_tr_b16 v[78:79], v182 offset:58368
    buffer_load_dwordx4 a[132:135], v191, s[4:7], s30 offen offset:512 sc1
    s_add_u32 s30, s30, 0x20000
    v_add_f32 v220, 1.0, v220
    v_mfma_f32_32x32x16_bf16 v[16:31], v[64:67], a[136:139], v[16:31]
    s_sub_u32 m0, s48, 56320
    ds_read_b64_tr_b16 v[48:49], v181 offset:10240
    ds_read_b64_tr_b16 v[50:51], v181 offset:43008
    buffer_load_dwordx4 v190, s[84:87], s49 offen lds
    s_add_u32 s49, s49, 0x10000
    v_add_f32 v221, 1.0, v221
    v_mfma_f32_32x32x16_bf16 v[32:47], v[72:75], a[136:139], v[32:47]
    s_waitcnt lgkmcnt(2)
    ds_read_b64_tr_b16 v[56:57], v182 offset:10240
    ds_read_b64_tr_b16 v[58:59], v182 offset:43008
    buffer_load_dwordx4 a[136:139], v191, s[4:7], s30 offen sc1
    v_add_f32 v222, 1.0, v222
    v_mfma_f32_32x32x16_bf16 v[16:31], v[68:71], a[140:143], v[16:31]
    ds_read_b64_tr_b16 v[52:53], v181 offset:26624
    ds_read_b64_tr_b16 v[54:55], v181 offset:59392
    v_add_f32 v223, 1.0, v223
    v_add_f32 v224, 1.0, v224
    v_mfma_f32_32x32x16_bf16 v[32:47], v[76:79], a[140:143], v[32:47]
    s_waitcnt vmcnt(20) lgkmcnt(2)
    ds_read_b64_tr_b16 v[60:61], v182 offset:26624
    ds_read_b64_tr_b16 v[62:63], v182 offset:59392
    buffer_load_dwordx4 a[140:143], v191, s[4:7], s30 offen offset:512 sc1
    s_add_u32 s30, s30, 0x20000
    v_add_f32 v225, 1.0, v225
    v_mfma_f32_32x32x16_bf16 v[16:31], v[48:51], a[144:147], v[16:31]
    s_sub_u32 m0, s48, 55296
    ds_read_b64_tr_b16 v[64:65], v181 offset:11264
    ds_read_b64_tr_b16 v[66:67], v181 offset:44032
    buffer_load_dwordx4 v190, s[84:87], s49 offen lds
    s_add_u32 s49, s49, 0x10000
    v_add_f32 v226, 1.0, v226
    v_mfma_f32_32x32x16_bf16 v[32:47], v[56:59], a[144:147], v[32:47]
    s_waitcnt lgkmcnt(2)
    ds_read_b64_tr_b16 v[72:73], v182 offset:11264
    ds_read_b64_tr_b16 v[74:75], v182 offset:44032
    buffer_load_dwordx4 a[144:147], v191, s[4:7], s30 offen sc1
    v_add_f32 v227, 1.0, v227
    v_mfma_f32_32x32x16_bf16 v[16:31], v[52:55], a[148:151], v[16:31]
    ds_read_b64_tr_b16 v[68:69], v181 offset:27648
    ds_read_b64_tr_b16 v[70:71], v181 offset:60416
    v_add_f32 v228, 1.0, v228
    v_add_f32 v229, 1.0, v229
    v_mfma_f32_32x32x16_bf16 v[32:47], v[60:63], a[148:151], v[32:47]
    s_waitcnt vmcnt(20) lgkmcnt(2)
    ds_read_b64_tr_b16 v[76:77], v182 offset:27648
    ds_read_b64_tr_b16 v[78:79], v182 offset:60416
    buffer_load_dwordx4 a[148:151], v191, s[4:7], s30 offen offset:512 sc1
    s_add_u32 s30, s30, 0x20000
    v_add_f32 v230, 1.0, v230
    v_mfma_f32_32x32x16_bf16 v[16:31], v[64:67], a[152:155], v[16:31]
    s_sub_u32 m0, s48, 54272
    ds_read_b64_tr_b16 v[48:49], v181 offset:12288
    ds_read_b64_tr_b16 v[50:51], v181 offset:45056
    buffer_load_dwordx4 v190, s[84:87], s49 offen lds
    s_add_u32 s49, s49, 0x10000
    v_add_f32 v231, 1.0, v231
    v_mfma_f32_32x32x16_bf16 v[32:47], v[72:75], a[152:155], v[32:47]
    s_waitcnt lgkmcnt(2)
    ds_read_b64_tr_b16 v[56:57], v182 offset:12288
    ds_read_b64_tr_b16 v[58:59], v182 offset:45056
    buffer_load_dwordx4 a[152:155], v191, s[4:7], s30 offen sc1
    v_add_f32 v232, 1.0, v232
    v_mfma_f32_32x32x16_bf16 v[16:31], v[68:71], a[156:159], v[16:31]
    ds_read_b64_tr_b16 v[52:53], v181 offset:28672
    ds_read_b64_tr_b16 v[54:55], v181 offset:61440
    v_add_f32 v233, 1.0, v233
    v_add_f32 v234, 1.0, v234
    v_mfma_f32_32x32x16_bf16 v[32:47], v[76:79], a[156:159], v[32:47]
    s_waitcnt vmcnt(20) lgkmcnt(2)
    ds_read_b64_tr_b16 v[60:61], v182 offset:28672
    ds_read_b64_tr_b16 v[62:63], v182 offset:61440
    buffer_load_dwordx4 a[156:159], v191, s[4:7], s30 offen offset:512 sc1
    s_add_u32 s30, s30, 0x20000
    v_add_f32 v235, 1.0, v235
    v_mfma_f32_32x32x16_bf16 v[16:31], v[48:51], a[160:163], v[16:31]
    s_sub_u32 m0, s48, 53248
    ds_read_b64_tr_b16 v[64:65], v181 offset:13312
    ds_read_b64_tr_b16 v[66:67], v181 offset:46080
    buffer_load_dwordx4 v190, s[84:87], s49 offen lds
    s_add_u32 s49, s49, 0x10000
    v_add_f32 v236, 1.0, v236
    v_mfma_f32_32x32x16_bf16 v[32:47], v[56:59], a[160:163], v[32:47]
    s_waitcnt lgkmcnt(2)
    ds_read_b64_tr_b16 v[72:73], v182 offset:13312
    ds_read_b64_tr_b16 v[74:75], v182 offset:46080
    buffer_load_dwordx4 a[160:163], v191, s[4:7], s30 offen sc1
    v_add_f32 v237, 1.0, v237
    v_mfma_f32_32x32x16_bf16 v[16:31], v[52:55], a[164:167], v[16:31]
    ds_read_b64_tr_b16 v[68:69], v181 offset:29696
    ds_read_b64_tr_b16 v[70:71], v181 offset:62464
    v_add_f32 v238, 1.0, v238
    v_add_f32 v239, 1.0, v239
    v_mfma_f32_32x32x16_bf16 v[32:47], v[60:63], a[164:167], v[32:47]
    s_waitcnt vmcnt(20) lgkmcnt(2)
    ds_read_b64_tr_b16 v[76:77], v182 offset:29696
    ds_read_b64_tr_b16 v[78:79], v182 offset:62464
    buffer_load_dwordx4 a[164:167], v191, s[4:7], s30 offen offset:512 sc1
    s_add_u32 s30, s30, 0x20000
    v_rcp_f32 v208, v208
    v_mfma_f32_32x32x16_bf16 v[16:31], v[64:67], a[168:171], v[16:31]
    s_sub_u32 m0, s48, 52224
    ds_read_b64_tr_b16 v[48:49], v181 offset:14336
    ds_read_b64_tr_b16 v[50:51], v181 offset:47104
    buffer_load_dwordx4 v190, s[84:87], s49 offen lds
    s_add_u32 s49, s49, 0x10000
    v_rcp_f32 v209, v209
    v_mfma_f32_32x32x16_bf16 v[32:47], v[72:75], a[168:171], v[32:47]
    s_waitcnt lgkmcnt(2)
    ds_read_b64_tr_b16 v[56:57], v182 offset:14336
    ds_read_b64_tr_b16 v[58:59], v182 offset:47104
    buffer_load_dwordx4 a[168:171], v191, s[4:7], s30 offen sc1
    v_rcp_f32 v210, v210
    v_mfma_f32_32x32x16_bf16 v[16:31], v[68:71], a[172:175], v[16:31]
    ds_read_b64_tr_b16 v[52:53], v181 offset:30720
    ds_read_b64_tr_b16 v[54:55], v181 offset:63488
    v_rcp_f32 v211, v211
    v_rcp_f32 v212, v212
    v_mfma_f32_32x32x16_bf16 v[32:47], v[76:79], a[172:175], v[32:47]
    s_waitcnt vmcnt(20) lgkmcnt(2)
    ds_read_b64_tr_b16 v[60:61], v182 offset:30720
    ds_read_b64_tr_b16 v[62:63], v182 offset:63488
    buffer_load_dwordx4 a[172:175], v191, s[4:7], s30 offen offset:512 sc1
    s_add_u32 s30, s30, 0x20000
    v_rcp_f32 v213, v213
    v_mfma_f32_32x32x16_bf16 v[16:31], v[48:51], a[176:179], v[16:31]
    s_sub_u32 m0, s48, 51200
    ds_read_b64_tr_b16 v[64:65], v181 offset:15360
    ds_read_b64_tr_b16 v[66:67], v181 offset:48128
    buffer_load_dwordx4 v190, s[84:87], s49 offen lds
    s_add_u32 s49, s49, 0x10000
    v_rcp_f32 v214, v214
    v_mfma_f32_32x32x16_bf16 v[32:47], v[56:59], a[176:179], v[32:47]
    s_waitcnt lgkmcnt(2)
    ds_read_b64_tr_b16 v[72:73], v182 offset:15360
    ds_read_b64_tr_b16 v[74:75], v182 offset:48128
    buffer_load_dwordx4 a[176:179], v191, s[4:7], s30 offen sc1
    v_rcp_f32 v215, v215
    v_mfma_f32_32x32x16_bf16 v[16:31], v[52:55], a[180:183], v[16:31]
    ds_read_b64_tr_b16 v[68:69], v181 offset:31744
    ds_read_b64_tr_b16 v[70:71], v181 offset:64512
    v_rcp_f32 v216, v216
    v_rcp_f32 v217, v217
    v_mfma_f32_32x32x16_bf16 v[32:47], v[60:63], a[180:183], v[32:47]
    s_waitcnt vmcnt(20) lgkmcnt(2)
    ds_read_b64_tr_b16 v[76:77], v182 offset:31744
    ds_read_b64_tr_b16 v[78:79], v182 offset:64512
    buffer_load_dwordx4 a[180:183], v191, s[4:7], s30 offen offset:512 sc1
    s_add_u32 s30, s30, 0x20000
    v_rcp_f32 v218, v218
    s_barrier
    v_mfma_f32_32x32x16_bf16 v[16:31], v[64:67], a[184:187], v[16:31]
    s_sub_u32 m0, s48, 50176
    ds_read_b64_tr_b16 v[48:49], v10 offset:0
    ds_read_b64_tr_b16 v[50:51], v10 offset:32768
    buffer_load_dwordx4 v190, s[84:87], s49 offen lds
    s_add_u32 s49, s49, 0x10000
    v_rcp_f32 v219, v219
    v_mfma_f32_32x32x16_bf16 v[32:47], v[72:75], a[184:187], v[32:47]
    s_waitcnt lgkmcnt(2)
    ds_read_b64_tr_b16 v[56:57], v11 offset:0
    ds_read_b64_tr_b16 v[58:59], v11 offset:32768
    buffer_load_dwordx4 a[184:187], v191, s[4:7], s30 offen sc1
    v_rcp_f32 v220, v220
    v_mfma_f32_32x32x16_bf16 v[16:31], v[68:71], a[188:191], v[16:31]
    ds_read_b64_tr_b16 v[52:53], v10 offset:16384
    ds_read_b64_tr_b16 v[54:55], v10 offset:49152
    v_rcp_f32 v221, v221
    v_rcp_f32 v222, v222
    v_mfma_f32_32x32x16_bf16 v[32:47], v[76:79], a[188:191], v[32:47]
    s_waitcnt vmcnt(20) lgkmcnt(2)
    ds_read_b64_tr_b16 v[60:61], v11 offset:16384
    ds_read_b64_tr_b16 v[62:63], v11 offset:49152
    buffer_load_dwordx4 a[188:191], v191, s[4:7], s30 offen offset:512 sc1
    s_add_u32 s30, s30, 0x20000
    v_rcp_f32 v223, v223
    v_mfma_f32_32x32x16_bf16 v[16:31], v[48:51], a[128:131], v[16:31]
    ds_read_b64_tr_b16 v[64:65], v10 offset:1024
    ds_read_b64_tr_b16 v[66:67], v10 offset:33792
    v_rcp_f32 v224, v224
    v_rcp_f32 v225, v225
    v_mfma_f32_32x32x16_bf16 v[32:47], v[56:59], a[128:131], v[32:47]
    s_waitcnt lgkmcnt(2)
    ds_read_b64_tr_b16 v[72:73], v11 offset:1024
    ds_read_b64_tr_b16 v[74:75], v11 offset:33792
    buffer_load_dwordx4 a[128:131], v191, s[4:7], s30 offen sc1
    v_rcp_f32 v226, v226
    v_rcp_f32 v227, v227
    v_mfma_f32_32x32x16_bf16 v[16:31], v[52:55], a[132:135], v[16:31]
    ds_read_b64_tr_b16 v[68:69], v10 offset:17408
    ds_read_b64_tr_b16 v[70:71], v10 offset:50176
    v_rcp_f32 v228, v228
    v_rcp_f32 v229, v229
    v_mfma_f32_32x32x16_bf16 v[32:47], v[60:63], a[132:135], v[32:47]
    s_waitcnt vmcnt(19) lgkmcnt(2)
    ds_read_b64_tr_b16 v[76:77], v11 offset:17408
    ds_read_b64_tr_b16 v[78:79], v11 offset:50176
    buffer_load_dwordx4 a[132:135], v191, s[4:7], s30 offen offset:512 sc1
    s_add_u32 s30, s30, 0x20000
    v_rcp_f32 v230, v230
    v_rcp_f32 v231, v231
    v_mfma_f32_32x32x16_bf16 v[16:31], v[64:67], a[136:139], v[16:31]
    ds_read_b64_tr_b16 v[48:49], v10 offset:2048
    ds_read_b64_tr_b16 v[50:51], v10 offset:34816
    v_rcp_f32 v232, v232
    v_rcp_f32 v233, v233
    v_mfma_f32_32x32x16_bf16 v[32:47], v[72:75], a[136:139], v[32:47]
    s_waitcnt lgkmcnt(2)
    ds_read_b64_tr_b16 v[56:57], v11 offset:2048
    ds_read_b64_tr_b16 v[58:59], v11 offset:34816
    buffer_load_dwordx4 a[136:139], v191, s[4:7], s30 offen sc1
    v_rcp_f32 v234, v234
    v_rcp_f32 v235, v235
    v_mfma_f32_32x32x16_bf16 v[16:31], v[68:71], a[140:143], v[16:31]
    ds_read_b64_tr_b16 v[52:53], v10 offset:18432
    ds_read_b64_tr_b16 v[54:55], v10 offset:51200
    v_rcp_f32 v236, v236
    v_rcp_f32 v237, v237
    v_mfma_f32_32x32x16_bf16 v[32:47], v[76:79], a[140:143], v[32:47]
    s_waitcnt vmcnt(18) lgkmcnt(2)
    ds_read_b64_tr_b16 v[60:61], v11 offset:18432
    ds_read_b64_tr_b16 v[62:63], v11 offset:51200
    buffer_load_dwordx4 a[140:143], v191, s[4:7], s30 offen offset:512 sc1
    s_add_u32 s30, s30, 0x20000
    v_rcp_f32 v238, v238
    v_rcp_f32 v239, v239
    v_mfma_f32_32x32x16_bf16 v[16:31], v[48:51], a[144:147], v[16:31]
    ds_read_b64_tr_b16 v[64:65], v10 offset:3072
    ds_read_b64_tr_b16 v[66:67], v10 offset:35840
    v_mul_f32 v208, v208, v80
    v_mul_f32 v209, v209, v81
    v_mfma_f32_32x32x16_bf16 v[32:47], v[56:59], a[144:147], v[32:47]
    s_waitcnt lgkmcnt(2)
    ds_read_b64_tr_b16 v[72:73], v11 offset:3072
    ds_read_b64_tr_b16 v[74:75], v11 offset:35840
    buffer_load_dwordx4 a[144:147], v191, s[4:7], s30 offen sc1
    v_mul_f32 v210, v210, v82
    v_mul_f32 v211, v211, v83
    v_mfma_f32_32x32x16_bf16 v[16:31], v[52:55], a[148:151], v[16:31]
    ds_read_b64_tr_b16 v[68:69], v10 offset:19456
    ds_read_b64_tr_b16 v[70:71], v10 offset:52224
    v_mul_f32 v212, v212, v84
    v_mul_f32 v213, v213, v85
    v_mfma_f32_32x32x16_bf16 v[32:47], v[60:63], a[148:151], v[32:47]
    s_waitcnt vmcnt(17) lgkmcnt(2)
    ds_read_b64_tr_b16 v[76:77], v11 offset:19456
    ds_read_b64_tr_b16 v[78:79], v11 offset:52224
    buffer_load_dwordx4 a[148:151], v191, s[4:7], s30 offen offset:512 sc1
    s_add_u32 s30, s30, 0x20000
    v_mul_f32 v214, v214, v86
    v_mul_f32 v215, v215, v87
    v_mfma_f32_32x32x16_bf16 v[16:31], v[64:67], a[152:155], v[16:31]
    ds_read_b64_tr_b16 v[48:49], v10 offset:4096
    ds_read_b64_tr_b16 v[50:51], v10 offset:36864
    v_mul_f32 v216, v216, v88
    v_mul_f32 v217, v217, v89
    v_mfma_f32_32x32x16_bf16 v[32:47], v[72:75], a[152:155], v[32:47]
    s_waitcnt lgkmcnt(2)
    ds_read_b64_tr_b16 v[56:57], v11 offset:4096
    ds_read_b64_tr_b16 v[58:59], v11 offset:36864
    buffer_load_dwordx4 a[152:155], v191, s[4:7], s30 offen sc1
    v_mul_f32 v218, v218, v90
    v_mul_f32 v219, v219, v91
    v_mfma_f32_32x32x16_bf16 v[16:31], v[68:71], a[156:159], v[16:31]
    ds_read_b64_tr_b16 v[52:53], v10 offset:20480
    ds_read_b64_tr_b16 v[54:55], v10 offset:53248
    v_mul_f32 v220, v220, v92
    v_mul_f32 v221, v221, v93
    v_mfma_f32_32x32x16_bf16 v[32:47], v[76:79], a[156:159], v[32:47]
    s_waitcnt vmcnt(16) lgkmcnt(2)
    ds_read_b64_tr_b16 v[60:61], v11 offset:20480
    ds_read_b64_tr_b16 v[62:63], v11 offset:53248
    buffer_load_dwordx4 a[156:159], v191, s[4:7], s30 offen offset:512 sc1
    s_add_u32 s30, s30, 0x20000
    v_mul_f32 v222, v222, v94
    v_mul_f32 v223, v223, v95
    v_mfma_f32_32x32x16_bf16 v[16:31], v[48:51], a[160:163], v[16:31]
    ds_read_b64_tr_b16 v[64:65], v10 offset:5120
    ds_read_b64_tr_b16 v[66:67], v10 offset:37888
    v_mul_f32 v224, v224, v96
    v_mul_f32 v225, v225, v97
    v_mfma_f32_32x32x16_bf16 v[32:47], v[56:59], a[160:163], v[32:47]
    s_waitcnt lgkmcnt(2)
    ds_read_b64_tr_b16 v[72:73], v11 offset:5120
    ds_read_b64_tr_b16 v[74:75], v11 offset:37888
    buffer_load_dwordx4 a[160:163], v191, s[4:7], s30 offen sc1
    v_mul_f32 v226, v226, v98
    v_mul_f32 v227, v227, v99
    v_mfma_f32_32x32x16_bf16 v[16:31], v[52:55], a[164:167], v[16:31]
    ds_read_b64_tr_b16 v[68:69], v10 offset:21504
    ds_read_b64_tr_b16 v[70:71], v10 offset:54272
    v_mul_f32 v228, v228, v100
    v_mul_f32 v229, v229, v101
    v_mfma_f32_32x32x16_bf16 v[32:47], v[60:63], a[164:167], v[32:47]
    s_waitcnt vmcnt(15) lgkmcnt(2)
    ds_read_b64_tr_b16 v[76:77], v11 offset:21504
    ds_read_b64_tr_b16 v[78:79], v11 offset:54272
    buffer_load_dwordx4 a[164:167], v191, s[4:7], s30 offen offset:512 sc1
    s_add_u32 s30, s30, 0x20000
    v_mul_f32 v230, v230, v102
    v_mul_f32 v231, v231, v103
    v_mfma_f32_32x32x16_bf16 v[16:31], v[64:67], a[168:171], v[16:31]
    ds_read_b64_tr_b16 v[48:49], v10 offset:6144
    ds_read_b64_tr_b16 v[50:51], v10 offset:38912
    v_mul_f32 v232, v232, v104
    v_mul_f32 v233, v233, v105
    v_mfma_f32_32x32x16_bf16 v[32:47], v[72:75], a[168:171], v[32:47]
    s_waitcnt lgkmcnt(2)
    ds_read_b64_tr_b16 v[56:57], v11 offset:6144
    ds_read_b64_tr_b16 v[58:59], v11 offset:38912
    buffer_load_dwordx4 a[168:171], v191, s[4:7], s30 offen sc1
    v_mul_f32 v234, v234, v106
    v_mul_f32 v235, v235, v107
    v_mfma_f32_32x32x16_bf16 v[16:31], v[68:71], a[172:175], v[16:31]
    ds_read_b64_tr_b16 v[52:53], v10 offset:22528
    ds_read_b64_tr_b16 v[54:55], v10 offset:55296
    v_mul_f32 v236, v236, v108
    v_mul_f32 v237, v237, v109
    v_mfma_f32_32x32x16_bf16 v[32:47], v[76:79], a[172:175], v[32:47]
    s_waitcnt vmcnt(14) lgkmcnt(2)
    ds_read_b64_tr_b16 v[60:61], v11 offset:22528
    ds_read_b64_tr_b16 v[62:63], v11 offset:55296
    buffer_load_dwordx4 a[172:175], v191, s[4:7], s30 offen offset:512 sc1
    s_add_u32 s30, s30, 0x20000
    v_mul_f32 v238, v238, v110
    v_mul_f32 v239, v239, v111
    v_mfma_f32_32x32x16_bf16 v[16:31], v[48:51], a[176:179], v[16:31]
    ds_read_b64_tr_b16 v[64:65], v10 offset:7168
    ds_read_b64_tr_b16 v[66:67], v10 offset:39936
    s_mov_b32 s51, 0xffff0000
    v_permlane32_swap_b32 v192, v194
    v_mfma_f32_32x32x16_bf16 v[32:47], v[56:59], a[176:179], v[32:47]
    s_waitcnt lgkmcnt(2)
    ds_read_b64_tr_b16 v[72:73], v11 offset:7168
    ds_read_b64_tr_b16 v[74:75], v11 offset:39936
    buffer_load_dwordx4 a[176:179], v191, s[4:7], s30 offen sc1
    v_permlane32_swap_b32 v193, v195
    v_permlane32_swap_b32 v196, v198
    v_mfma_f32_32x32x16_bf16 v[16:31], v[52:55], a[180:183], v[16:31]
    ds_read_b64_tr_b16 v[68:69], v10 offset:23552
    ds_read_b64_tr_b16 v[70:71], v10 offset:56320
    v_permlane32_swap_b32 v197, v199
    v_permlane32_swap_b32 v200, v202
    v_mfma_f32_32x32x16_bf16 v[32:47], v[60:63], a[180:183], v[32:47]
    s_waitcnt vmcnt(13) lgkmcnt(2)
    ds_read_b64_tr_b16 v[76:77], v11 offset:23552
    ds_read_b64_tr_b16 v[78:79], v11 offset:56320
    buffer_load_dwordx4 a[180:183], v191, s[4:7], s30 offen offset:512 sc1
    s_add_u32 s30, s30, 0x20000
    v_permlane32_swap_b32 v201, v203
    v_permlane32_swap_b32 v204, v206
    s_barrier
    v_mfma_f32_32x32x16_bf16 v[16:31], v[64:67], a[184:187], v[16:31]
    ds_read_b64_tr_b16 v[48:49], v10 offset:8192
    ds_read_b64_tr_b16 v[50:51], v10 offset:40960
    v_permlane32_swap_b32 v205, v207
    s_nop 1
    v_mfma_f32_32x32x16_bf16 v[32:47], v[72:75], a[184:187], v[32:47]
    s_waitcnt lgkmcnt(2)
    ds_read_b64_tr_b16 v[56:57], v11 offset:8192
    ds_read_b64_tr_b16 v[58:59], v11 offset:40960
    buffer_load_dwordx4 a[184:187], v191, s[4:7], s30 offen sc1
    v_lshlrev_b32 v112, 16, v192
    v_and_b32 v113, s51, v192
    v_mfma_f32_32x32x16_bf16 v[16:31], v[68:71], a[188:191], v[16:31]
    ds_read_b64_tr_b16 v[52:53], v10 offset:24576
    ds_read_b64_tr_b16 v[54:55], v10 offset:57344
    v_lshlrev_b32 v114, 16, v193
    v_and_b32 v115, s51, v193
    v_mfma_f32_32x32x16_bf16 v[32:47], v[76:79], a[188:191], v[32:47]
    s_waitcnt vmcnt(13) lgkmcnt(2)
    ds_read_b64_tr_b16 v[60:61], v11 offset:24576
    ds_read_b64_tr_b16 v[62:63], v11 offset:57344
    buffer_load_dwordx4 a[188:191], v191, s[4:7], s30 offen offset:512 sc1
    s_add_u32 s30, s30, 0x20000
    v_lshlrev_b32 v116, 16, v194
    v_and_b32 v117, s51, v194
    v_mfma_f32_32x32x16_bf16 v[16:31], v[48:51], a[128:131], v[16:31]
    ds_read_b64_tr_b16 v[64:65], v10 offset:9216
    ds_read_b64_tr_b16 v[66:67], v10 offset:41984
    v_lshlrev_b32 v118, 16, v195
    v_and_b32 v119, s51, v195
    v_mfma_f32_32x32x16_bf16 v[32:47], v[56:59], a[128:131], v[32:47]
    s_waitcnt lgkmcnt(2)
    ds_read_b64_tr_b16 v[72:73], v11 offset:9216
    ds_read_b64_tr_b16 v[74:75], v11 offset:41984
    v_lshlrev_b32 v120, 16, v196
    v_and_b32 v121, s51, v196
    v_mfma_f32_32x32x16_bf16 v[16:31], v[52:55], a[132:135], v[16:31]
    ds_read_b64_tr_b16 v[68:69], v10 offset:25600
    ds_read_b64_tr_b16 v[70:71], v10 offset:58368
    v_lshlrev_b32 v122, 16, v197
    v_and_b32 v123, s51, v197
    v_mfma_f32_32x32x16_bf16 v[32:47], v[60:63], a[132:135], v[32:47]
    s_waitcnt vmcnt(12) lgkmcnt(2)
    ds_read_b64_tr_b16 v[76:77], v11 offset:25600
    ds_read_b64_tr_b16 v[78:79], v11 offset:58368
    v_lshlrev_b32 v124, 16, v198
    v_and_b32 v125, s51, v198
    v_mfma_f32_32x32x16_bf16 v[16:31], v[64:67], a[136:139], v[16:31]
    ds_read_b64_tr_b16 v[48:49], v10 offset:10240
    ds_read_b64_tr_b16 v[50:51], v10 offset:43008
    v_lshlrev_b32 v126, 16, v199
    v_and_b32 v127, s51, v199
    v_mfma_f32_32x32x16_bf16 v[32:47], v[72:75], a[136:139], v[32:47]
    s_waitcnt lgkmcnt(2)
    ds_read_b64_tr_b16 v[56:57], v11 offset:10240
    ds_read_b64_tr_b16 v[58:59], v11 offset:43008
    v_lshlrev_b32 v128, 16, v200
    v_and_b32 v129, s51, v200
    v_mfma_f32_32x32x16_bf16 v[16:31], v[68:71], a[140:143], v[16:31]
    ds_read_b64_tr_b16 v[52:53], v10 offset:26624
    ds_read_b64_tr_b16 v[54:55], v10 offset:59392
    v_lshlrev_b32 v130, 16, v201
    v_and_b32 v131, s51, v201
    v_mfma_f32_32x32x16_bf16 v[32:47], v[76:79], a[140:143], v[32:47]
    s_waitcnt vmcnt(10) lgkmcnt(2)
    ds_read_b64_tr_b16 v[60:61], v11 offset:26624
    ds_read_b64_tr_b16 v[62:63], v11 offset:59392
    v_lshlrev_b32 v132, 16, v202
    v_and_b32 v133, s51, v202
    v_mfma_f32_32x32x16_bf16 v[16:31], v[48:51], a[144:147], v[16:31]
    ds_read_b64_tr_b16 v[64:65], v10 offset:11264
    ds_read_b64_tr_b16 v[66:67], v10 offset:44032
    v_lshlrev_b32 v134, 16, v203
    v_and_b32 v135, s51, v203
    v_mfma_f32_32x32x16_bf16 v[32:47], v[56:59], a[144:147], v[32:47]
    s_waitcnt lgkmcnt(2)
    ds_read_b64_tr_b16 v[72:73], v11 offset:11264
    ds_read_b64_tr_b16 v[74:75], v11 offset:44032
    v_lshlrev_b32 v136, 16, v204
    v_and_b32 v137, s51, v204
    v_mfma_f32_32x32x16_bf16 v[16:31], v[52:55], a[148:151], v[16:31]
    ds_read_b64_tr_b16 v[68:69], v10 offset:27648
    ds_read_b64_tr_b16 v[70:71], v10 offset:60416
    v_lshlrev_b32 v138, 16, v205
    v_and_b32 v139, s51, v205
    v_mfma_f32_32x32x16_bf16 v[32:47], v[60:63], a[148:151], v[32:47]
    s_waitcnt vmcnt(8) lgkmcnt(2)
    ds_read_b64_tr_b16 v[76:77], v11 offset:27648
    ds_read_b64_tr_b16 v[78:79], v11 offset:60416
    v_lshlrev_b32 v140, 16, v206
    v_and_b32 v141, s51, v206
    v_mfma_f32_32x32x16_bf16 v[16:31], v[64:67], a[152:155], v[16:31]
    ds_read_b64_tr_b16 v[48:49], v10 offset:12288
    ds_read_b64_tr_b16 v[50:51], v10 offset:45056
    v_lshlrev_b32 v142, 16, v207
    v_and_b32 v143, s51, v207
    v_mfma_f32_32x32x16_bf16 v[32:47], v[72:75], a[152:155], v[32:47]
    s_waitcnt lgkmcnt(2)
    ds_read_b64_tr_b16 v[56:57], v11 offset:12288
    ds_read_b64_tr_b16 v[58:59], v11 offset:45056
    v_mfma_f32_32x32x16_bf16 v[16:31], v[68:71], a[156:159], v[16:31]
    ds_read_b64_tr_b16 v[52:53], v10 offset:28672
    ds_read_b64_tr_b16 v[54:55], v10 offset:61440
    v_mfma_f32_32x32x16_bf16 v[32:47], v[76:79], a[156:159], v[32:47]
    s_waitcnt vmcnt(6) lgkmcnt(2)
    ds_read_b64_tr_b16 v[60:61], v11 offset:28672
    ds_read_b64_tr_b16 v[62:63], v11 offset:61440
    v_mfma_f32_32x32x16_bf16 v[16:31], v[48:51], a[160:163], v[16:31]
    ds_read_b64_tr_b16 v[64:65], v10 offset:13312
    ds_read_b64_tr_b16 v[66:67], v10 offset:46080
    v_mfma_f32_32x32x16_bf16 v[32:47], v[56:59], a[160:163], v[32:47]
    s_waitcnt lgkmcnt(2)
    ds_read_b64_tr_b16 v[72:73], v11 offset:13312
    ds_read_b64_tr_b16 v[74:75], v11 offset:46080
    v_mfma_f32_32x32x16_bf16 v[16:31], v[52:55], a[164:167], v[16:31]
    ds_read_b64_tr_b16 v[68:69], v10 offset:29696
    ds_read_b64_tr_b16 v[70:71], v10 offset:62464
    v_mfma_f32_32x32x16_bf16 v[32:47], v[60:63], a[164:167], v[32:47]
    s_waitcnt vmcnt(4) lgkmcnt(2)
    ds_read_b64_tr_b16 v[76:77], v11 offset:29696
    ds_read_b64_tr_b16 v[78:79], v11 offset:62464
    v_mfma_f32_32x32x16_bf16 v[16:31], v[64:67], a[168:171], v[16:31]
    ds_read_b64_tr_b16 v[48:49], v10 offset:14336
    ds_read_b64_tr_b16 v[50:51], v10 offset:47104
    v_mfma_f32_32x32x16_bf16 v[32:47], v[72:75], a[168:171], v[32:47]
    s_waitcnt lgkmcnt(2)
    ds_read_b64_tr_b16 v[56:57], v11 offset:14336
    ds_read_b64_tr_b16 v[58:59], v11 offset:47104
    v_mfma_f32_32x32x16_bf16 v[16:31], v[68:71], a[172:175], v[16:31]
    ds_read_b64_tr_b16 v[52:53], v10 offset:30720
    ds_read_b64_tr_b16 v[54:55], v10 offset:63488
    v_mfma_f32_32x32x16_bf16 v[32:47], v[76:79], a[172:175], v[32:47]
    s_waitcnt vmcnt(2) lgkmcnt(2)
    ds_read_b64_tr_b16 v[60:61], v11 offset:30720
    ds_read_b64_tr_b16 v[62:63], v11 offset:63488
    v_mfma_f32_32x32x16_bf16 v[16:31], v[48:51], a[176:179], v[16:31]
    ds_read_b64_tr_b16 v[64:65], v10 offset:15360
    ds_read_b64_tr_b16 v[66:67], v10 offset:48128
    v_mfma_f32_32x32x16_bf16 v[32:47], v[56:59], a[176:179], v[32:47]
    s_waitcnt lgkmcnt(2)
    ds_read_b64_tr_b16 v[72:73], v11 offset:15360
    ds_read_b64_tr_b16 v[74:75], v11 offset:48128
    v_mfma_f32_32x32x16_bf16 v[16:31], v[52:55], a[180:183], v[16:31]
    ds_read_b64_tr_b16 v[68:69], v10 offset:31744
    ds_read_b64_tr_b16 v[70:71], v10 offset:64512
    v_mfma_f32_32x32x16_bf16 v[32:47], v[60:63], a[180:183], v[32:47]
    s_waitcnt vmcnt(0) lgkmcnt(2)
    ds_read_b64_tr_b16 v[76:77], v11 offset:31744
    ds_read_b64_tr_b16 v[78:79], v11 offset:64512
    v_mfma_f32_32x32x16_bf16 v[16:31], v[64:67], a[184:187], v[16:31]
    v_mfma_f32_32x32x16_bf16 v[32:47], v[72:75], a[184:187], v[32:47]
    s_waitcnt lgkmcnt(0)
    v_mfma_f32_32x32x16_bf16 v[16:31], v[68:71], a[188:191], v[16:31]
    v_mfma_f32_32x32x16_bf16 v[32:47], v[76:79], a[188:191], v[32:47]
    s_nop 11
    v_fmac_f32 v112, v16, v208
    v_fmac_f32 v113, v17, v209
    v_fmac_f32 v114, v18, v210
    v_fmac_f32 v115, v19, v211
    v_fmac_f32 v116, v20, v212
    v_fmac_f32 v117, v21, v213
    v_fmac_f32 v118, v22, v214
    v_fmac_f32 v119, v23, v215
    v_fmac_f32 v120, v24, v216
    v_fmac_f32 v121, v25, v217
    v_fmac_f32 v122, v26, v218
    v_fmac_f32 v123, v27, v219
    v_fmac_f32 v124, v28, v220
    v_fmac_f32 v125, v29, v221
    v_fmac_f32 v126, v30, v222
    v_fmac_f32 v127, v31, v223
    v_cvt_pk_bf16_f32 v48, v112, v113
    v_cvt_pk_bf16_f32 v49, v114, v115
    v_cvt_pk_bf16_f32 v50, v116, v117
    v_cvt_pk_bf16_f32 v51, v118, v119
    v_cvt_pk_bf16_f32 v52, v120, v121
    v_cvt_pk_bf16_f32 v53, v122, v123
    v_cvt_pk_bf16_f32 v54, v124, v125
    v_cvt_pk_bf16_f32 v55, v126, v127
    s_nop 1
    v_permlane32_swap_b32 v48, v50
    v_permlane32_swap_b32 v49, v51
    v_permlane32_swap_b32 v52, v54
    v_permlane32_swap_b32 v53, v55
    ds_write_b128 v148, v[48:51]
    ds_write_b128 v149, v[52:55]
    s_nop 0
    v_fmac_f32 v128, v32, v224
    v_fmac_f32 v129, v33, v225
    v_fmac_f32 v130, v34, v226
    v_fmac_f32 v131, v35, v227
    v_fmac_f32 v132, v36, v228
    v_fmac_f32 v133, v37, v229
    v_fmac_f32 v134, v38, v230
    v_fmac_f32 v135, v39, v231
    v_fmac_f32 v136, v40, v232
    v_fmac_f32 v137, v41, v233
    v_fmac_f32 v138, v42, v234
    v_fmac_f32 v139, v43, v235
    v_fmac_f32 v140, v44, v236
    v_fmac_f32 v141, v45, v237
    v_fmac_f32 v142, v46, v238
    v_fmac_f32 v143, v47, v239
    v_cvt_pk_bf16_f32 v56, v128, v129
    v_cvt_pk_bf16_f32 v57, v130, v131
    v_cvt_pk_bf16_f32 v58, v132, v133
    v_cvt_pk_bf16_f32 v59, v134, v135
    v_cvt_pk_bf16_f32 v60, v136, v137
    v_cvt_pk_bf16_f32 v61, v138, v139
    v_cvt_pk_bf16_f32 v62, v140, v141
    v_cvt_pk_bf16_f32 v63, v142, v143
    s_nop 1
    v_permlane32_swap_b32 v56, v58
    v_permlane32_swap_b32 v57, v59
    v_permlane32_swap_b32 v60, v62
    v_permlane32_swap_b32 v61, v63
    ds_write_b128 v150, v[56:59]
    ds_write_b128 v151, v[60:63]
    ds_read_b128 v[64:67], v152 offset:0
    ds_read_b128 v[68:71], v152 offset:1024
    ds_read_b128 v[72:75], v152 offset:2048
    ds_read_b128 v[76:79], v152 offset:3072
    s_mov_b32 s50, 0
    s_waitcnt lgkmcnt(3)
    buffer_store_dwordx4 v[64:67], v167, s[32:35], s50 offen sc1
    s_mov_b32 s50, 16384
    s_waitcnt lgkmcnt(2)
    buffer_store_dwordx4 v[68:71], v167, s[32:35], s50 offen sc1
    s_mov_b32 s50, 32768
    s_waitcnt lgkmcnt(1)
    buffer_store_dwordx4 v[72:75], v167, s[32:35], s50 offen sc1
    s_mov_b32 s50, 49152
    s_waitcnt lgkmcnt(0)
    buffer_store_dwordx4 v[76:79], v167, s[32:35], s50 offen sc1
    s_or_b32 s50, s2, s77
    s_cmp_eq_u32 s50, 0
    s_cbranch_scc0 L_noepoch
    s_lshl_b32 s50, s50, 5
    v_lshlrev_b32 v12, 2, v0
    v_mov_b32 v13, s76
    s_mov_b32 exec_hi, 0
    buffer_store_dword v13, v12, s[40:43], s50 offen sc1
    s_mov_b64 exec, -1
L_noepoch:
L_end:
    s_endpgm
L_p2_slow:
    s_waitcnt vmcnt(0) lgkmcnt(0)
    s_mov_b32 s23, 0
    s_mov_b32 s28, 64
    v_mov_b32 v44, 0xff800000
    v_mov_b32 v48, 0xff800000
L_p2_maxloop:
    buffer_load_dwordx4 v[28:31], v4, s[8:11], s23 offen offset:0 sc1
    buffer_load_dwordx4 v[32:35], v4, s[8:11], s23 offen offset:512 sc1
    s_add_u32 s23, s23, 2048
    s_waitcnt vmcnt(0)
    v_mfma_f32_32x32x16_bf16 v[68:83], v[28:31], v[12:15], 0
    v_mfma_f32_32x32x16_bf16 v[68:83], v[32:35], v[16:19], v[68:83]
    v_mfma_f32_32x32x16_bf16 v[84:99], v[28:31], v[20:23], 0
    v_mfma_f32_32x32x16_bf16 v[84:99], v[32:35], v[24:27], v[84:99]
    s_nop 15
    v_max3_f32 v44, v68, v69, v44
    v_max3_f32 v44, v70, v71, v44
    v_max3_f32 v44, v72, v73, v44
    v_max3_f32 v44, v74, v75, v44
    v_max3_f32 v44, v76, v77, v44
    v_max3_f32 v44, v78, v79, v44
    v_max3_f32 v44, v80, v81, v44
    v_max3_f32 v44, v82, v83, v44
    v_max3_f32 v48, v84, v85, v48
    v_max3_f32 v48, v86, v87, v48
    v_max3_f32 v48, v88, v89, v48
    v_max3_f32 v48, v90, v91, v48
    v_max3_f32 v48, v92, v93, v48
    v_max3_f32 v48, v94, v95, v48
    v_max3_f32 v48, v96, v97, v48
    v_max3_f32 v48, v98, v99, v48
    s_sub_u32 s28, s28, 1
    s_cmp_lg_u32 s28, 0
    s_cbranch_scc1 L_p2_maxloop
    v_mov_b32 v45, v44
    s_nop 1
    v_permlane32_swap_b32 v44, v45
    s_nop 1
    v_max_f32 v44, v44, v45
    v_sub_f32 v208, 0, v44
    v_sub_f32 v209, 0, v44
    v_sub_f32 v210, 0, v44
    v_sub_f32 v211, 0, v44
    v_sub_f32 v212, 0, v44
    v_sub_f32 v213, 0, v44
    v_sub_f32 v214, 0, v44
    v_sub_f32 v215, 0, v44
    v_sub_f32 v216, 0, v44
    v_sub_f32 v217, 0, v44
    v_sub_f32 v218, 0, v44
    v_sub_f32 v219, 0, v44
    v_sub_f32 v220, 0, v44
    v_sub_f32 v221, 0, v44
    v_sub_f32 v222, 0, v44
    v_sub_f32 v223, 0, v44
    v_mov_b32 v49, v48
    s_nop 1
    v_permlane32_swap_b32 v48, v49
    s_nop 1
    v_max_f32 v48, v48, v49
    v_sub_f32 v224, 0, v48
    v_sub_f32 v225, 0, v48
    v_sub_f32 v226, 0, v48
    v_sub_f32 v227, 0, v48
    v_sub_f32 v228, 0, v48
    v_sub_f32 v229, 0, v48
    v_sub_f32 v230, 0, v48
    v_sub_f32 v231, 0, v48
    v_sub_f32 v232, 0, v48
    v_sub_f32 v233, 0, v48
    v_sub_f32 v234, 0, v48
    v_sub_f32 v235, 0, v48
    v_sub_f32 v236, 0, v48
    v_sub_f32 v237, 0, v48
    v_sub_f32 v238, 0, v48
    v_sub_f32 v239, 0, v48
    s_barrier
    s_mov_b32 s23, 0
    s_mov_b32 s25, s24
    s_mov_b32 s26, 0
    s_mov_b32 m0, s25
    s_nop 0
    buffer_load_dwordx4 v2, s[8:11], s23 offen sc1 lds
    buffer_load_dwordx4 v2, s[8:11], s23 offen offset:1024 sc1 lds
    s_add_u32 m0, s25, 8192
    s_nop 0
    buffer_load_dwordx4 v3, s[12:15], s23 offen sc1 lds
    buffer_load_dwordx4 v3, s[12:15], s23 offen offset:1024 sc1 lds
    s_add_u32 s23, s23, 8192
    s_add_u32 s25, s25, 16384
    s_and_b32 s25, s25, 65535
    s_mov_b32 m0, s25
    s_nop 0
    buffer_load_dwordx4 v2, s[8:11], s23 offen sc1 lds
    buffer_load_dwordx4 v2, s[8:11], s23 offen offset:1024 sc1 lds
    s_add_u32 m0, s25, 8192
    s_nop 0
    buffer_load_dwordx4 v3, s[12:15], s23 offen sc1 lds
    buffer_load_dwordx4 v3, s[12:15], s23 offen offset:1024 sc1 lds
    s_add_u32 s23, s23, 8192
    s_add_u32 s25, s25, 16384
    s_and_b32 s25, s25, 65535
    s_mov_b32 m0, s25
    s_nop 0
    buffer_load_dwordx4 v2, s[8:11], s23 offen sc1 lds
    v_mov_b32 v6, v4
    v_mov_b32 v7, v5
    v_mov_b32 v164, v165
    v_mov_b32 v100, 0
    v_mov_b32 v101, 0
    v_mov_b32 v102, 0
    v_mov_b32 v103, 0
    v_mov_b32 v104, 0
    v_mov_b32 v105, 0
    v_mov_b32 v106, 0
    v_mov_b32 v107, 0
    v_mov_b32 v108, 0
    v_mov_b32 v109, 0
    v_mov_b32 v110, 0
    v_mov_b32 v111, 0
    v_mov_b32 v112, 0
    v_mov_b32 v113, 0
    v_mov_b32 v114, 0
    v_mov_b32 v115, 0
    v_mov_b32 v44, 0
    v_mov_b32 v45, 0
    v_mov_b32 v46, 0
    v_mov_b32 v47, 0
    v_mov_b32 v116, 0
    v_mov_b32 v117, 0
    v_mov_b32 v118, 0
    v_mov_b32 v119, 0
    v_mov_b32 v120, 0
    v_mov_b32 v121, 0
    v_mov_b32 v122, 0
    v_mov_b32 v123, 0
    v_mov_b32 v124, 0
    v_mov_b32 v125, 0
    v_mov_b32 v126, 0
    v_mov_b32 v127, 0
    v_mov_b32 v128, 0
    v_mov_b32 v129, 0
    v_mov_b32 v130, 0
    v_mov_b32 v131, 0
    v_mov_b32 v48, 0
    v_mov_b32 v49, 0
    v_mov_b32 v50, 0
    v_mov_b32 v51, 0
    v_mov_b32 v60, 0
    v_mov_b32 v36, 0
    v_mov_b32 v61, 0
    v_mov_b32 v37, 0
    v_mov_b32 v62, 0
    v_mov_b32 v38, 0
    v_mov_b32 v63, 0
    v_mov_b32 v39, 0
    v_mov_b32 v64, 0
    v_mov_b32 v40, 0
    v_mov_b32 v65, 0
    v_mov_b32 v41, 0
    v_mov_b32 v66, 0
    v_mov_b32 v42, 0
    v_mov_b32 v67, 0
    v_mov_b32 v43, 0
    v_mov_b32 v172, 0
    v_mov_b32 v173, 0
    v_mov_b32 v174, 0
    v_mov_b32 v175, 0
    s_mov_b32 s28, 15
    s_waitcnt vmcnt(5)
    s_barrier
    ds_read_b128 v[28:31], v6 offset:0
    ds_read_b128 v[32:35], v6 offset:512
    s_waitcnt lgkmcnt(0)
    v_mfma_f32_32x32x16_bf16 v[68:83], v[28:31], v[12:15], v[208:223]
    v_mfma_f32_32x32x16_bf16 v[68:83], v[32:35], v[16:19], v[68:83]
    s_nop 11
L_p2_sloop:
    v_mfma_f32_32x32x16_bf16 v[84:99], v[28:31], v[20:23], v[224:239]
    ds_read_b128 v[28:31], v6 offset:2048
    v_exp_f32 v68, v68
    v_exp_f32 v69, v69
    v_cvt_pk_bf16_f32 v66, v172, v173
    v_cvt_pk_bf16_f32 v67, v174, v175
    v_mfma_f32_32x32x16_bf16 v[84:99], v[32:35], v[24:27], v[84:99]
    ds_read_b128 v[32:35], v6 offset:2560
    v_exp_f32 v70, v70
    v_exp_f32 v71, v71
    v_exp_f32 v72, v72
    v_mfma_f32_32x32x16_bf16 v[116:131], v[36:39], v[60:63], v[116:131]
    ds_read_b64_tr_b16 v[36:37], v7 offset:8192
    ds_read_b64_tr_b16 v[38:39], v164 offset:8192
    v_exp_f32 v73, v73
    v_cvt_pk_bf16_f32 v52, v68, v69
    v_exp_f32 v74, v74
    v_cvt_pk_bf16_f32 v53, v70, v71
    v_mfma_f32_32x32x16_bf16 v[116:131], v[40:43], v[64:67], v[116:131]
    s_waitcnt lgkmcnt(2)
    ds_read_b64_tr_b16 v[40:41], v7 offset:9216
    v_exp_f32 v75, v75
    v_exp_f32 v76, v76
    v_exp_f32 v77, v77
    v_smfmac_f32_16x16x64_bf16 v[48:51], v[8:11], v[60:67], v166
    ds_read_b64_tr_b16 v[42:43], v164 offset:9216
    v_cvt_pk_bf16_f32 v54, v72, v73
    v_exp_f32 v78, v78
    v_cvt_pk_bf16_f32 v55, v74, v75
    v_exp_f32 v79, v79
    v_exp_f32 v168, v80
    v_cvt_pk_bf16_f32 v56, v76, v77
    v_exp_f32 v169, v81
    v_exp_f32 v170, v82
    v_cvt_pk_bf16_f32 v57, v78, v79
    v_exp_f32 v171, v83
    v_mfma_f32_32x32x16_bf16 v[68:83], v[28:31], v[12:15], v[208:223]
    v_exp_f32 v84, v84
    v_exp_f32 v85, v85
    v_cvt_pk_bf16_f32 v58, v168, v169
    v_cvt_pk_bf16_f32 v59, v170, v171
    v_mfma_f32_32x32x16_bf16 v[68:83], v[32:35], v[16:19], v[68:83]
    s_waitcnt lgkmcnt(0)
    v_exp_f32 v86, v86
    v_exp_f32 v87, v87
    v_exp_f32 v88, v88
    v_mfma_f32_32x32x16_bf16 v[100:115], v[36:39], v[52:55], v[100:115]
    s_mov_b32 m0, s25
    v_exp_f32 v89, v89
    v_cvt_pk_bf16_f32 v60, v84, v85
    v_exp_f32 v90, v90
    v_cvt_pk_bf16_f32 v61, v86, v87
    v_mfma_f32_32x32x16_bf16 v[100:115], v[40:43], v[56:59], v[100:115]
    buffer_load_dwordx4 v2, s[8:11], s23 offen offset:1024 sc1 lds
    v_exp_f32 v91, v91
    v_exp_f32 v92, v92
    v_exp_f32 v93, v93
    v_smfmac_f32_16x16x64_bf16 v[44:47], v[8:11], v[52:59], v166
    s_add_u32 s26, s26, 16384
    s_and_b32 s26, s26, 65535
    v_cvt_pk_bf16_f32 v62, v88, v89
    v_exp_f32 v94, v94
    v_cvt_pk_bf16_f32 v63, v90, v91
    v_exp_f32 v95, v95
    v_exp_f32 v172, v96
    v_cvt_pk_bf16_f32 v64, v92, v93
    v_exp_f32 v173, v97
    v_exp_f32 v174, v98
    v_cvt_pk_bf16_f32 v65, v94, v95
    v_exp_f32 v175, v99
    v_mfma_f32_32x32x16_bf16 v[84:99], v[28:31], v[20:23], v[224:239]
    ds_read_b128 v[28:31], v6 offset:4096
    v_exp_f32 v68, v68
    v_exp_f32 v69, v69
    v_cvt_pk_bf16_f32 v66, v172, v173
    v_cvt_pk_bf16_f32 v67, v174, v175
    v_mfma_f32_32x32x16_bf16 v[84:99], v[32:35], v[24:27], v[84:99]
    ds_read_b128 v[32:35], v6 offset:4608
    v_exp_f32 v70, v70
    v_exp_f32 v71, v71
    v_exp_f32 v72, v72
    v_mfma_f32_32x32x16_bf16 v[116:131], v[36:39], v[60:63], v[116:131]
    ds_read_b64_tr_b16 v[36:37], v7 offset:10240
    ds_read_b64_tr_b16 v[38:39], v164 offset:10240
    v_exp_f32 v73, v73
    v_cvt_pk_bf16_f32 v52, v68, v69
    v_exp_f32 v74, v74
    v_cvt_pk_bf16_f32 v53, v70, v71
    v_mfma_f32_32x32x16_bf16 v[116:131], v[40:43], v[64:67], v[116:131]
    s_waitcnt lgkmcnt(2)
    ds_read_b64_tr_b16 v[40:41], v7 offset:11264
    v_exp_f32 v75, v75
    v_exp_f32 v76, v76
    v_exp_f32 v77, v77
    v_smfmac_f32_16x16x64_bf16 v[48:51], v[8:11], v[60:67], v166
    ds_read_b64_tr_b16 v[42:43], v164 offset:11264
    v_cvt_pk_bf16_f32 v54, v72, v73
    v_exp_f32 v78, v78
    v_cvt_pk_bf16_f32 v55, v74, v75
    v_exp_f32 v79, v79
    v_exp_f32 v168, v80
    v_cvt_pk_bf16_f32 v56, v76, v77
    v_exp_f32 v169, v81
    v_exp_f32 v170, v82
    v_cvt_pk_bf16_f32 v57, v78, v79
    v_exp_f32 v171, v83
    v_mfma_f32_32x32x16_bf16 v[68:83], v[28:31], v[12:15], v[208:223]
    v_exp_f32 v84, v84
    v_exp_f32 v85, v85
    v_cvt_pk_bf16_f32 v58, v168, v169
    v_cvt_pk_bf16_f32 v59, v170, v171
    v_mfma_f32_32x32x16_bf16 v[68:83], v[32:35], v[16:19], v[68:83]
    s_waitcnt lgkmcnt(0)
    v_exp_f32 v86, v86
    v_exp_f32 v87, v87
    v_exp_f32 v88, v88
    v_mfma_f32_32x32x16_bf16 v[100:115], v[36:39], v[52:55], v[100:115]
    s_add_u32 m0, s25, 8192
    v_exp_f32 v89, v89
    v_cvt_pk_bf16_f32 v60, v84, v85
    v_exp_f32 v90, v90
    v_cvt_pk_bf16_f32 v61, v86, v87
    v_mfma_f32_32x32x16_bf16 v[100:115], v[40:43], v[56:59], v[100:115]
    buffer_load_dwordx4 v3, s[12:15], s23 offen sc1 lds
    v_exp_f32 v91, v91
    v_exp_f32 v92, v92
    v_exp_f32 v93, v93
    v_smfmac_f32_16x16x64_bf16 v[44:47], v[8:11], v[52:59], v166
    v_cvt_pk_bf16_f32 v62, v88, v89
    v_exp_f32 v94, v94
    v_cvt_pk_bf16_f32 v63, v90, v91
    v_exp_f32 v95, v95
    v_exp_f32 v172, v96
    v_cvt_pk_bf16_f32 v64, v92, v93
    v_exp_f32 v173, v97
    v_exp_f32 v174, v98
    v_cvt_pk_bf16_f32 v65, v94, v95
    v_exp_f32 v175, v99
    v_mfma_f32_32x32x16_bf16 v[84:99], v[28:31], v[20:23], v[224:239]
    ds_read_b128 v[28:31], v6 offset:6144
    v_exp_f32 v68, v68
    v_exp_f32 v69, v69
    v_cvt_pk_bf16_f32 v66, v172, v173
    v_cvt_pk_bf16_f32 v67, v174, v175
    v_mfma_f32_32x32x16_bf16 v[84:99], v[32:35], v[24:27], v[84:99]
    ds_read_b128 v[32:35], v6 offset:6656
    v_exp_f32 v70, v70
    v_exp_f32 v71, v71
    v_exp_f32 v72, v72
    v_mfma_f32_32x32x16_bf16 v[116:131], v[36:39], v[60:63], v[116:131]
    ds_read_b64_tr_b16 v[36:37], v7 offset:12288
    ds_read_b64_tr_b16 v[38:39], v164 offset:12288
    v_exp_f32 v73, v73
    v_cvt_pk_bf16_f32 v52, v68, v69
    v_exp_f32 v74, v74
    v_cvt_pk_bf16_f32 v53, v70, v71
    v_mfma_f32_32x32x16_bf16 v[116:131], v[40:43], v[64:67], v[116:131]
    s_waitcnt lgkmcnt(2)
    ds_read_b64_tr_b16 v[40:41], v7 offset:13312
    v_exp_f32 v75, v75
    v_exp_f32 v76, v76
    v_exp_f32 v77, v77
    v_smfmac_f32_16x16x64_bf16 v[48:51], v[8:11], v[60:67], v166
    ds_read_b64_tr_b16 v[42:43], v164 offset:13312
    v_cvt_pk_bf16_f32 v54, v72, v73
    v_exp_f32 v78, v78
    v_cvt_pk_bf16_f32 v55, v74, v75
    v_exp_f32 v79, v79
    v_exp_f32 v168, v80
    v_cvt_pk_bf16_f32 v56, v76, v77
    v_exp_f32 v169, v81
    v_exp_f32 v170, v82
    v_cvt_pk_bf16_f32 v57, v78, v79
    v_exp_f32 v171, v83
    v_mfma_f32_32x32x16_bf16 v[68:83], v[28:31], v[12:15], v[208:223]
    v_exp_f32 v84, v84
    v_exp_f32 v85, v85
    v_cvt_pk_bf16_f32 v58, v168, v169
    v_cvt_pk_bf16_f32 v59, v170, v171
    v_mfma_f32_32x32x16_bf16 v[68:83], v[32:35], v[16:19], v[68:83]
    s_waitcnt lgkmcnt(0)
    v_exp_f32 v86, v86
    v_exp_f32 v87, v87
    v_exp_f32 v88, v88
    v_mfma_f32_32x32x16_bf16 v[100:115], v[36:39], v[52:55], v[100:115]
    s_add_u32 m0, s25, 8192
    v_exp_f32 v89, v89
    v_cvt_pk_bf16_f32 v60, v84, v85
    v_exp_f32 v90, v90
    v_cvt_pk_bf16_f32 v61, v86, v87
    v_mfma_f32_32x32x16_bf16 v[100:115], v[40:43], v[56:59], v[100:115]
    buffer_load_dwordx4 v3, s[12:15], s23 offen offset:1024 sc1 lds
    v_exp_f32 v91, v91
    v_exp_f32 v92, v92
    v_exp_f32 v93, v93
    v_smfmac_f32_16x16x64_bf16 v[44:47], v[8:11], v[52:59], v166
    s_add_u32 s23, s23, 8192
    v_cvt_pk_bf16_f32 v62, v88, v89
    v_exp_f32 v94, v94
    v_cvt_pk_bf16_f32 v63, v90, v91
    v_exp_f32 v95, v95
    v_exp_f32 v172, v96
    v_cvt_pk_bf16_f32 v64, v92, v93
    v_exp_f32 v173, v97
    v_exp_f32 v174, v98
    v_cvt_pk_bf16_f32 v65, v94, v95
    v_exp_f32 v175, v99
    v_add_u32 v6, s26, v4
    v_mfma_f32_32x32x16_bf16 v[84:99], v[28:31], v[20:23], v[224:239]
    s_waitcnt vmcnt(4)
    s_barrier
    ds_read_b128 v[28:31], v6 offset:0
    v_exp_f32 v68, v68
    v_exp_f32 v69, v69
    v_cvt_pk_bf16_f32 v66, v172, v173
    v_cvt_pk_bf16_f32 v67, v174, v175
    v_mfma_f32_32x32x16_bf16 v[84:99], v[32:35], v[24:27], v[84:99]
    s_add_u32 s25, s25, 16384
    ds_read_b128 v[32:35], v6 offset:512
    v_exp_f32 v70, v70
    v_exp_f32 v71, v71
    v_exp_f32 v72, v72
    v_mfma_f32_32x32x16_bf16 v[116:131], v[36:39], v[60:63], v[116:131]
    s_and_b32 s25, s25, 65535
    ds_read_b64_tr_b16 v[36:37], v7 offset:14336
    ds_read_b64_tr_b16 v[38:39], v164 offset:14336
    v_exp_f32 v73, v73
    v_cvt_pk_bf16_f32 v52, v68, v69
    v_exp_f32 v74, v74
    v_cvt_pk_bf16_f32 v53, v70, v71
    v_mfma_f32_32x32x16_bf16 v[116:131], v[40:43], v[64:67], v[116:131]
    s_waitcnt lgkmcnt(2)
    ds_read_b64_tr_b16 v[40:41], v7 offset:15360
    v_exp_f32 v75, v75
    v_exp_f32 v76, v76
    v_exp_f32 v77, v77
    v_smfmac_f32_16x16x64_bf16 v[48:51], v[8:11], v[60:67], v166
    ds_read_b64_tr_b16 v[42:43], v164 offset:15360
    v_cvt_pk_bf16_f32 v54, v72, v73
    v_exp_f32 v78, v78
    v_cvt_pk_bf16_f32 v55, v74, v75
    v_exp_f32 v79, v79
    v_exp_f32 v168, v80
    v_cvt_pk_bf16_f32 v56, v76, v77
    v_exp_f32 v169, v81
    v_exp_f32 v170, v82
    v_cvt_pk_bf16_f32 v57, v78, v79
    v_exp_f32 v171, v83
    v_mfma_f32_32x32x16_bf16 v[68:83], v[28:31], v[12:15], v[208:223]
    v_exp_f32 v84, v84
    v_exp_f32 v85, v85
    v_cvt_pk_bf16_f32 v58, v168, v169
    v_cvt_pk_bf16_f32 v59, v170, v171
    v_mfma_f32_32x32x16_bf16 v[68:83], v[32:35], v[16:19], v[68:83]
    s_waitcnt lgkmcnt(0)
    v_exp_f32 v86, v86
    v_exp_f32 v87, v87
    v_exp_f32 v88, v88
    v_mfma_f32_32x32x16_bf16 v[100:115], v[36:39], v[52:55], v[100:115]
    s_mov_b32 m0, s25
    v_exp_f32 v89, v89
    v_cvt_pk_bf16_f32 v60, v84, v85
    v_exp_f32 v90, v90
    v_cvt_pk_bf16_f32 v61, v86, v87
    v_mfma_f32_32x32x16_bf16 v[100:115], v[40:43], v[56:59], v[100:115]
    buffer_load_dwordx4 v2, s[8:11], s23 offen sc1 lds
    v_exp_f32 v91, v91
    v_exp_f32 v92, v92
    v_exp_f32 v93, v93
    v_smfmac_f32_16x16x64_bf16 v[44:47], v[8:11], v[52:59], v166
    s_sub_u32 s28, s28, 1
    v_cvt_pk_bf16_f32 v62, v88, v89
    v_exp_f32 v94, v94
    v_cvt_pk_bf16_f32 v63, v90, v91
    v_exp_f32 v95, v95
    v_exp_f32 v172, v96
    v_cvt_pk_bf16_f32 v64, v92, v93
    v_exp_f32 v173, v97
    v_exp_f32 v174, v98
    v_cvt_pk_bf16_f32 v65, v94, v95
    v_exp_f32 v175, v99
    v_add_u32 v7, s26, v5
    v_add_u32 v164, s26, v165
    s_cbranch_scc0 L_p2_sloop
    v_cvt_pk_bf16_f32 v66, v172, v173
    v_cvt_pk_bf16_f32 v67, v174, v175
    v_mfma_f32_32x32x16_bf16 v[116:131], v[36:39], v[60:63], v[116:131]
    s_nop 0
    v_mfma_f32_32x32x16_bf16 v[116:131], v[40:43], v[64:67], v[116:131]
    v_smfmac_f32_16x16x64_bf16 v[48:51], v[8:11], v[60:67], v166
    s_nop 15
    s_mov_b32 s50, 0x17800000
    s_mov_b32 s51, 0x76800000
    s_mov_b32 s52, 0x7f800000
    s_mov_b32 s53, 0x12800000
    v_add_f32 v44, v44, v45
    v_add_f32 v46, abs(v100), abs(v101)
    v_rcp_f32 v45, v44
    v_add_f32 v47, abs(v102), abs(v103)
    v_add_f32 v46, v46, abs(v104)
    v_add_f32 v47, v47, abs(v105)
    v_add_f32 v46, v46, abs(v106)
    v_add_f32 v47, v47, abs(v107)
    v_add_f32 v46, v46, abs(v108)
    v_add_f32 v47, v47, abs(v109)
    v_add_f32 v46, v46, abs(v110)
    v_add_f32 v47, v47, abs(v111)
    v_add_f32 v46, v46, abs(v112)
    v_add_f32 v47, v47, abs(v113)
    v_add_f32 v46, v46, abs(v114)
    v_add_f32 v47, v47, abs(v115)
    v_mul_f32 v100, v100, v45
    v_mul_f32 v101, v101, v45
    v_mul_f32 v102, v102, v45
    v_mul_f32 v103, v103, v45
    v_mul_f32 v104, v104, v45
    v_mul_f32 v105, v105, v45
    v_mul_f32 v106, v106, v45
    v_mul_f32 v107, v107, v45
    v_mul_f32 v108, v108, v45
    v_mul_f32 v109, v109, v45
    v_mul_f32 v110, v110, v45
    v_mul_f32 v111, v111, v45
    v_mul_f32 v112, v112, v45
    v_mul_f32 v113, v113, v45
    v_mul_f32 v114, v114, v45
    v_mul_f32 v115, v115, v45
    v_cvt_pk_bf16_f32 v68, v100, v101
    v_cvt_pk_bf16_f32 v69, v102, v103
    v_cvt_pk_bf16_f32 v70, v108, v109
    v_cvt_pk_bf16_f32 v71, v110, v111
    buffer_store_dwordx4 v[68:71], v4, s[16:19], s27 offen offset:0 sc1
    v_cvt_pk_bf16_f32 v72, v104, v105
    v_cvt_pk_bf16_f32 v73, v106, v107
    v_cvt_pk_bf16_f32 v74, v112, v113
    v_cvt_pk_bf16_f32 v75, v114, v115
    buffer_store_dwordx4 v[72:75], v4, s[16:19], s27 offen offset:512 sc1
    v_add_f32 v48, v48, v49
    v_add_f32 v50, abs(v116), abs(v117)
    v_rcp_f32 v49, v48
    v_add_f32 v51, abs(v118), abs(v119)
    v_add_f32 v50, v50, abs(v120)
    v_add_f32 v51, v51, abs(v121)
    v_add_f32 v50, v50, abs(v122)
    v_add_f32 v51, v51, abs(v123)
    v_add_f32 v50, v50, abs(v124)
    v_add_f32 v51, v51, abs(v125)
    v_add_f32 v50, v50, abs(v126)
    v_add_f32 v51, v51, abs(v127)
    v_add_f32 v50, v50, abs(v128)
    v_add_f32 v51, v51, abs(v129)
    v_add_f32 v50, v50, abs(v130)
    v_add_f32 v51, v51, abs(v131)
    v_mul_f32 v116, v116, v49
    v_mul_f32 v117, v117, v49
    v_mul_f32 v118, v118, v49
    v_mul_f32 v119, v119, v49
    v_mul_f32 v120, v120, v49
    v_mul_f32 v121, v121, v49
    v_mul_f32 v122, v122, v49
    v_mul_f32 v123, v123, v49
    v_mul_f32 v124, v124, v49
    v_mul_f32 v125, v125, v49
    v_mul_f32 v126, v126, v49
    v_mul_f32 v127, v127, v49
    v_mul_f32 v128, v128, v49
    v_mul_f32 v129, v129, v49
    v_mul_f32 v130, v130, v49
    v_mul_f32 v131, v131, v49
    v_cvt_pk_bf16_f32 v84, v116, v117
    v_cvt_pk_bf16_f32 v85, v118, v119
    v_cvt_pk_bf16_f32 v86, v124, v125
    v_cvt_pk_bf16_f32 v87, v126, v127
    buffer_store_dwordx4 v[84:87], v4, s[16:19], s27 offen offset:2048 sc1
    v_cvt_pk_bf16_f32 v88, v120, v121
    v_cvt_pk_bf16_f32 v89, v122, v123
    v_cvt_pk_bf16_f32 v90, v128, v129
    v_cvt_pk_bf16_f32 v91, v130, v131
    buffer_store_dwordx4 v[88:91], v4, s[16:19], s27 offen offset:2560 sc1
    v_add_f32 v46, v46, v47
    v_cmp_nle_f32 vcc, s50, v44
    s_mov_b64 s[54:55], vcc
    v_cmp_nge_f32 vcc, s51, v44
    s_or_b64 s[54:55], s[54:55], vcc
    v_cmp_ngt_f32 vcc, s52, v46
    s_or_b64 s[54:55], s[54:55], vcc
    v_fma_f32 v47, v44, s53, v46
    v_cmp_nle_f32 vcc, s53, v47
    s_or_b64 s[54:55], s[54:55], vcc
    v_add_f32 v50, v50, v51
    v_cmp_nle_f32 vcc, s50, v48
    s_or_b64 s[54:55], s[54:55], vcc
    v_cmp_nge_f32 vcc, s51, v48
    s_or_b64 s[54:55], s[54:55], vcc
    v_cmp_ngt_f32 vcc, s52, v50
    s_or_b64 s[54:55], s[54:55], vcc
    v_fma_f32 v51, v48, s53, v50
    v_cmp_nle_f32 vcc, s53, v51
    s_or_b64 s[54:55], s[54:55], vcc
    s_or_b32 s50, s54, s55
    s_min_u32 s50, s50, 1
    s_lshl_b32 s51, s77, 2
    v_mov_b32 v169, s50
    v_mov_b32 v170, 163824
    v_add_u32 v168, s51, v170
    s_waitcnt vmcnt(0)
    s_barrier
    s_branch L_p2_voted
L_code_end:
.section .rodata,"a"
.p2align 6
.amdhsa_kernel recurrent_scan__softmax_full_mha__geglu_ffn__prompt_kernel
  .amdhsa_next_free_vgpr 512
  .amdhsa_next_free_sgpr 102
  .amdhsa_accum_offset 256
  .amdhsa_group_segment_fixed_size 0
  .amdhsa_kernarg_size 80
  .amdhsa_user_sgpr_count 2
  .amdhsa_user_sgpr_kernarg_segment_ptr 1
  .amdhsa_system_sgpr_workgroup_id_x 1
.end_amdhsa_kernel
```
